```python
import torch

def _softmax(x, axis=-1):
    return torch.softmax(x, dim=axis)
def _gelu(x):
    return torch.nn.functional.gelu(x, approximate="tanh")
def _silu(x):
    return torch.nn.functional.silu(x)
def _sigmoid(x):
    return torch.sigmoid(x)
def _layernorm(x, axis=-1, eps=1e-5):
    m = x.mean(dim=axis, keepdim=True)
    v = x.var(dim=axis, keepdim=True, unbiased=False)
    return (x - m) / torch.sqrt(v + eps)
def _scatter_add(tgt, idx, src, axis=0):
    return tgt.clone().index_add_(axis, idx, src)
def _segment_sum(src, seg, n):
    out = torch.zeros((n,) + src.shape[1:], dtype=src.dtype)
    return out.index_add_(0, seg, src)
def _pad(x, pw):
    flat = tuple(v for pair in reversed(pw) for v in pair)
    return torch.nn.functional.pad(x, flat)

kernel_name = 'concat_heads__grouped_kv_mqa__spectral_gfnet__prompt'

def setup_inputs():

    _w = (lambda a: (lambda t: t.to(torch.bfloat16) if t.is_floating_point() else t)(torch.as_tensor(a)))
    def _A_setup():
        B, S, D, H = 1, 2048, 512, 32
        Dh = D // H
        return {
            "x": _w((lambda *s: torch.randn(*s, dtype=torch.bfloat16) * 0.05)(B, S, D)),
            "wq": _w((lambda *s: torch.randn(*s, dtype=torch.bfloat16) * 0.8)(D, H * Dh)),
            "wk": _w((lambda *s: torch.randn(*s, dtype=torch.bfloat16) * 0.8)(D, Dh)),
            "wv": _w((lambda *s: torch.randn(*s, dtype=torch.bfloat16) * 0.05)(D, Dh)),
            "wo": _w((lambda *s: torch.randn(*s, dtype=torch.bfloat16) * 0.05)(H * Dh, D)),
        }
    _A_in = _A_setup()

    def _B_setup():
        B, S, D = 1, 2048, 512
        Df = D // 2 + 1
        return {
            "x": _w((lambda *s: torch.randn(*s, dtype=torch.bfloat16) * 0.05)(B, S, D)),
            "w_r": _w((lambda *s: torch.randn(*s, dtype=torch.bfloat16) * 0.4)(S, Df) * 0.02),
            "w_i": _w((lambda *s: torch.randn(*s, dtype=torch.bfloat16) * 0.4)(S, Df) * 0.02),
        }
    _B_in = _B_setup()

    return {
        "A_x": _A_in["x"],
        "A_wq": _A_in["wq"],
        "A_wk": _A_in["wk"],
        "A_wv": _A_in["wv"],
        "A_wo": _A_in["wo"],
        "B_x": _B_in["x"],
        "B_w_r": _B_in["w_r"],
        "B_w_i": _B_in["w_i"],
    }

def reference(A_x, A_wq, A_wk, A_wv, A_wo, B_x, B_w_r, B_w_i):
    def _A_ref(x, wq, wk, wv, wo):
        B, S, D = x.shape
        H = 32
        Dh = D // H
        q = (lambda x, *d: x.permute(*d))((x @ wq).reshape(B, S, H, Dh), 0, 2, 1, 3)
        k = x @ wk
        v = x @ wv
        scores = torch.einsum("bhqd,bkd->bhqk", q, k) * (Dh ** -0.5)
        p = _softmax(scores, axis=-1)
        o = torch.einsum("bhqk,bkd->bhqd", p, v)
        return (lambda x, *d: x.permute(*d))(o, 0, 2, 1, 3).reshape(B, S, H * Dh) @ wo

    def _B_ref(x, w_r, w_i):
        B, S, D = x.shape
        X = (lambda x, axes=(-2,-1): torch.fft.rfft2(x.float(), dim=axes))(x, axes=(-2, -1))
        W = w_r + 1j * w_i
        X = X * W
        y = (lambda x, s, axes=(-2,-1): torch.fft.irfft2(x, s=s, dim=axes).to(torch.bfloat16))(X, (S, D), axes=(-2, -1))
        return y

    a = _A_ref(A_x, A_wq, A_wk, A_wv, A_wo)
    b = _B_ref(B_x, B_w_r, B_w_i)
    return torch.concatenate([a, b], axis=-1)
```

```asm
; @launch kernel=k1_kernel grid=(260,1,1) block=(256,1,1) lds=81920
; @launch kernel=k2_kernel grid=(256,1,1) block=(768,1,1) lds=154624
; @launch kernel=k3_kernel grid=(256,1,1) block=(256,1,1) lds=65536
.amdgcn_target "amdgcn-amd-amdhsa--gfx950"
.text
  .p2align 8
  .globl k1_kernel
  .type k1_kernel,@function
k1_kernel:
  s_cmp_gt_u32 s2, 259
  s_cbranch_scc1 K1_exit
  s_load_dwordx8 s[64:71], s[0:1], 0
  s_load_dwordx2 s[72:73], s[0:1], 40
  s_load_dwordx4 s[80:83], s[0:1], 48
  s_load_dwordx2 s[78:79], s[0:1], 80
  v_lshrrev_b32 v10, 6, v0
  v_and_b32 v1, 63, v0
  v_readfirstlane_b32 s3, v10
  v_lshrrev_b32 v2, 5, v1
  v_and_b32 v3, 31, v1
  s_bfe_u32 s6, s2, 0x20001
  s_lshr_b32 s7, s2, 3
  s_and_b32 s4, s7, 3
  s_lshl_b32 s6, s6, 2
  s_add_u32 s4, s4, s6
  s_bfe_u32 s5, s7, 0x30002
  s_waitcnt lgkmcnt(0)
  s_cmp_ge_u32 s2, 256
  s_cbranch_scc1 K1_tab
  s_bitcmp1_b32 s2, 0
  s_cbranch_scc1 K1_b
  s_mov_b32 s8, s64
  s_mov_b32 s9, s65
  s_mov_b32 s10, 2097152
  s_mov_b32 s11, 0x00020000
  s_mov_b32 s12, s66
  s_mov_b32 s13, s67
  s_mov_b32 s14, 524288
  s_mov_b32 s15, 0x00020000
  s_mov_b32 s16, s78
  s_mov_b32 s17, s79
  s_mov_b32 s18, 2097152
  s_mov_b32 s19, 0x00020000
  s_add_u32 s24, s78, 2097152
  s_addc_u32 s25, s79, 0
  s_mov_b32 s26, 131072
  s_mov_b32 s27, 0x00020000
  s_mov_b32 s20, s68
  s_mov_b32 s21, s69
  s_mov_b32 s22, 16384
  s_mov_b32 s23, 0x00020000
  s_cmp_lt_u32 s5, 4
  s_cbranch_scc1 K1_k
  s_mov_b32 s20, s70
  s_mov_b32 s21, s71
K1_k:
  v_lshrrev_b32 v10, 2, v1
  v_and_b32 v10, 4, v10
  v_xor_b32 v10, v10, v1
  v_and_b32 v10, 7, v10
  v_lshlrev_b32 v10, 4, v10
  v_lshrrev_b32 v11, 3, v1
  v_lshl_or_b32 v5, v11, 10, v10
  v_and_b32 v10, 3, v1
  v_lshrrev_b32 v11, 1, v10
  v_and_b32 v10, 1, v10
  v_lshl_or_b32 v10, v10, 1, v11
  v_lshlrev_b32 v10, 3, v10
  v_bfe_u32 v11, v1, 2, 2
  v_lshl_or_b32 v8, v11, 5, v10
  v_lshl_or_b32 v8, v2, 10, v8
  v_add_u32 v8, 0x10000, v8
  v_lshl_or_b32 v10, v11, 7, v10
  v_lshl_or_b32 v10, v2, 12, v10
  v_bfe_u32 v11, v1, 4, 1
  v_lshl_or_b32 v10, v11, 5, v10
  v_bfe_u32 v11, v1, 3, 1
  v_lshl_or_b32 v6, v11, 6, v10
  v_xor_b32 v7, 64, v6
  v_and_b32 v11, 14, v1
  v_lshrrev_b32 v10, 4, v1
  v_lshlrev_b32 v10, 5, v10
  v_lshl_or_b32 v4, v11, 10, v10
  v_and_b32 v10, 1, v1
  v_lshl_or_b32 v4, v10, 4, v4
  v_and_b32 v24, 1, v1
  v_sub_u32 v24, 0, v24
  s_lshl_b32 s6, s4, 2
  s_add_u32 s6, s6, s3
  s_lshl_b32 s44, s6, 15
  s_lshl_b32 s45, s5, 7
  s_add_u32 s53, s4, s5
  s_and_b32 s53, s53, 0
  s_lshl_b32 s40, s3, 12
  s_mul_i32 s54, s3, 32768
  s_add_u32 s54, s54, s45
  s_lshl_b32 s56, s3, 10
  s_add_u32 s43, s56, 0x10000
  v_lshlrev_b32 v13, 4, v1
  s_add_u32 s55, s53, 0
  s_and_b32 s55, s55, 3
  s_mul_i32 s41, s55, 131072
  s_add_u32 s41, s41, s54
  s_lshl_b32 s57, s55, 8
  s_add_u32 s57, s57, s44
  s_lshl_b32 s42, s55, 12
  s_add_u32 s42, s42, s56
  s_mov_b32 m0, s40
  s_add_u32 s40, s40, 1024
  buffer_load_dwordx4 v5, s[12:15], s41 offen lds
  s_add_u32 s41, s41, 8192
  s_mov_b32 m0, s40
  s_add_u32 s40, s40, 1024
  buffer_load_dwordx4 v5, s[12:15], s41 offen lds
  s_add_u32 s41, s41, 8192
  s_mov_b32 m0, s40
  s_add_u32 s40, s40, 1024
  buffer_load_dwordx4 v5, s[12:15], s41 offen lds
  s_add_u32 s41, s41, 8192
  s_mov_b32 m0, s40
  s_add_u32 s40, s40, 13312
  buffer_load_dwordx4 v5, s[12:15], s41 offen lds
  s_mov_b32 m0, s43
  s_add_u32 s43, s43, 4096
  buffer_load_dwordx4 v13, s[20:23], s42 offen lds
  buffer_load_dwordx4 v[128:131], v4, s[8:11], s57 offen offset:0
  buffer_load_dwordx4 v[132:135], v4, s[8:11], s57 offen offset:1024
  s_add_u32 s58, s57, 16384
  buffer_load_dwordx4 v[136:139], v4, s[8:11], s58 offen offset:0
  buffer_load_dwordx4 v[140:143], v4, s[8:11], s58 offen offset:1024
  buffer_load_dwordx4 v[144:147], v4, s[8:11], s57 offen offset:128
  buffer_load_dwordx4 v[148:151], v4, s[8:11], s57 offen offset:1152
  buffer_load_dwordx4 v[152:155], v4, s[8:11], s58 offen offset:128
  buffer_load_dwordx4 v[156:159], v4, s[8:11], s58 offen offset:1152
  s_add_u32 s55, s53, 1
  s_and_b32 s55, s55, 3
  s_mul_i32 s41, s55, 131072
  s_add_u32 s41, s41, s54
  s_lshl_b32 s57, s55, 8
  s_add_u32 s57, s57, s44
  s_lshl_b32 s42, s55, 12
  s_add_u32 s42, s42, s56
  s_mov_b32 m0, s40
  s_add_u32 s40, s40, 1024
  buffer_load_dwordx4 v5, s[12:15], s41 offen lds
  s_add_u32 s41, s41, 8192
  s_mov_b32 m0, s40
  s_add_u32 s40, s40, 1024
  buffer_load_dwordx4 v5, s[12:15], s41 offen lds
  s_add_u32 s41, s41, 8192
  s_mov_b32 m0, s40
  s_add_u32 s40, s40, 1024
  buffer_load_dwordx4 v5, s[12:15], s41 offen lds
  s_add_u32 s41, s41, 8192
  s_mov_b32 m0, s40
  s_add_u32 s40, s40, 13312
  buffer_load_dwordx4 v5, s[12:15], s41 offen lds
  s_mov_b32 m0, s43
  s_add_u32 s43, s43, 4096
  buffer_load_dwordx4 v13, s[20:23], s42 offen lds
  buffer_load_dwordx4 v[160:163], v4, s[8:11], s57 offen offset:0
  buffer_load_dwordx4 v[164:167], v4, s[8:11], s57 offen offset:1024
  s_add_u32 s58, s57, 16384
  buffer_load_dwordx4 v[168:171], v4, s[8:11], s58 offen offset:0
  buffer_load_dwordx4 v[172:175], v4, s[8:11], s58 offen offset:1024
  buffer_load_dwordx4 v[176:179], v4, s[8:11], s57 offen offset:128
  buffer_load_dwordx4 v[180:183], v4, s[8:11], s57 offen offset:1152
  buffer_load_dwordx4 v[184:187], v4, s[8:11], s58 offen offset:128
  buffer_load_dwordx4 v[188:191], v4, s[8:11], s58 offen offset:1152
  s_and_b32 s7, s5, 3
  s_cmp_eq_u32 s7, s3
  s_cbranch_scc0 K1A_plain
  s_cmp_lt_u32 s5, 4
  s_cbranch_scc0 K1A_v
  s_waitcnt vmcnt(21)
  s_barrier
  ds_read_b64_tr_b16 v[28:29], v6 offset:0
  ds_read_b64_tr_b16 v[30:31], v6 offset:512
  ds_read_b64_tr_b16 v[32:33], v7 offset:0
  ds_read_b64_tr_b16 v[34:35], v7 offset:512
  ds_read_b64_tr_b16 v[36:37], v8 offset:0
  ds_read_b64_tr_b16 v[38:39], v8 offset:128
  ds_read_b64_tr_b16 v[40:41], v6 offset:1024
  ds_read_b64_tr_b16 v[42:43], v6 offset:1536
  ds_read_b64_tr_b16 v[44:45], v7 offset:1024
  ds_read_b64_tr_b16 v[46:47], v7 offset:1536
  ds_read_b64_tr_b16 v[48:49], v8 offset:256
  ds_read_b64_tr_b16 v[50:51], v8 offset:384
  s_waitcnt vmcnt(17)
  v_xor_b32_dpp v16, v132, v128 quad_perm:[1,0,3,2] row_mask:0xf bank_mask:0xf
  v_xor_b32_dpp v17, v133, v129 quad_perm:[1,0,3,2] row_mask:0xf bank_mask:0xf
  v_xor_b32_dpp v18, v134, v130 quad_perm:[1,0,3,2] row_mask:0xf bank_mask:0xf
  v_xor_b32_dpp v19, v135, v131 quad_perm:[1,0,3,2] row_mask:0xf bank_mask:0xf
  v_xor_b32_dpp v20, v140, v136 quad_perm:[1,0,3,2] row_mask:0xf bank_mask:0xf
  v_xor_b32_dpp v21, v141, v137 quad_perm:[1,0,3,2] row_mask:0xf bank_mask:0xf
  v_xor_b32_dpp v22, v142, v138 quad_perm:[1,0,3,2] row_mask:0xf bank_mask:0xf
  v_xor_b32_dpp v23, v143, v139 quad_perm:[1,0,3,2] row_mask:0xf bank_mask:0xf
  v_and_b32 v16, v24, v16
  v_and_b32 v17, v24, v17
  v_and_b32 v18, v24, v18
  v_and_b32 v19, v24, v19
  v_and_b32 v20, v24, v20
  v_and_b32 v21, v24, v21
  v_and_b32 v22, v24, v22
  v_and_b32 v23, v24, v23
  v_xor_b32 v128, v16, v128
  v_xor_b32 v129, v17, v129
  v_xor_b32 v130, v18, v130
  v_xor_b32 v131, v19, v131
  v_xor_b32 v136, v20, v136
  v_xor_b32 v137, v21, v137
  v_xor_b32 v138, v22, v138
  v_xor_b32 v139, v23, v139
  v_xor_b32_dpp v132, v16, v132 quad_perm:[1,0,3,2] row_mask:0xf bank_mask:0xf
  v_xor_b32_dpp v133, v17, v133 quad_perm:[1,0,3,2] row_mask:0xf bank_mask:0xf
  v_xor_b32_dpp v134, v18, v134 quad_perm:[1,0,3,2] row_mask:0xf bank_mask:0xf
  v_xor_b32_dpp v135, v19, v135 quad_perm:[1,0,3,2] row_mask:0xf bank_mask:0xf
  v_xor_b32_dpp v140, v20, v140 quad_perm:[1,0,3,2] row_mask:0xf bank_mask:0xf
  v_xor_b32_dpp v141, v21, v141 quad_perm:[1,0,3,2] row_mask:0xf bank_mask:0xf
  v_xor_b32_dpp v142, v22, v142 quad_perm:[1,0,3,2] row_mask:0xf bank_mask:0xf
  v_xor_b32_dpp v143, v23, v143 quad_perm:[1,0,3,2] row_mask:0xf bank_mask:0xf
  v_permlane16_swap_b32 v128, v136
  v_permlane16_swap_b32 v129, v137
  v_permlane16_swap_b32 v130, v138
  v_permlane16_swap_b32 v131, v139
  v_permlane16_swap_b32 v132, v140
  v_permlane16_swap_b32 v133, v141
  v_permlane16_swap_b32 v134, v142
  v_permlane16_swap_b32 v135, v143
  s_waitcnt vmcnt(13)
  s_waitcnt lgkmcnt(6)
  v_mfma_f32_32x32x16_bf16 v[64:79], v[28:31], v[128:131], 0
  v_xor_b32_dpp v16, v148, v144 quad_perm:[1,0,3,2] row_mask:0xf bank_mask:0xf
  v_xor_b32_dpp v17, v149, v145 quad_perm:[1,0,3,2] row_mask:0xf bank_mask:0xf
  v_xor_b32_dpp v18, v150, v146 quad_perm:[1,0,3,2] row_mask:0xf bank_mask:0xf
  v_xor_b32_dpp v19, v151, v147 quad_perm:[1,0,3,2] row_mask:0xf bank_mask:0xf
  v_mfma_f32_32x32x16_bf16 v[80:95], v[32:35], v[128:131], 0
  v_xor_b32_dpp v20, v156, v152 quad_perm:[1,0,3,2] row_mask:0xf bank_mask:0xf
  v_xor_b32_dpp v21, v157, v153 quad_perm:[1,0,3,2] row_mask:0xf bank_mask:0xf
  v_xor_b32_dpp v22, v158, v154 quad_perm:[1,0,3,2] row_mask:0xf bank_mask:0xf
  v_mfma_f32_32x32x16_bf16 v[96:111], v[36:39], v[128:131], 0
  v_xor_b32_dpp v23, v159, v155 quad_perm:[1,0,3,2] row_mask:0xf bank_mask:0xf
  v_and_b32 v16, v24, v16
  v_and_b32 v17, v24, v17
  ds_read_b64_tr_b16 v[52:53], v6 offset:2048
  ds_read_b64_tr_b16 v[54:55], v6 offset:2560
  ds_read_b64_tr_b16 v[56:57], v7 offset:2048
  ds_read_b64_tr_b16 v[58:59], v7 offset:2560
  ds_read_b64_tr_b16 v[60:61], v8 offset:512
  ds_read_b64_tr_b16 v[62:63], v8 offset:640
  s_add_u32 s55, s53, 2
  s_and_b32 s55, s55, 3
  s_mul_i32 s41, s55, 131072
  s_add_u32 s41, s41, s54
  s_lshl_b32 s57, s55, 8
  s_add_u32 s57, s57, s44
  s_lshl_b32 s42, s55, 12
  s_add_u32 s42, s42, s56
  s_mov_b32 m0, s40
  s_add_u32 s40, s40, 1024
  buffer_load_dwordx4 v5, s[12:15], s41 offen lds
  s_add_u32 s41, s41, 8192
  s_mov_b32 m0, s40
  s_add_u32 s40, s40, 1024
  buffer_load_dwordx4 v5, s[12:15], s41 offen lds
  s_add_u32 s41, s41, 8192
  s_waitcnt lgkmcnt(6)
  v_mfma_f32_32x32x16_bf16 v[64:79], v[40:43], v[132:135], v[64:79]
  v_and_b32 v18, v24, v18
  v_and_b32 v19, v24, v19
  v_and_b32 v20, v24, v20
  v_and_b32 v21, v24, v21
  v_mfma_f32_32x32x16_bf16 v[80:95], v[44:47], v[132:135], v[80:95]
  v_and_b32 v22, v24, v22
  v_and_b32 v23, v24, v23
  v_xor_b32 v144, v16, v144
  v_mfma_f32_32x32x16_bf16 v[96:111], v[48:51], v[132:135], v[96:111]
  v_xor_b32 v145, v17, v145
  v_xor_b32 v146, v18, v146
  v_xor_b32 v147, v19, v147
  ds_read_b64_tr_b16 v[28:29], v6 offset:3072
  ds_read_b64_tr_b16 v[30:31], v6 offset:3584
  ds_read_b64_tr_b16 v[32:33], v7 offset:3072
  ds_read_b64_tr_b16 v[34:35], v7 offset:3584
  ds_read_b64_tr_b16 v[36:37], v8 offset:768
  ds_read_b64_tr_b16 v[38:39], v8 offset:896
  s_mov_b32 m0, s40
  s_add_u32 s40, s40, 1024
  buffer_load_dwordx4 v5, s[12:15], s41 offen lds
  s_add_u32 s41, s41, 8192
  s_mov_b32 m0, s40
  s_add_u32 s40, s40, 13312
  buffer_load_dwordx4 v5, s[12:15], s41 offen lds
  s_waitcnt lgkmcnt(6)
  v_mfma_f32_32x32x16_bf16 v[64:79], v[52:55], v[136:139], v[64:79]
  v_xor_b32 v152, v20, v152
  v_xor_b32 v153, v21, v153
  v_xor_b32 v154, v22, v154
  v_xor_b32 v155, v23, v155
  v_mfma_f32_32x32x16_bf16 v[80:95], v[56:59], v[136:139], v[80:95]
  v_xor_b32_dpp v148, v16, v148 quad_perm:[1,0,3,2] row_mask:0xf bank_mask:0xf
  v_xor_b32_dpp v149, v17, v149 quad_perm:[1,0,3,2] row_mask:0xf bank_mask:0xf
  v_xor_b32_dpp v150, v18, v150 quad_perm:[1,0,3,2] row_mask:0xf bank_mask:0xf
  v_mfma_f32_32x32x16_bf16 v[96:111], v[60:63], v[136:139], v[96:111]
  v_xor_b32_dpp v151, v19, v151 quad_perm:[1,0,3,2] row_mask:0xf bank_mask:0xf
  v_xor_b32_dpp v156, v20, v156 quad_perm:[1,0,3,2] row_mask:0xf bank_mask:0xf
  v_xor_b32_dpp v157, v21, v157 quad_perm:[1,0,3,2] row_mask:0xf bank_mask:0xf
  ds_read_b64_tr_b16 v[40:41], v6 offset:8192
  ds_read_b64_tr_b16 v[42:43], v6 offset:8704
  ds_read_b64_tr_b16 v[44:45], v7 offset:8192
  ds_read_b64_tr_b16 v[46:47], v7 offset:8704
  ds_read_b64_tr_b16 v[48:49], v8 offset:2048
  ds_read_b64_tr_b16 v[50:51], v8 offset:2176
  s_mov_b32 m0, s43
  s_add_u32 s43, s43, 4096
  buffer_load_dwordx4 v13, s[20:23], s42 offen lds
  s_waitcnt lgkmcnt(6)
  v_mfma_f32_32x32x16_bf16 v[64:79], v[28:31], v[140:143], v[64:79]
  v_xor_b32_dpp v158, v22, v158 quad_perm:[1,0,3,2] row_mask:0xf bank_mask:0xf
  v_xor_b32_dpp v159, v23, v159 quad_perm:[1,0,3,2] row_mask:0xf bank_mask:0xf
  v_permlane16_swap_b32 v144, v152
  v_permlane16_swap_b32 v145, v153
  v_mfma_f32_32x32x16_bf16 v[80:95], v[32:35], v[140:143], v[80:95]
  v_permlane16_swap_b32 v146, v154
  v_permlane16_swap_b32 v147, v155
  v_permlane16_swap_b32 v148, v156
  v_mfma_f32_32x32x16_bf16 v[96:111], v[36:39], v[140:143], v[96:111]
  v_permlane16_swap_b32 v149, v157
  v_permlane16_swap_b32 v150, v158
  v_permlane16_swap_b32 v151, v159
  ds_read_b64_tr_b16 v[52:53], v6 offset:9216
  ds_read_b64_tr_b16 v[54:55], v6 offset:9728
  ds_read_b64_tr_b16 v[56:57], v7 offset:9216
  ds_read_b64_tr_b16 v[58:59], v7 offset:9728
  ds_read_b64_tr_b16 v[60:61], v8 offset:2304
  ds_read_b64_tr_b16 v[62:63], v8 offset:2432
  buffer_load_dwordx4 v[192:195], v4, s[8:11], s57 offen offset:0
  buffer_load_dwordx4 v[196:199], v4, s[8:11], s57 offen offset:1024
  s_waitcnt vmcnt(11)
  s_waitcnt lgkmcnt(6)
  v_mfma_f32_32x32x16_bf16 v[64:79], v[40:43], v[144:147], v[64:79]
  v_xor_b32_dpp v16, v164, v160 quad_perm:[1,0,3,2] row_mask:0xf bank_mask:0xf
  v_xor_b32_dpp v17, v165, v161 quad_perm:[1,0,3,2] row_mask:0xf bank_mask:0xf
  v_xor_b32_dpp v18, v166, v162 quad_perm:[1,0,3,2] row_mask:0xf bank_mask:0xf
  v_xor_b32_dpp v19, v167, v163 quad_perm:[1,0,3,2] row_mask:0xf bank_mask:0xf
  v_mfma_f32_32x32x16_bf16 v[80:95], v[44:47], v[144:147], v[80:95]
  v_xor_b32_dpp v20, v172, v168 quad_perm:[1,0,3,2] row_mask:0xf bank_mask:0xf
  v_xor_b32_dpp v21, v173, v169 quad_perm:[1,0,3,2] row_mask:0xf bank_mask:0xf
  v_xor_b32_dpp v22, v174, v170 quad_perm:[1,0,3,2] row_mask:0xf bank_mask:0xf
  v_mfma_f32_32x32x16_bf16 v[96:111], v[48:51], v[144:147], v[96:111]
  v_xor_b32_dpp v23, v175, v171 quad_perm:[1,0,3,2] row_mask:0xf bank_mask:0xf
  v_and_b32 v16, v24, v16
  v_and_b32 v17, v24, v17
  ds_read_b64_tr_b16 v[28:29], v6 offset:10240
  ds_read_b64_tr_b16 v[30:31], v6 offset:10752
  ds_read_b64_tr_b16 v[32:33], v7 offset:10240
  ds_read_b64_tr_b16 v[34:35], v7 offset:10752
  ds_read_b64_tr_b16 v[36:37], v8 offset:2560
  ds_read_b64_tr_b16 v[38:39], v8 offset:2688
  s_add_u32 s58, s57, 16384
  buffer_load_dwordx4 v[200:203], v4, s[8:11], s58 offen offset:0
  buffer_load_dwordx4 v[204:207], v4, s[8:11], s58 offen offset:1024
  s_waitcnt lgkmcnt(6)
  v_mfma_f32_32x32x16_bf16 v[64:79], v[52:55], v[148:151], v[64:79]
  v_and_b32 v18, v24, v18
  v_and_b32 v19, v24, v19
  v_and_b32 v20, v24, v20
  v_and_b32 v21, v24, v21
  v_mfma_f32_32x32x16_bf16 v[80:95], v[56:59], v[148:151], v[80:95]
  v_and_b32 v22, v24, v22
  v_and_b32 v23, v24, v23
  v_xor_b32 v160, v16, v160
  v_mfma_f32_32x32x16_bf16 v[96:111], v[60:63], v[148:151], v[96:111]
  v_xor_b32 v161, v17, v161
  v_xor_b32 v162, v18, v162
  v_xor_b32 v163, v19, v163
  ds_read_b64_tr_b16 v[40:41], v6 offset:11264
  ds_read_b64_tr_b16 v[42:43], v6 offset:11776
  ds_read_b64_tr_b16 v[44:45], v7 offset:11264
  ds_read_b64_tr_b16 v[46:47], v7 offset:11776
  ds_read_b64_tr_b16 v[48:49], v8 offset:2816
  ds_read_b64_tr_b16 v[50:51], v8 offset:2944
  buffer_load_dwordx4 v[208:211], v4, s[8:11], s57 offen offset:128
  s_waitcnt lgkmcnt(6)
  v_mfma_f32_32x32x16_bf16 v[64:79], v[28:31], v[152:155], v[64:79]
  v_xor_b32 v168, v20, v168
  v_xor_b32 v169, v21, v169
  v_xor_b32 v170, v22, v170
  v_xor_b32 v171, v23, v171
  v_mfma_f32_32x32x16_bf16 v[80:95], v[32:35], v[152:155], v[80:95]
  v_xor_b32_dpp v164, v16, v164 quad_perm:[1,0,3,2] row_mask:0xf bank_mask:0xf
  v_xor_b32_dpp v165, v17, v165 quad_perm:[1,0,3,2] row_mask:0xf bank_mask:0xf
  v_xor_b32_dpp v166, v18, v166 quad_perm:[1,0,3,2] row_mask:0xf bank_mask:0xf
  v_mfma_f32_32x32x16_bf16 v[96:111], v[36:39], v[152:155], v[96:111]
  v_xor_b32_dpp v167, v19, v167 quad_perm:[1,0,3,2] row_mask:0xf bank_mask:0xf
  v_xor_b32_dpp v172, v20, v172 quad_perm:[1,0,3,2] row_mask:0xf bank_mask:0xf
  v_xor_b32_dpp v173, v21, v173 quad_perm:[1,0,3,2] row_mask:0xf bank_mask:0xf
  s_barrier
  ds_read_b64_tr_b16 v[52:53], v6 offset:16384
  ds_read_b64_tr_b16 v[54:55], v6 offset:16896
  ds_read_b64_tr_b16 v[56:57], v7 offset:16384
  ds_read_b64_tr_b16 v[58:59], v7 offset:16896
  ds_read_b64_tr_b16 v[60:61], v8 offset:4096
  ds_read_b64_tr_b16 v[62:63], v8 offset:4224
  buffer_load_dwordx4 v[212:215], v4, s[8:11], s57 offen offset:1152
  buffer_load_dwordx4 v[216:219], v4, s[8:11], s58 offen offset:128
  s_waitcnt lgkmcnt(6)
  v_mfma_f32_32x32x16_bf16 v[64:79], v[40:43], v[156:159], v[64:79]
  v_xor_b32_dpp v174, v22, v174 quad_perm:[1,0,3,2] row_mask:0xf bank_mask:0xf
  v_xor_b32_dpp v175, v23, v175 quad_perm:[1,0,3,2] row_mask:0xf bank_mask:0xf
  v_permlane16_swap_b32 v160, v168
  v_permlane16_swap_b32 v161, v169
  v_mfma_f32_32x32x16_bf16 v[80:95], v[44:47], v[156:159], v[80:95]
  v_permlane16_swap_b32 v162, v170
  v_permlane16_swap_b32 v163, v171
  v_permlane16_swap_b32 v164, v172
  v_mfma_f32_32x32x16_bf16 v[96:111], v[48:51], v[156:159], v[96:111]
  v_permlane16_swap_b32 v165, v173
  v_permlane16_swap_b32 v166, v174
  v_permlane16_swap_b32 v167, v175
  ds_read_b64_tr_b16 v[28:29], v6 offset:17408
  ds_read_b64_tr_b16 v[30:31], v6 offset:17920
  ds_read_b64_tr_b16 v[32:33], v7 offset:17408
  ds_read_b64_tr_b16 v[34:35], v7 offset:17920
  ds_read_b64_tr_b16 v[36:37], v8 offset:4352
  ds_read_b64_tr_b16 v[38:39], v8 offset:4480
  buffer_load_dwordx4 v[220:223], v4, s[8:11], s58 offen offset:1152
  s_waitcnt vmcnt(13)
  s_waitcnt lgkmcnt(6)
  v_mfma_f32_32x32x16_bf16 v[64:79], v[52:55], v[160:163], v[64:79]
  v_xor_b32_dpp v16, v180, v176 quad_perm:[1,0,3,2] row_mask:0xf bank_mask:0xf
  v_xor_b32_dpp v17, v181, v177 quad_perm:[1,0,3,2] row_mask:0xf bank_mask:0xf
  v_xor_b32_dpp v18, v182, v178 quad_perm:[1,0,3,2] row_mask:0xf bank_mask:0xf
  v_xor_b32_dpp v19, v183, v179 quad_perm:[1,0,3,2] row_mask:0xf bank_mask:0xf
  v_mfma_f32_32x32x16_bf16 v[80:95], v[56:59], v[160:163], v[80:95]
  v_xor_b32_dpp v20, v188, v184 quad_perm:[1,0,3,2] row_mask:0xf bank_mask:0xf
  v_xor_b32_dpp v21, v189, v185 quad_perm:[1,0,3,2] row_mask:0xf bank_mask:0xf
  v_xor_b32_dpp v22, v190, v186 quad_perm:[1,0,3,2] row_mask:0xf bank_mask:0xf
  v_mfma_f32_32x32x16_bf16 v[96:111], v[60:63], v[160:163], v[96:111]
  v_xor_b32_dpp v23, v191, v187 quad_perm:[1,0,3,2] row_mask:0xf bank_mask:0xf
  v_and_b32 v16, v24, v16
  v_and_b32 v17, v24, v17
  ds_read_b64_tr_b16 v[40:41], v6 offset:18432
  ds_read_b64_tr_b16 v[42:43], v6 offset:18944
  ds_read_b64_tr_b16 v[44:45], v7 offset:18432
  ds_read_b64_tr_b16 v[46:47], v7 offset:18944
  ds_read_b64_tr_b16 v[48:49], v8 offset:4608
  ds_read_b64_tr_b16 v[50:51], v8 offset:4736
  s_add_u32 s55, s53, 3
  s_and_b32 s55, s55, 3
  s_mul_i32 s41, s55, 131072
  s_add_u32 s41, s41, s54
  s_lshl_b32 s57, s55, 8
  s_add_u32 s57, s57, s44
  s_lshl_b32 s42, s55, 12
  s_add_u32 s42, s42, s56
  s_mov_b32 m0, s40
  s_add_u32 s40, s40, 1024
  buffer_load_dwordx4 v5, s[12:15], s41 offen lds
  s_add_u32 s41, s41, 8192
  s_mov_b32 m0, s40
  s_add_u32 s40, s40, 1024
  buffer_load_dwordx4 v5, s[12:15], s41 offen lds
  s_add_u32 s41, s41, 8192
  s_waitcnt lgkmcnt(6)
  v_mfma_f32_32x32x16_bf16 v[64:79], v[28:31], v[164:167], v[64:79]
  v_and_b32 v18, v24, v18
  v_and_b32 v19, v24, v19
  v_and_b32 v20, v24, v20
  v_and_b32 v21, v24, v21
  v_mfma_f32_32x32x16_bf16 v[80:95], v[32:35], v[164:167], v[80:95]
  v_and_b32 v22, v24, v22
  v_and_b32 v23, v24, v23
  v_xor_b32 v176, v16, v176
  v_mfma_f32_32x32x16_bf16 v[96:111], v[36:39], v[164:167], v[96:111]
  v_xor_b32 v177, v17, v177
  v_xor_b32 v178, v18, v178
  v_xor_b32 v179, v19, v179
  ds_read_b64_tr_b16 v[52:53], v6 offset:19456
  ds_read_b64_tr_b16 v[54:55], v6 offset:19968
  ds_read_b64_tr_b16 v[56:57], v7 offset:19456
  ds_read_b64_tr_b16 v[58:59], v7 offset:19968
  ds_read_b64_tr_b16 v[60:61], v8 offset:4864
  ds_read_b64_tr_b16 v[62:63], v8 offset:4992
  s_mov_b32 m0, s40
  s_add_u32 s40, s40, 1024
  buffer_load_dwordx4 v5, s[12:15], s41 offen lds
  s_add_u32 s41, s41, 8192
  s_mov_b32 m0, s40
  s_add_u32 s40, s40, 13312
  buffer_load_dwordx4 v5, s[12:15], s41 offen lds
  s_waitcnt lgkmcnt(6)
  v_mfma_f32_32x32x16_bf16 v[64:79], v[40:43], v[168:171], v[64:79]
  v_xor_b32 v184, v20, v184
  v_xor_b32 v185, v21, v185
  v_xor_b32 v186, v22, v186
  v_xor_b32 v187, v23, v187
  v_mfma_f32_32x32x16_bf16 v[80:95], v[44:47], v[168:171], v[80:95]
  v_xor_b32_dpp v180, v16, v180 quad_perm:[1,0,3,2] row_mask:0xf bank_mask:0xf
  v_xor_b32_dpp v181, v17, v181 quad_perm:[1,0,3,2] row_mask:0xf bank_mask:0xf
  v_xor_b32_dpp v182, v18, v182 quad_perm:[1,0,3,2] row_mask:0xf bank_mask:0xf
  v_mfma_f32_32x32x16_bf16 v[96:111], v[48:51], v[168:171], v[96:111]
  v_xor_b32_dpp v183, v19, v183 quad_perm:[1,0,3,2] row_mask:0xf bank_mask:0xf
  v_xor_b32_dpp v188, v20, v188 quad_perm:[1,0,3,2] row_mask:0xf bank_mask:0xf
  v_xor_b32_dpp v189, v21, v189 quad_perm:[1,0,3,2] row_mask:0xf bank_mask:0xf
  ds_read_b64_tr_b16 v[28:29], v6 offset:24576
  ds_read_b64_tr_b16 v[30:31], v6 offset:25088
  ds_read_b64_tr_b16 v[32:33], v7 offset:24576
  ds_read_b64_tr_b16 v[34:35], v7 offset:25088
  ds_read_b64_tr_b16 v[36:37], v8 offset:6144
  ds_read_b64_tr_b16 v[38:39], v8 offset:6272
  s_mov_b32 m0, s43
  s_add_u32 s43, s43, 4096
  buffer_load_dwordx4 v13, s[20:23], s42 offen lds
  s_waitcnt lgkmcnt(6)
  v_mfma_f32_32x32x16_bf16 v[64:79], v[52:55], v[172:175], v[64:79]
  v_xor_b32_dpp v190, v22, v190 quad_perm:[1,0,3,2] row_mask:0xf bank_mask:0xf
  v_xor_b32_dpp v191, v23, v191 quad_perm:[1,0,3,2] row_mask:0xf bank_mask:0xf
  v_permlane16_swap_b32 v176, v184
  v_permlane16_swap_b32 v177, v185
  v_mfma_f32_32x32x16_bf16 v[80:95], v[56:59], v[172:175], v[80:95]
  v_permlane16_swap_b32 v178, v186
  v_permlane16_swap_b32 v179, v187
  v_permlane16_swap_b32 v180, v188
  v_mfma_f32_32x32x16_bf16 v[96:111], v[60:63], v[172:175], v[96:111]
  v_permlane16_swap_b32 v181, v189
  v_permlane16_swap_b32 v182, v190
  v_permlane16_swap_b32 v183, v191
  ds_read_b64_tr_b16 v[40:41], v6 offset:25600
  ds_read_b64_tr_b16 v[42:43], v6 offset:26112
  ds_read_b64_tr_b16 v[44:45], v7 offset:25600
  ds_read_b64_tr_b16 v[46:47], v7 offset:26112
  ds_read_b64_tr_b16 v[48:49], v8 offset:6400
  ds_read_b64_tr_b16 v[50:51], v8 offset:6528
  buffer_load_dwordx4 v[224:227], v4, s[8:11], s57 offen offset:0
  buffer_load_dwordx4 v[228:231], v4, s[8:11], s57 offen offset:1024
  s_waitcnt vmcnt(11)
  s_waitcnt lgkmcnt(6)
  v_mfma_f32_32x32x16_bf16 v[64:79], v[28:31], v[176:179], v[64:79]
  v_xor_b32_dpp v16, v196, v192 quad_perm:[1,0,3,2] row_mask:0xf bank_mask:0xf
  v_xor_b32_dpp v17, v197, v193 quad_perm:[1,0,3,2] row_mask:0xf bank_mask:0xf
  v_xor_b32_dpp v18, v198, v194 quad_perm:[1,0,3,2] row_mask:0xf bank_mask:0xf
  v_xor_b32_dpp v19, v199, v195 quad_perm:[1,0,3,2] row_mask:0xf bank_mask:0xf
  v_mfma_f32_32x32x16_bf16 v[80:95], v[32:35], v[176:179], v[80:95]
  v_xor_b32_dpp v20, v204, v200 quad_perm:[1,0,3,2] row_mask:0xf bank_mask:0xf
  v_xor_b32_dpp v21, v205, v201 quad_perm:[1,0,3,2] row_mask:0xf bank_mask:0xf
  v_xor_b32_dpp v22, v206, v202 quad_perm:[1,0,3,2] row_mask:0xf bank_mask:0xf
  v_mfma_f32_32x32x16_bf16 v[96:111], v[36:39], v[176:179], v[96:111]
  v_xor_b32_dpp v23, v207, v203 quad_perm:[1,0,3,2] row_mask:0xf bank_mask:0xf
  v_and_b32 v16, v24, v16
  v_and_b32 v17, v24, v17
  ds_read_b64_tr_b16 v[52:53], v6 offset:26624
  ds_read_b64_tr_b16 v[54:55], v6 offset:27136
  ds_read_b64_tr_b16 v[56:57], v7 offset:26624
  ds_read_b64_tr_b16 v[58:59], v7 offset:27136
  ds_read_b64_tr_b16 v[60:61], v8 offset:6656
  ds_read_b64_tr_b16 v[62:63], v8 offset:6784
  s_add_u32 s58, s57, 16384
  buffer_load_dwordx4 v[232:235], v4, s[8:11], s58 offen offset:0
  buffer_load_dwordx4 v[236:239], v4, s[8:11], s58 offen offset:1024
  s_waitcnt lgkmcnt(6)
  v_mfma_f32_32x32x16_bf16 v[64:79], v[40:43], v[180:183], v[64:79]
  v_and_b32 v18, v24, v18
  v_and_b32 v19, v24, v19
  v_and_b32 v20, v24, v20
  v_and_b32 v21, v24, v21
  v_mfma_f32_32x32x16_bf16 v[80:95], v[44:47], v[180:183], v[80:95]
  v_and_b32 v22, v24, v22
  v_and_b32 v23, v24, v23
  v_xor_b32 v192, v16, v192
  v_mfma_f32_32x32x16_bf16 v[96:111], v[48:51], v[180:183], v[96:111]
  v_xor_b32 v193, v17, v193
  v_xor_b32 v194, v18, v194
  v_xor_b32 v195, v19, v195
  ds_read_b64_tr_b16 v[28:29], v6 offset:27648
  ds_read_b64_tr_b16 v[30:31], v6 offset:28160
  ds_read_b64_tr_b16 v[32:33], v7 offset:27648
  ds_read_b64_tr_b16 v[34:35], v7 offset:28160
  ds_read_b64_tr_b16 v[36:37], v8 offset:6912
  ds_read_b64_tr_b16 v[38:39], v8 offset:7040
  buffer_load_dwordx4 v[240:243], v4, s[8:11], s57 offen offset:128
  s_waitcnt lgkmcnt(6)
  v_mfma_f32_32x32x16_bf16 v[64:79], v[52:55], v[184:187], v[64:79]
  v_xor_b32 v200, v20, v200
  v_xor_b32 v201, v21, v201
  v_xor_b32 v202, v22, v202
  v_xor_b32 v203, v23, v203
  v_mfma_f32_32x32x16_bf16 v[80:95], v[56:59], v[184:187], v[80:95]
  v_xor_b32_dpp v196, v16, v196 quad_perm:[1,0,3,2] row_mask:0xf bank_mask:0xf
  v_xor_b32_dpp v197, v17, v197 quad_perm:[1,0,3,2] row_mask:0xf bank_mask:0xf
  v_xor_b32_dpp v198, v18, v198 quad_perm:[1,0,3,2] row_mask:0xf bank_mask:0xf
  v_mfma_f32_32x32x16_bf16 v[96:111], v[60:63], v[184:187], v[96:111]
  v_xor_b32_dpp v199, v19, v199 quad_perm:[1,0,3,2] row_mask:0xf bank_mask:0xf
  v_xor_b32_dpp v204, v20, v204 quad_perm:[1,0,3,2] row_mask:0xf bank_mask:0xf
  v_xor_b32_dpp v205, v21, v205 quad_perm:[1,0,3,2] row_mask:0xf bank_mask:0xf
  s_barrier
  ds_read_b64_tr_b16 v[40:41], v6 offset:32768
  ds_read_b64_tr_b16 v[42:43], v6 offset:33280
  ds_read_b64_tr_b16 v[44:45], v7 offset:32768
  ds_read_b64_tr_b16 v[46:47], v7 offset:33280
  ds_read_b64_tr_b16 v[48:49], v8 offset:8192
  ds_read_b64_tr_b16 v[50:51], v8 offset:8320
  buffer_load_dwordx4 v[244:247], v4, s[8:11], s57 offen offset:1152
  buffer_load_dwordx4 v[248:251], v4, s[8:11], s58 offen offset:128
  s_waitcnt lgkmcnt(6)
  v_mfma_f32_32x32x16_bf16 v[64:79], v[28:31], v[188:191], v[64:79]
  v_xor_b32_dpp v206, v22, v206 quad_perm:[1,0,3,2] row_mask:0xf bank_mask:0xf
  v_xor_b32_dpp v207, v23, v207 quad_perm:[1,0,3,2] row_mask:0xf bank_mask:0xf
  v_permlane16_swap_b32 v192, v200
  v_permlane16_swap_b32 v193, v201
  v_mfma_f32_32x32x16_bf16 v[80:95], v[32:35], v[188:191], v[80:95]
  v_permlane16_swap_b32 v194, v202
  v_permlane16_swap_b32 v195, v203
  v_permlane16_swap_b32 v196, v204
  v_mfma_f32_32x32x16_bf16 v[96:111], v[36:39], v[188:191], v[96:111]
  v_permlane16_swap_b32 v197, v205
  v_permlane16_swap_b32 v198, v206
  v_permlane16_swap_b32 v199, v207
  ds_read_b64_tr_b16 v[52:53], v6 offset:33792
  ds_read_b64_tr_b16 v[54:55], v6 offset:34304
  ds_read_b64_tr_b16 v[56:57], v7 offset:33792
  ds_read_b64_tr_b16 v[58:59], v7 offset:34304
  ds_read_b64_tr_b16 v[60:61], v8 offset:8448
  ds_read_b64_tr_b16 v[62:63], v8 offset:8576
  buffer_load_dwordx4 v[252:255], v4, s[8:11], s58 offen offset:1152
  s_waitcnt vmcnt(13)
  s_waitcnt lgkmcnt(6)
  v_mfma_f32_32x32x16_bf16 v[64:79], v[40:43], v[192:195], v[64:79]
  v_xor_b32_dpp v16, v212, v208 quad_perm:[1,0,3,2] row_mask:0xf bank_mask:0xf
  v_xor_b32_dpp v17, v213, v209 quad_perm:[1,0,3,2] row_mask:0xf bank_mask:0xf
  v_xor_b32_dpp v18, v214, v210 quad_perm:[1,0,3,2] row_mask:0xf bank_mask:0xf
  v_xor_b32_dpp v19, v215, v211 quad_perm:[1,0,3,2] row_mask:0xf bank_mask:0xf
  v_mfma_f32_32x32x16_bf16 v[80:95], v[44:47], v[192:195], v[80:95]
  v_xor_b32_dpp v20, v220, v216 quad_perm:[1,0,3,2] row_mask:0xf bank_mask:0xf
  v_xor_b32_dpp v21, v221, v217 quad_perm:[1,0,3,2] row_mask:0xf bank_mask:0xf
  v_xor_b32_dpp v22, v222, v218 quad_perm:[1,0,3,2] row_mask:0xf bank_mask:0xf
  v_mfma_f32_32x32x16_bf16 v[96:111], v[48:51], v[192:195], v[96:111]
  v_xor_b32_dpp v23, v223, v219 quad_perm:[1,0,3,2] row_mask:0xf bank_mask:0xf
  v_and_b32 v16, v24, v16
  v_and_b32 v17, v24, v17
  ds_read_b64_tr_b16 v[28:29], v6 offset:34816
  ds_read_b64_tr_b16 v[30:31], v6 offset:35328
  ds_read_b64_tr_b16 v[32:33], v7 offset:34816
  ds_read_b64_tr_b16 v[34:35], v7 offset:35328
  ds_read_b64_tr_b16 v[36:37], v8 offset:8704
  ds_read_b64_tr_b16 v[38:39], v8 offset:8832
  s_waitcnt lgkmcnt(6)
  v_mfma_f32_32x32x16_bf16 v[64:79], v[52:55], v[196:199], v[64:79]
  v_and_b32 v18, v24, v18
  v_and_b32 v19, v24, v19
  v_and_b32 v20, v24, v20
  v_and_b32 v21, v24, v21
  v_mfma_f32_32x32x16_bf16 v[80:95], v[56:59], v[196:199], v[80:95]
  v_and_b32 v22, v24, v22
  v_and_b32 v23, v24, v23
  v_xor_b32 v208, v16, v208
  v_mfma_f32_32x32x16_bf16 v[96:111], v[60:63], v[196:199], v[96:111]
  v_xor_b32 v209, v17, v209
  v_xor_b32 v210, v18, v210
  v_xor_b32 v211, v19, v211
  ds_read_b64_tr_b16 v[40:41], v6 offset:35840
  ds_read_b64_tr_b16 v[42:43], v6 offset:36352
  ds_read_b64_tr_b16 v[44:45], v7 offset:35840
  ds_read_b64_tr_b16 v[46:47], v7 offset:36352
  ds_read_b64_tr_b16 v[48:49], v8 offset:8960
  ds_read_b64_tr_b16 v[50:51], v8 offset:9088
  s_waitcnt lgkmcnt(6)
  v_mfma_f32_32x32x16_bf16 v[64:79], v[28:31], v[200:203], v[64:79]
  v_xor_b32 v216, v20, v216
  v_xor_b32 v217, v21, v217
  v_xor_b32 v218, v22, v218
  v_xor_b32 v219, v23, v219
  v_mfma_f32_32x32x16_bf16 v[80:95], v[32:35], v[200:203], v[80:95]
  v_xor_b32_dpp v212, v16, v212 quad_perm:[1,0,3,2] row_mask:0xf bank_mask:0xf
  v_xor_b32_dpp v213, v17, v213 quad_perm:[1,0,3,2] row_mask:0xf bank_mask:0xf
  v_xor_b32_dpp v214, v18, v214 quad_perm:[1,0,3,2] row_mask:0xf bank_mask:0xf
  v_mfma_f32_32x32x16_bf16 v[96:111], v[36:39], v[200:203], v[96:111]
  v_xor_b32_dpp v215, v19, v215 quad_perm:[1,0,3,2] row_mask:0xf bank_mask:0xf
  v_xor_b32_dpp v220, v20, v220 quad_perm:[1,0,3,2] row_mask:0xf bank_mask:0xf
  v_xor_b32_dpp v221, v21, v221 quad_perm:[1,0,3,2] row_mask:0xf bank_mask:0xf
  ds_read_b64_tr_b16 v[52:53], v6 offset:40960
  ds_read_b64_tr_b16 v[54:55], v6 offset:41472
  ds_read_b64_tr_b16 v[56:57], v7 offset:40960
  ds_read_b64_tr_b16 v[58:59], v7 offset:41472
  ds_read_b64_tr_b16 v[60:61], v8 offset:10240
  ds_read_b64_tr_b16 v[62:63], v8 offset:10368
  s_waitcnt lgkmcnt(6)
  v_mfma_f32_32x32x16_bf16 v[64:79], v[40:43], v[204:207], v[64:79]
  v_xor_b32_dpp v222, v22, v222 quad_perm:[1,0,3,2] row_mask:0xf bank_mask:0xf
  v_xor_b32_dpp v223, v23, v223 quad_perm:[1,0,3,2] row_mask:0xf bank_mask:0xf
  v_permlane16_swap_b32 v208, v216
  v_permlane16_swap_b32 v209, v217
  v_mfma_f32_32x32x16_bf16 v[80:95], v[44:47], v[204:207], v[80:95]
  v_permlane16_swap_b32 v210, v218
  v_permlane16_swap_b32 v211, v219
  v_permlane16_swap_b32 v212, v220
  v_mfma_f32_32x32x16_bf16 v[96:111], v[48:51], v[204:207], v[96:111]
  v_permlane16_swap_b32 v213, v221
  v_permlane16_swap_b32 v214, v222
  v_permlane16_swap_b32 v215, v223
  ds_read_b64_tr_b16 v[28:29], v6 offset:41984
  ds_read_b64_tr_b16 v[30:31], v6 offset:42496
  ds_read_b64_tr_b16 v[32:33], v7 offset:41984
  ds_read_b64_tr_b16 v[34:35], v7 offset:42496
  ds_read_b64_tr_b16 v[36:37], v8 offset:10496
  ds_read_b64_tr_b16 v[38:39], v8 offset:10624
  s_waitcnt vmcnt(4)
  s_waitcnt lgkmcnt(6)
  v_mfma_f32_32x32x16_bf16 v[64:79], v[52:55], v[208:211], v[64:79]
  v_xor_b32_dpp v16, v228, v224 quad_perm:[1,0,3,2] row_mask:0xf bank_mask:0xf
  v_xor_b32_dpp v17, v229, v225 quad_perm:[1,0,3,2] row_mask:0xf bank_mask:0xf
  v_xor_b32_dpp v18, v230, v226 quad_perm:[1,0,3,2] row_mask:0xf bank_mask:0xf
  v_xor_b32_dpp v19, v231, v227 quad_perm:[1,0,3,2] row_mask:0xf bank_mask:0xf
  v_mfma_f32_32x32x16_bf16 v[80:95], v[56:59], v[208:211], v[80:95]
  v_xor_b32_dpp v20, v236, v232 quad_perm:[1,0,3,2] row_mask:0xf bank_mask:0xf
  v_xor_b32_dpp v21, v237, v233 quad_perm:[1,0,3,2] row_mask:0xf bank_mask:0xf
  v_xor_b32_dpp v22, v238, v234 quad_perm:[1,0,3,2] row_mask:0xf bank_mask:0xf
  v_mfma_f32_32x32x16_bf16 v[96:111], v[60:63], v[208:211], v[96:111]
  v_xor_b32_dpp v23, v239, v235 quad_perm:[1,0,3,2] row_mask:0xf bank_mask:0xf
  v_and_b32 v16, v24, v16
  v_and_b32 v17, v24, v17
  ds_read_b64_tr_b16 v[40:41], v6 offset:43008
  ds_read_b64_tr_b16 v[42:43], v6 offset:43520
  ds_read_b64_tr_b16 v[44:45], v7 offset:43008
  ds_read_b64_tr_b16 v[46:47], v7 offset:43520
  ds_read_b64_tr_b16 v[48:49], v8 offset:10752
  ds_read_b64_tr_b16 v[50:51], v8 offset:10880
  s_waitcnt lgkmcnt(6)
  v_mfma_f32_32x32x16_bf16 v[64:79], v[28:31], v[212:215], v[64:79]
  v_and_b32 v18, v24, v18
  v_and_b32 v19, v24, v19
  v_and_b32 v20, v24, v20
  v_and_b32 v21, v24, v21
  v_mfma_f32_32x32x16_bf16 v[80:95], v[32:35], v[212:215], v[80:95]
  v_and_b32 v22, v24, v22
  v_and_b32 v23, v24, v23
  v_xor_b32 v224, v16, v224
  v_mfma_f32_32x32x16_bf16 v[96:111], v[36:39], v[212:215], v[96:111]
  v_xor_b32 v225, v17, v225
  v_xor_b32 v226, v18, v226
  v_xor_b32 v227, v19, v227
  ds_read_b64_tr_b16 v[52:53], v6 offset:44032
  ds_read_b64_tr_b16 v[54:55], v6 offset:44544
  ds_read_b64_tr_b16 v[56:57], v7 offset:44032
  ds_read_b64_tr_b16 v[58:59], v7 offset:44544
  ds_read_b64_tr_b16 v[60:61], v8 offset:11008
  ds_read_b64_tr_b16 v[62:63], v8 offset:11136
  s_waitcnt lgkmcnt(6)
  v_mfma_f32_32x32x16_bf16 v[64:79], v[40:43], v[216:219], v[64:79]
  v_xor_b32 v232, v20, v232
  v_xor_b32 v233, v21, v233
  v_xor_b32 v234, v22, v234
  v_xor_b32 v235, v23, v235
  v_mfma_f32_32x32x16_bf16 v[80:95], v[44:47], v[216:219], v[80:95]
  v_xor_b32_dpp v228, v16, v228 quad_perm:[1,0,3,2] row_mask:0xf bank_mask:0xf
  v_xor_b32_dpp v229, v17, v229 quad_perm:[1,0,3,2] row_mask:0xf bank_mask:0xf
  v_xor_b32_dpp v230, v18, v230 quad_perm:[1,0,3,2] row_mask:0xf bank_mask:0xf
  v_mfma_f32_32x32x16_bf16 v[96:111], v[48:51], v[216:219], v[96:111]
  v_xor_b32_dpp v231, v19, v231 quad_perm:[1,0,3,2] row_mask:0xf bank_mask:0xf
  v_xor_b32_dpp v236, v20, v236 quad_perm:[1,0,3,2] row_mask:0xf bank_mask:0xf
  v_xor_b32_dpp v237, v21, v237 quad_perm:[1,0,3,2] row_mask:0xf bank_mask:0xf
  s_barrier
  ds_read_b64_tr_b16 v[28:29], v6 offset:49152
  ds_read_b64_tr_b16 v[30:31], v6 offset:49664
  ds_read_b64_tr_b16 v[32:33], v7 offset:49152
  ds_read_b64_tr_b16 v[34:35], v7 offset:49664
  ds_read_b64_tr_b16 v[36:37], v8 offset:12288
  ds_read_b64_tr_b16 v[38:39], v8 offset:12416
  s_waitcnt lgkmcnt(6)
  v_mfma_f32_32x32x16_bf16 v[64:79], v[52:55], v[220:223], v[64:79]
  v_xor_b32_dpp v238, v22, v238 quad_perm:[1,0,3,2] row_mask:0xf bank_mask:0xf
  v_xor_b32_dpp v239, v23, v239 quad_perm:[1,0,3,2] row_mask:0xf bank_mask:0xf
  v_permlane16_swap_b32 v224, v232
  v_permlane16_swap_b32 v225, v233
  v_mfma_f32_32x32x16_bf16 v[80:95], v[56:59], v[220:223], v[80:95]
  v_permlane16_swap_b32 v226, v234
  v_permlane16_swap_b32 v227, v235
  v_permlane16_swap_b32 v228, v236
  v_mfma_f32_32x32x16_bf16 v[96:111], v[60:63], v[220:223], v[96:111]
  v_permlane16_swap_b32 v229, v237
  v_permlane16_swap_b32 v230, v238
  v_permlane16_swap_b32 v231, v239
  ds_read_b64_tr_b16 v[40:41], v6 offset:50176
  ds_read_b64_tr_b16 v[42:43], v6 offset:50688
  ds_read_b64_tr_b16 v[44:45], v7 offset:50176
  ds_read_b64_tr_b16 v[46:47], v7 offset:50688
  ds_read_b64_tr_b16 v[48:49], v8 offset:12544
  ds_read_b64_tr_b16 v[50:51], v8 offset:12672
  s_waitcnt vmcnt(0)
  s_waitcnt lgkmcnt(6)
  v_mfma_f32_32x32x16_bf16 v[64:79], v[28:31], v[224:227], v[64:79]
  v_xor_b32_dpp v16, v244, v240 quad_perm:[1,0,3,2] row_mask:0xf bank_mask:0xf
  v_xor_b32_dpp v17, v245, v241 quad_perm:[1,0,3,2] row_mask:0xf bank_mask:0xf
  v_xor_b32_dpp v18, v246, v242 quad_perm:[1,0,3,2] row_mask:0xf bank_mask:0xf
  v_xor_b32_dpp v19, v247, v243 quad_perm:[1,0,3,2] row_mask:0xf bank_mask:0xf
  v_mfma_f32_32x32x16_bf16 v[80:95], v[32:35], v[224:227], v[80:95]
  v_xor_b32_dpp v20, v252, v248 quad_perm:[1,0,3,2] row_mask:0xf bank_mask:0xf
  v_xor_b32_dpp v21, v253, v249 quad_perm:[1,0,3,2] row_mask:0xf bank_mask:0xf
  v_xor_b32_dpp v22, v254, v250 quad_perm:[1,0,3,2] row_mask:0xf bank_mask:0xf
  v_mfma_f32_32x32x16_bf16 v[96:111], v[36:39], v[224:227], v[96:111]
  v_xor_b32_dpp v23, v255, v251 quad_perm:[1,0,3,2] row_mask:0xf bank_mask:0xf
  v_and_b32 v16, v24, v16
  v_and_b32 v17, v24, v17
  ds_read_b64_tr_b16 v[52:53], v6 offset:51200
  ds_read_b64_tr_b16 v[54:55], v6 offset:51712
  ds_read_b64_tr_b16 v[56:57], v7 offset:51200
  ds_read_b64_tr_b16 v[58:59], v7 offset:51712
  ds_read_b64_tr_b16 v[60:61], v8 offset:12800
  ds_read_b64_tr_b16 v[62:63], v8 offset:12928
  s_waitcnt lgkmcnt(6)
  v_mfma_f32_32x32x16_bf16 v[64:79], v[40:43], v[228:231], v[64:79]
  v_and_b32 v18, v24, v18
  v_and_b32 v19, v24, v19
  v_and_b32 v20, v24, v20
  v_and_b32 v21, v24, v21
  v_mfma_f32_32x32x16_bf16 v[80:95], v[44:47], v[228:231], v[80:95]
  v_and_b32 v22, v24, v22
  v_and_b32 v23, v24, v23
  v_xor_b32 v240, v16, v240
  v_mfma_f32_32x32x16_bf16 v[96:111], v[48:51], v[228:231], v[96:111]
  v_xor_b32 v241, v17, v241
  v_xor_b32 v242, v18, v242
  v_xor_b32 v243, v19, v243
  ds_read_b64_tr_b16 v[28:29], v6 offset:52224
  ds_read_b64_tr_b16 v[30:31], v6 offset:52736
  ds_read_b64_tr_b16 v[32:33], v7 offset:52224
  ds_read_b64_tr_b16 v[34:35], v7 offset:52736
  ds_read_b64_tr_b16 v[36:37], v8 offset:13056
  ds_read_b64_tr_b16 v[38:39], v8 offset:13184
  s_waitcnt lgkmcnt(6)
  v_mfma_f32_32x32x16_bf16 v[64:79], v[52:55], v[232:235], v[64:79]
  v_xor_b32 v248, v20, v248
  v_xor_b32 v249, v21, v249
  v_xor_b32 v250, v22, v250
  v_xor_b32 v251, v23, v251
  v_mfma_f32_32x32x16_bf16 v[80:95], v[56:59], v[232:235], v[80:95]
  v_xor_b32_dpp v244, v16, v244 quad_perm:[1,0,3,2] row_mask:0xf bank_mask:0xf
  v_xor_b32_dpp v245, v17, v245 quad_perm:[1,0,3,2] row_mask:0xf bank_mask:0xf
  v_xor_b32_dpp v246, v18, v246 quad_perm:[1,0,3,2] row_mask:0xf bank_mask:0xf
  v_mfma_f32_32x32x16_bf16 v[96:111], v[60:63], v[232:235], v[96:111]
  v_xor_b32_dpp v247, v19, v247 quad_perm:[1,0,3,2] row_mask:0xf bank_mask:0xf
  v_xor_b32_dpp v252, v20, v252 quad_perm:[1,0,3,2] row_mask:0xf bank_mask:0xf
  v_xor_b32_dpp v253, v21, v253 quad_perm:[1,0,3,2] row_mask:0xf bank_mask:0xf
  ds_read_b64_tr_b16 v[40:41], v6 offset:57344
  ds_read_b64_tr_b16 v[42:43], v6 offset:57856
  ds_read_b64_tr_b16 v[44:45], v7 offset:57344
  ds_read_b64_tr_b16 v[46:47], v7 offset:57856
  ds_read_b64_tr_b16 v[48:49], v8 offset:14336
  ds_read_b64_tr_b16 v[50:51], v8 offset:14464
  s_waitcnt lgkmcnt(6)
  v_mfma_f32_32x32x16_bf16 v[64:79], v[28:31], v[236:239], v[64:79]
  v_xor_b32_dpp v254, v22, v254 quad_perm:[1,0,3,2] row_mask:0xf bank_mask:0xf
  v_xor_b32_dpp v255, v23, v255 quad_perm:[1,0,3,2] row_mask:0xf bank_mask:0xf
  v_permlane16_swap_b32 v240, v248
  v_permlane16_swap_b32 v241, v249
  v_mfma_f32_32x32x16_bf16 v[80:95], v[32:35], v[236:239], v[80:95]
  v_permlane16_swap_b32 v242, v250
  v_permlane16_swap_b32 v243, v251
  v_permlane16_swap_b32 v244, v252
  v_mfma_f32_32x32x16_bf16 v[96:111], v[36:39], v[236:239], v[96:111]
  v_permlane16_swap_b32 v245, v253
  v_permlane16_swap_b32 v246, v254
  v_permlane16_swap_b32 v247, v255
  ds_read_b64_tr_b16 v[52:53], v6 offset:58368
  ds_read_b64_tr_b16 v[54:55], v6 offset:58880
  ds_read_b64_tr_b16 v[56:57], v7 offset:58368
  ds_read_b64_tr_b16 v[58:59], v7 offset:58880
  ds_read_b64_tr_b16 v[60:61], v8 offset:14592
  ds_read_b64_tr_b16 v[62:63], v8 offset:14720
  s_waitcnt lgkmcnt(6)
  v_mfma_f32_32x32x16_bf16 v[64:79], v[40:43], v[240:243], v[64:79]
  v_mfma_f32_32x32x16_bf16 v[80:95], v[44:47], v[240:243], v[80:95]
  v_mfma_f32_32x32x16_bf16 v[96:111], v[48:51], v[240:243], v[96:111]
  ds_read_b64_tr_b16 v[28:29], v6 offset:59392
  ds_read_b64_tr_b16 v[30:31], v6 offset:59904
  ds_read_b64_tr_b16 v[32:33], v7 offset:59392
  ds_read_b64_tr_b16 v[34:35], v7 offset:59904
  ds_read_b64_tr_b16 v[36:37], v8 offset:14848
  ds_read_b64_tr_b16 v[38:39], v8 offset:14976
  s_waitcnt lgkmcnt(6)
  v_mfma_f32_32x32x16_bf16 v[64:79], v[52:55], v[244:247], v[64:79]
  v_mfma_f32_32x32x16_bf16 v[80:95], v[56:59], v[244:247], v[80:95]
  v_mfma_f32_32x32x16_bf16 v[96:111], v[60:63], v[244:247], v[96:111]
  ds_read_b64_tr_b16 v[40:41], v6 offset:60416
  ds_read_b64_tr_b16 v[42:43], v6 offset:60928
  ds_read_b64_tr_b16 v[44:45], v7 offset:60416
  ds_read_b64_tr_b16 v[46:47], v7 offset:60928
  ds_read_b64_tr_b16 v[48:49], v8 offset:15104
  ds_read_b64_tr_b16 v[50:51], v8 offset:15232
  s_waitcnt lgkmcnt(6)
  v_mfma_f32_32x32x16_bf16 v[64:79], v[28:31], v[248:251], v[64:79]
  v_mfma_f32_32x32x16_bf16 v[80:95], v[32:35], v[248:251], v[80:95]
  v_mfma_f32_32x32x16_bf16 v[96:111], v[36:39], v[248:251], v[96:111]
  s_waitcnt lgkmcnt(0)
  v_mfma_f32_32x32x16_bf16 v[64:79], v[40:43], v[252:255], v[64:79]
  v_mfma_f32_32x32x16_bf16 v[80:95], v[44:47], v[252:255], v[80:95]
  v_mfma_f32_32x32x16_bf16 v[96:111], v[48:51], v[252:255], v[96:111]
  s_nop 7
  s_nop 7
  v_cvt_pk_bf16_f32 v16, v96, v97
  v_cvt_pk_bf16_f32 v17, v98, v99
  v_cvt_pk_bf16_f32 v18, v100, v101
  v_cvt_pk_bf16_f32 v19, v102, v103
  v_lshlrev_b32 v10, 4, v1
  s_lshl_b32 s46, s6, 10
  buffer_store_dwordx4 v[16:19], v10, s[24:27], s46 offen
  s_branch K1A_epi
K1A_v:
  s_waitcnt vmcnt(21)
  s_barrier
  ds_read_b64_tr_b16 v[28:29], v6 offset:0
  ds_read_b64_tr_b16 v[30:31], v6 offset:512
  ds_read_b64_tr_b16 v[32:33], v7 offset:0
  ds_read_b64_tr_b16 v[34:35], v7 offset:512
  ds_read_b64_tr_b16 v[36:37], v8 offset:0
  ds_read_b64_tr_b16 v[38:39], v8 offset:128
  ds_read_b64_tr_b16 v[40:41], v6 offset:1024
  ds_read_b64_tr_b16 v[42:43], v6 offset:1536
  ds_read_b64_tr_b16 v[44:45], v7 offset:1024
  ds_read_b64_tr_b16 v[46:47], v7 offset:1536
  ds_read_b64_tr_b16 v[48:49], v8 offset:256
  ds_read_b64_tr_b16 v[50:51], v8 offset:384
  s_waitcnt vmcnt(17)
  v_xor_b32_dpp v16, v132, v128 quad_perm:[1,0,3,2] row_mask:0xf bank_mask:0xf
  v_xor_b32_dpp v17, v133, v129 quad_perm:[1,0,3,2] row_mask:0xf bank_mask:0xf
  v_xor_b32_dpp v18, v134, v130 quad_perm:[1,0,3,2] row_mask:0xf bank_mask:0xf
  v_xor_b32_dpp v19, v135, v131 quad_perm:[1,0,3,2] row_mask:0xf bank_mask:0xf
  v_xor_b32_dpp v20, v140, v136 quad_perm:[1,0,3,2] row_mask:0xf bank_mask:0xf
  v_xor_b32_dpp v21, v141, v137 quad_perm:[1,0,3,2] row_mask:0xf bank_mask:0xf
  v_xor_b32_dpp v22, v142, v138 quad_perm:[1,0,3,2] row_mask:0xf bank_mask:0xf
  v_xor_b32_dpp v23, v143, v139 quad_perm:[1,0,3,2] row_mask:0xf bank_mask:0xf
  v_and_b32 v16, v24, v16
  v_and_b32 v17, v24, v17
  v_and_b32 v18, v24, v18
  v_and_b32 v19, v24, v19
  v_and_b32 v20, v24, v20
  v_and_b32 v21, v24, v21
  v_and_b32 v22, v24, v22
  v_and_b32 v23, v24, v23
  v_xor_b32 v128, v16, v128
  v_xor_b32 v129, v17, v129
  v_xor_b32 v130, v18, v130
  v_xor_b32 v131, v19, v131
  v_xor_b32 v136, v20, v136
  v_xor_b32 v137, v21, v137
  v_xor_b32 v138, v22, v138
  v_xor_b32 v139, v23, v139
  v_xor_b32_dpp v132, v16, v132 quad_perm:[1,0,3,2] row_mask:0xf bank_mask:0xf
  v_xor_b32_dpp v133, v17, v133 quad_perm:[1,0,3,2] row_mask:0xf bank_mask:0xf
  v_xor_b32_dpp v134, v18, v134 quad_perm:[1,0,3,2] row_mask:0xf bank_mask:0xf
  v_xor_b32_dpp v135, v19, v135 quad_perm:[1,0,3,2] row_mask:0xf bank_mask:0xf
  v_xor_b32_dpp v140, v20, v140 quad_perm:[1,0,3,2] row_mask:0xf bank_mask:0xf
  v_xor_b32_dpp v141, v21, v141 quad_perm:[1,0,3,2] row_mask:0xf bank_mask:0xf
  v_xor_b32_dpp v142, v22, v142 quad_perm:[1,0,3,2] row_mask:0xf bank_mask:0xf
  v_xor_b32_dpp v143, v23, v143 quad_perm:[1,0,3,2] row_mask:0xf bank_mask:0xf
  v_permlane16_swap_b32 v128, v136
  v_permlane16_swap_b32 v129, v137
  v_permlane16_swap_b32 v130, v138
  v_permlane16_swap_b32 v131, v139
  v_permlane16_swap_b32 v132, v140
  v_permlane16_swap_b32 v133, v141
  v_permlane16_swap_b32 v134, v142
  v_permlane16_swap_b32 v135, v143
  s_waitcnt vmcnt(13)
  s_waitcnt lgkmcnt(6)
  v_mfma_f32_32x32x16_bf16 v[64:79], v[28:31], v[128:131], 0
  v_xor_b32_dpp v16, v148, v144 quad_perm:[1,0,3,2] row_mask:0xf bank_mask:0xf
  v_xor_b32_dpp v17, v149, v145 quad_perm:[1,0,3,2] row_mask:0xf bank_mask:0xf
  v_xor_b32_dpp v18, v150, v146 quad_perm:[1,0,3,2] row_mask:0xf bank_mask:0xf
  v_xor_b32_dpp v19, v151, v147 quad_perm:[1,0,3,2] row_mask:0xf bank_mask:0xf
  v_mfma_f32_32x32x16_bf16 v[80:95], v[32:35], v[128:131], 0
  v_xor_b32_dpp v20, v156, v152 quad_perm:[1,0,3,2] row_mask:0xf bank_mask:0xf
  v_xor_b32_dpp v21, v157, v153 quad_perm:[1,0,3,2] row_mask:0xf bank_mask:0xf
  v_xor_b32_dpp v22, v158, v154 quad_perm:[1,0,3,2] row_mask:0xf bank_mask:0xf
  v_mfma_f32_32x32x16_bf16 v[96:111], v[128:131], v[36:39], 0
  v_xor_b32_dpp v23, v159, v155 quad_perm:[1,0,3,2] row_mask:0xf bank_mask:0xf
  v_and_b32 v16, v24, v16
  v_and_b32 v17, v24, v17
  ds_read_b64_tr_b16 v[52:53], v6 offset:2048
  ds_read_b64_tr_b16 v[54:55], v6 offset:2560
  ds_read_b64_tr_b16 v[56:57], v7 offset:2048
  ds_read_b64_tr_b16 v[58:59], v7 offset:2560
  ds_read_b64_tr_b16 v[60:61], v8 offset:512
  ds_read_b64_tr_b16 v[62:63], v8 offset:640
  s_add_u32 s55, s53, 2
  s_and_b32 s55, s55, 3
  s_mul_i32 s41, s55, 131072
  s_add_u32 s41, s41, s54
  s_lshl_b32 s57, s55, 8
  s_add_u32 s57, s57, s44
  s_lshl_b32 s42, s55, 12
  s_add_u32 s42, s42, s56
  s_mov_b32 m0, s40
  s_add_u32 s40, s40, 1024
  buffer_load_dwordx4 v5, s[12:15], s41 offen lds
  s_add_u32 s41, s41, 8192
  s_mov_b32 m0, s40
  s_add_u32 s40, s40, 1024
  buffer_load_dwordx4 v5, s[12:15], s41 offen lds
  s_add_u32 s41, s41, 8192
  s_waitcnt lgkmcnt(6)
  v_mfma_f32_32x32x16_bf16 v[64:79], v[40:43], v[132:135], v[64:79]
  v_and_b32 v18, v24, v18
  v_and_b32 v19, v24, v19
  v_and_b32 v20, v24, v20
  v_and_b32 v21, v24, v21
  v_mfma_f32_32x32x16_bf16 v[80:95], v[44:47], v[132:135], v[80:95]
  v_and_b32 v22, v24, v22
  v_and_b32 v23, v24, v23
  v_xor_b32 v144, v16, v144
  v_mfma_f32_32x32x16_bf16 v[96:111], v[132:135], v[48:51], v[96:111]
  v_xor_b32 v145, v17, v145
  v_xor_b32 v146, v18, v146
  v_xor_b32 v147, v19, v147
  ds_read_b64_tr_b16 v[28:29], v6 offset:3072
  ds_read_b64_tr_b16 v[30:31], v6 offset:3584
  ds_read_b64_tr_b16 v[32:33], v7 offset:3072
  ds_read_b64_tr_b16 v[34:35], v7 offset:3584
  ds_read_b64_tr_b16 v[36:37], v8 offset:768
  ds_read_b64_tr_b16 v[38:39], v8 offset:896
  s_mov_b32 m0, s40
  s_add_u32 s40, s40, 1024
  buffer_load_dwordx4 v5, s[12:15], s41 offen lds
  s_add_u32 s41, s41, 8192
  s_mov_b32 m0, s40
  s_add_u32 s40, s40, 13312
  buffer_load_dwordx4 v5, s[12:15], s41 offen lds
  s_waitcnt lgkmcnt(6)
  v_mfma_f32_32x32x16_bf16 v[64:79], v[52:55], v[136:139], v[64:79]
  v_xor_b32 v152, v20, v152
  v_xor_b32 v153, v21, v153
  v_xor_b32 v154, v22, v154
  v_xor_b32 v155, v23, v155
  v_mfma_f32_32x32x16_bf16 v[80:95], v[56:59], v[136:139], v[80:95]
  v_xor_b32_dpp v148, v16, v148 quad_perm:[1,0,3,2] row_mask:0xf bank_mask:0xf
  v_xor_b32_dpp v149, v17, v149 quad_perm:[1,0,3,2] row_mask:0xf bank_mask:0xf
  v_xor_b32_dpp v150, v18, v150 quad_perm:[1,0,3,2] row_mask:0xf bank_mask:0xf
  v_mfma_f32_32x32x16_bf16 v[96:111], v[136:139], v[60:63], v[96:111]
  v_xor_b32_dpp v151, v19, v151 quad_perm:[1,0,3,2] row_mask:0xf bank_mask:0xf
  v_xor_b32_dpp v156, v20, v156 quad_perm:[1,0,3,2] row_mask:0xf bank_mask:0xf
  v_xor_b32_dpp v157, v21, v157 quad_perm:[1,0,3,2] row_mask:0xf bank_mask:0xf
  ds_read_b64_tr_b16 v[40:41], v6 offset:8192
  ds_read_b64_tr_b16 v[42:43], v6 offset:8704
  ds_read_b64_tr_b16 v[44:45], v7 offset:8192
  ds_read_b64_tr_b16 v[46:47], v7 offset:8704
  ds_read_b64_tr_b16 v[48:49], v8 offset:2048
  ds_read_b64_tr_b16 v[50:51], v8 offset:2176
  s_mov_b32 m0, s43
  s_add_u32 s43, s43, 4096
  buffer_load_dwordx4 v13, s[20:23], s42 offen lds
  s_waitcnt lgkmcnt(6)
  v_mfma_f32_32x32x16_bf16 v[64:79], v[28:31], v[140:143], v[64:79]
  v_xor_b32_dpp v158, v22, v158 quad_perm:[1,0,3,2] row_mask:0xf bank_mask:0xf
  v_xor_b32_dpp v159, v23, v159 quad_perm:[1,0,3,2] row_mask:0xf bank_mask:0xf
  v_permlane16_swap_b32 v144, v152
  v_permlane16_swap_b32 v145, v153
  v_mfma_f32_32x32x16_bf16 v[80:95], v[32:35], v[140:143], v[80:95]
  v_permlane16_swap_b32 v146, v154
  v_permlane16_swap_b32 v147, v155
  v_permlane16_swap_b32 v148, v156
  v_mfma_f32_32x32x16_bf16 v[96:111], v[140:143], v[36:39], v[96:111]
  v_permlane16_swap_b32 v149, v157
  v_permlane16_swap_b32 v150, v158
  v_permlane16_swap_b32 v151, v159
  ds_read_b64_tr_b16 v[52:53], v6 offset:9216
  ds_read_b64_tr_b16 v[54:55], v6 offset:9728
  ds_read_b64_tr_b16 v[56:57], v7 offset:9216
  ds_read_b64_tr_b16 v[58:59], v7 offset:9728
  ds_read_b64_tr_b16 v[60:61], v8 offset:2304
  ds_read_b64_tr_b16 v[62:63], v8 offset:2432
  buffer_load_dwordx4 v[192:195], v4, s[8:11], s57 offen offset:0
  buffer_load_dwordx4 v[196:199], v4, s[8:11], s57 offen offset:1024
  s_waitcnt vmcnt(11)
  s_waitcnt lgkmcnt(6)
  v_mfma_f32_32x32x16_bf16 v[64:79], v[40:43], v[144:147], v[64:79]
  v_xor_b32_dpp v16, v164, v160 quad_perm:[1,0,3,2] row_mask:0xf bank_mask:0xf
  v_xor_b32_dpp v17, v165, v161 quad_perm:[1,0,3,2] row_mask:0xf bank_mask:0xf
  v_xor_b32_dpp v18, v166, v162 quad_perm:[1,0,3,2] row_mask:0xf bank_mask:0xf
  v_xor_b32_dpp v19, v167, v163 quad_perm:[1,0,3,2] row_mask:0xf bank_mask:0xf
  v_mfma_f32_32x32x16_bf16 v[80:95], v[44:47], v[144:147], v[80:95]
  v_xor_b32_dpp v20, v172, v168 quad_perm:[1,0,3,2] row_mask:0xf bank_mask:0xf
  v_xor_b32_dpp v21, v173, v169 quad_perm:[1,0,3,2] row_mask:0xf bank_mask:0xf
  v_xor_b32_dpp v22, v174, v170 quad_perm:[1,0,3,2] row_mask:0xf bank_mask:0xf
  v_mfma_f32_32x32x16_bf16 v[96:111], v[144:147], v[48:51], v[96:111]
  v_xor_b32_dpp v23, v175, v171 quad_perm:[1,0,3,2] row_mask:0xf bank_mask:0xf
  v_and_b32 v16, v24, v16
  v_and_b32 v17, v24, v17
  ds_read_b64_tr_b16 v[28:29], v6 offset:10240
  ds_read_b64_tr_b16 v[30:31], v6 offset:10752
  ds_read_b64_tr_b16 v[32:33], v7 offset:10240
  ds_read_b64_tr_b16 v[34:35], v7 offset:10752
  ds_read_b64_tr_b16 v[36:37], v8 offset:2560
  ds_read_b64_tr_b16 v[38:39], v8 offset:2688
  s_add_u32 s58, s57, 16384
  buffer_load_dwordx4 v[200:203], v4, s[8:11], s58 offen offset:0
  buffer_load_dwordx4 v[204:207], v4, s[8:11], s58 offen offset:1024
  s_waitcnt lgkmcnt(6)
  v_mfma_f32_32x32x16_bf16 v[64:79], v[52:55], v[148:151], v[64:79]
  v_and_b32 v18, v24, v18
  v_and_b32 v19, v24, v19
  v_and_b32 v20, v24, v20
  v_and_b32 v21, v24, v21
  v_mfma_f32_32x32x16_bf16 v[80:95], v[56:59], v[148:151], v[80:95]
  v_and_b32 v22, v24, v22
  v_and_b32 v23, v24, v23
  v_xor_b32 v160, v16, v160
  v_mfma_f32_32x32x16_bf16 v[96:111], v[148:151], v[60:63], v[96:111]
  v_xor_b32 v161, v17, v161
  v_xor_b32 v162, v18, v162
  v_xor_b32 v163, v19, v163
  ds_read_b64_tr_b16 v[40:41], v6 offset:11264
  ds_read_b64_tr_b16 v[42:43], v6 offset:11776
  ds_read_b64_tr_b16 v[44:45], v7 offset:11264
  ds_read_b64_tr_b16 v[46:47], v7 offset:11776
  ds_read_b64_tr_b16 v[48:49], v8 offset:2816
  ds_read_b64_tr_b16 v[50:51], v8 offset:2944
  buffer_load_dwordx4 v[208:211], v4, s[8:11], s57 offen offset:128
  s_waitcnt lgkmcnt(6)
  v_mfma_f32_32x32x16_bf16 v[64:79], v[28:31], v[152:155], v[64:79]
  v_xor_b32 v168, v20, v168
  v_xor_b32 v169, v21, v169
  v_xor_b32 v170, v22, v170
  v_xor_b32 v171, v23, v171
  v_mfma_f32_32x32x16_bf16 v[80:95], v[32:35], v[152:155], v[80:95]
  v_xor_b32_dpp v164, v16, v164 quad_perm:[1,0,3,2] row_mask:0xf bank_mask:0xf
  v_xor_b32_dpp v165, v17, v165 quad_perm:[1,0,3,2] row_mask:0xf bank_mask:0xf
  v_xor_b32_dpp v166, v18, v166 quad_perm:[1,0,3,2] row_mask:0xf bank_mask:0xf
  v_mfma_f32_32x32x16_bf16 v[96:111], v[152:155], v[36:39], v[96:111]
  v_xor_b32_dpp v167, v19, v167 quad_perm:[1,0,3,2] row_mask:0xf bank_mask:0xf
  v_xor_b32_dpp v172, v20, v172 quad_perm:[1,0,3,2] row_mask:0xf bank_mask:0xf
  v_xor_b32_dpp v173, v21, v173 quad_perm:[1,0,3,2] row_mask:0xf bank_mask:0xf
  s_barrier
  ds_read_b64_tr_b16 v[52:53], v6 offset:16384
  ds_read_b64_tr_b16 v[54:55], v6 offset:16896
  ds_read_b64_tr_b16 v[56:57], v7 offset:16384
  ds_read_b64_tr_b16 v[58:59], v7 offset:16896
  ds_read_b64_tr_b16 v[60:61], v8 offset:4096
  ds_read_b64_tr_b16 v[62:63], v8 offset:4224
  buffer_load_dwordx4 v[212:215], v4, s[8:11], s57 offen offset:1152
  buffer_load_dwordx4 v[216:219], v4, s[8:11], s58 offen offset:128
  s_waitcnt lgkmcnt(6)
  v_mfma_f32_32x32x16_bf16 v[64:79], v[40:43], v[156:159], v[64:79]
  v_xor_b32_dpp v174, v22, v174 quad_perm:[1,0,3,2] row_mask:0xf bank_mask:0xf
  v_xor_b32_dpp v175, v23, v175 quad_perm:[1,0,3,2] row_mask:0xf bank_mask:0xf
  v_permlane16_swap_b32 v160, v168
  v_permlane16_swap_b32 v161, v169
  v_mfma_f32_32x32x16_bf16 v[80:95], v[44:47], v[156:159], v[80:95]
  v_permlane16_swap_b32 v162, v170
  v_permlane16_swap_b32 v163, v171
  v_permlane16_swap_b32 v164, v172
  v_mfma_f32_32x32x16_bf16 v[96:111], v[156:159], v[48:51], v[96:111]
  v_permlane16_swap_b32 v165, v173
  v_permlane16_swap_b32 v166, v174
  v_permlane16_swap_b32 v167, v175
  ds_read_b64_tr_b16 v[28:29], v6 offset:17408
  ds_read_b64_tr_b16 v[30:31], v6 offset:17920
  ds_read_b64_tr_b16 v[32:33], v7 offset:17408
  ds_read_b64_tr_b16 v[34:35], v7 offset:17920
  ds_read_b64_tr_b16 v[36:37], v8 offset:4352
  ds_read_b64_tr_b16 v[38:39], v8 offset:4480
  buffer_load_dwordx4 v[220:223], v4, s[8:11], s58 offen offset:1152
  s_waitcnt vmcnt(13)
  s_waitcnt lgkmcnt(6)
  v_mfma_f32_32x32x16_bf16 v[64:79], v[52:55], v[160:163], v[64:79]
  v_xor_b32_dpp v16, v180, v176 quad_perm:[1,0,3,2] row_mask:0xf bank_mask:0xf
  v_xor_b32_dpp v17, v181, v177 quad_perm:[1,0,3,2] row_mask:0xf bank_mask:0xf
  v_xor_b32_dpp v18, v182, v178 quad_perm:[1,0,3,2] row_mask:0xf bank_mask:0xf
  v_xor_b32_dpp v19, v183, v179 quad_perm:[1,0,3,2] row_mask:0xf bank_mask:0xf
  v_mfma_f32_32x32x16_bf16 v[80:95], v[56:59], v[160:163], v[80:95]
  v_xor_b32_dpp v20, v188, v184 quad_perm:[1,0,3,2] row_mask:0xf bank_mask:0xf
  v_xor_b32_dpp v21, v189, v185 quad_perm:[1,0,3,2] row_mask:0xf bank_mask:0xf
  v_xor_b32_dpp v22, v190, v186 quad_perm:[1,0,3,2] row_mask:0xf bank_mask:0xf
  v_mfma_f32_32x32x16_bf16 v[96:111], v[160:163], v[60:63], v[96:111]
  v_xor_b32_dpp v23, v191, v187 quad_perm:[1,0,3,2] row_mask:0xf bank_mask:0xf
  v_and_b32 v16, v24, v16
  v_and_b32 v17, v24, v17
  ds_read_b64_tr_b16 v[40:41], v6 offset:18432
  ds_read_b64_tr_b16 v[42:43], v6 offset:18944
  ds_read_b64_tr_b16 v[44:45], v7 offset:18432
  ds_read_b64_tr_b16 v[46:47], v7 offset:18944
  ds_read_b64_tr_b16 v[48:49], v8 offset:4608
  ds_read_b64_tr_b16 v[50:51], v8 offset:4736
  s_add_u32 s55, s53, 3
  s_and_b32 s55, s55, 3
  s_mul_i32 s41, s55, 131072
  s_add_u32 s41, s41, s54
  s_lshl_b32 s57, s55, 8
  s_add_u32 s57, s57, s44
  s_lshl_b32 s42, s55, 12
  s_add_u32 s42, s42, s56
  s_mov_b32 m0, s40
  s_add_u32 s40, s40, 1024
  buffer_load_dwordx4 v5, s[12:15], s41 offen lds
  s_add_u32 s41, s41, 8192
  s_mov_b32 m0, s40
  s_add_u32 s40, s40, 1024
  buffer_load_dwordx4 v5, s[12:15], s41 offen lds
  s_add_u32 s41, s41, 8192
  s_waitcnt lgkmcnt(6)
  v_mfma_f32_32x32x16_bf16 v[64:79], v[28:31], v[164:167], v[64:79]
  v_and_b32 v18, v24, v18
  v_and_b32 v19, v24, v19
  v_and_b32 v20, v24, v20
  v_and_b32 v21, v24, v21
  v_mfma_f32_32x32x16_bf16 v[80:95], v[32:35], v[164:167], v[80:95]
  v_and_b32 v22, v24, v22
  v_and_b32 v23, v24, v23
  v_xor_b32 v176, v16, v176
  v_mfma_f32_32x32x16_bf16 v[96:111], v[164:167], v[36:39], v[96:111]
  v_xor_b32 v177, v17, v177
  v_xor_b32 v178, v18, v178
  v_xor_b32 v179, v19, v179
  ds_read_b64_tr_b16 v[52:53], v6 offset:19456
  ds_read_b64_tr_b16 v[54:55], v6 offset:19968
  ds_read_b64_tr_b16 v[56:57], v7 offset:19456
  ds_read_b64_tr_b16 v[58:59], v7 offset:19968
  ds_read_b64_tr_b16 v[60:61], v8 offset:4864
  ds_read_b64_tr_b16 v[62:63], v8 offset:4992
  s_mov_b32 m0, s40
  s_add_u32 s40, s40, 1024
  buffer_load_dwordx4 v5, s[12:15], s41 offen lds
  s_add_u32 s41, s41, 8192
  s_mov_b32 m0, s40
  s_add_u32 s40, s40, 13312
  buffer_load_dwordx4 v5, s[12:15], s41 offen lds
  s_waitcnt lgkmcnt(6)
  v_mfma_f32_32x32x16_bf16 v[64:79], v[40:43], v[168:171], v[64:79]
  v_xor_b32 v184, v20, v184
  v_xor_b32 v185, v21, v185
  v_xor_b32 v186, v22, v186
  v_xor_b32 v187, v23, v187
  v_mfma_f32_32x32x16_bf16 v[80:95], v[44:47], v[168:171], v[80:95]
  v_xor_b32_dpp v180, v16, v180 quad_perm:[1,0,3,2] row_mask:0xf bank_mask:0xf
  v_xor_b32_dpp v181, v17, v181 quad_perm:[1,0,3,2] row_mask:0xf bank_mask:0xf
  v_xor_b32_dpp v182, v18, v182 quad_perm:[1,0,3,2] row_mask:0xf bank_mask:0xf
  v_mfma_f32_32x32x16_bf16 v[96:111], v[168:171], v[48:51], v[96:111]
  v_xor_b32_dpp v183, v19, v183 quad_perm:[1,0,3,2] row_mask:0xf bank_mask:0xf
  v_xor_b32_dpp v188, v20, v188 quad_perm:[1,0,3,2] row_mask:0xf bank_mask:0xf
  v_xor_b32_dpp v189, v21, v189 quad_perm:[1,0,3,2] row_mask:0xf bank_mask:0xf
  ds_read_b64_tr_b16 v[28:29], v6 offset:24576
  ds_read_b64_tr_b16 v[30:31], v6 offset:25088
  ds_read_b64_tr_b16 v[32:33], v7 offset:24576
  ds_read_b64_tr_b16 v[34:35], v7 offset:25088
  ds_read_b64_tr_b16 v[36:37], v8 offset:6144
  ds_read_b64_tr_b16 v[38:39], v8 offset:6272
  s_mov_b32 m0, s43
  s_add_u32 s43, s43, 4096
  buffer_load_dwordx4 v13, s[20:23], s42 offen lds
  s_waitcnt lgkmcnt(6)
  v_mfma_f32_32x32x16_bf16 v[64:79], v[52:55], v[172:175], v[64:79]
  v_xor_b32_dpp v190, v22, v190 quad_perm:[1,0,3,2] row_mask:0xf bank_mask:0xf
  v_xor_b32_dpp v191, v23, v191 quad_perm:[1,0,3,2] row_mask:0xf bank_mask:0xf
  v_permlane16_swap_b32 v176, v184
  v_permlane16_swap_b32 v177, v185
  v_mfma_f32_32x32x16_bf16 v[80:95], v[56:59], v[172:175], v[80:95]
  v_permlane16_swap_b32 v178, v186
  v_permlane16_swap_b32 v179, v187
  v_permlane16_swap_b32 v180, v188
  v_mfma_f32_32x32x16_bf16 v[96:111], v[172:175], v[60:63], v[96:111]
  v_permlane16_swap_b32 v181, v189
  v_permlane16_swap_b32 v182, v190
  v_permlane16_swap_b32 v183, v191
  ds_read_b64_tr_b16 v[40:41], v6 offset:25600
  ds_read_b64_tr_b16 v[42:43], v6 offset:26112
  ds_read_b64_tr_b16 v[44:45], v7 offset:25600
  ds_read_b64_tr_b16 v[46:47], v7 offset:26112
  ds_read_b64_tr_b16 v[48:49], v8 offset:6400
  ds_read_b64_tr_b16 v[50:51], v8 offset:6528
  buffer_load_dwordx4 v[224:227], v4, s[8:11], s57 offen offset:0
  buffer_load_dwordx4 v[228:231], v4, s[8:11], s57 offen offset:1024
  s_waitcnt vmcnt(11)
  s_waitcnt lgkmcnt(6)
  v_mfma_f32_32x32x16_bf16 v[64:79], v[28:31], v[176:179], v[64:79]
  v_xor_b32_dpp v16, v196, v192 quad_perm:[1,0,3,2] row_mask:0xf bank_mask:0xf
  v_xor_b32_dpp v17, v197, v193 quad_perm:[1,0,3,2] row_mask:0xf bank_mask:0xf
  v_xor_b32_dpp v18, v198, v194 quad_perm:[1,0,3,2] row_mask:0xf bank_mask:0xf
  v_xor_b32_dpp v19, v199, v195 quad_perm:[1,0,3,2] row_mask:0xf bank_mask:0xf
  v_mfma_f32_32x32x16_bf16 v[80:95], v[32:35], v[176:179], v[80:95]
  v_xor_b32_dpp v20, v204, v200 quad_perm:[1,0,3,2] row_mask:0xf bank_mask:0xf
  v_xor_b32_dpp v21, v205, v201 quad_perm:[1,0,3,2] row_mask:0xf bank_mask:0xf
  v_xor_b32_dpp v22, v206, v202 quad_perm:[1,0,3,2] row_mask:0xf bank_mask:0xf
  v_mfma_f32_32x32x16_bf16 v[96:111], v[176:179], v[36:39], v[96:111]
  v_xor_b32_dpp v23, v207, v203 quad_perm:[1,0,3,2] row_mask:0xf bank_mask:0xf
  v_and_b32 v16, v24, v16
  v_and_b32 v17, v24, v17
  ds_read_b64_tr_b16 v[52:53], v6 offset:26624
  ds_read_b64_tr_b16 v[54:55], v6 offset:27136
  ds_read_b64_tr_b16 v[56:57], v7 offset:26624
  ds_read_b64_tr_b16 v[58:59], v7 offset:27136
  ds_read_b64_tr_b16 v[60:61], v8 offset:6656
  ds_read_b64_tr_b16 v[62:63], v8 offset:6784
  s_add_u32 s58, s57, 16384
  buffer_load_dwordx4 v[232:235], v4, s[8:11], s58 offen offset:0
  buffer_load_dwordx4 v[236:239], v4, s[8:11], s58 offen offset:1024
  s_waitcnt lgkmcnt(6)
  v_mfma_f32_32x32x16_bf16 v[64:79], v[40:43], v[180:183], v[64:79]
  v_and_b32 v18, v24, v18
  v_and_b32 v19, v24, v19
  v_and_b32 v20, v24, v20
  v_and_b32 v21, v24, v21
  v_mfma_f32_32x32x16_bf16 v[80:95], v[44:47], v[180:183], v[80:95]
  v_and_b32 v22, v24, v22
  v_and_b32 v23, v24, v23
  v_xor_b32 v192, v16, v192
  v_mfma_f32_32x32x16_bf16 v[96:111], v[180:183], v[48:51], v[96:111]
  v_xor_b32 v193, v17, v193
  v_xor_b32 v194, v18, v194
  v_xor_b32 v195, v19, v195
  ds_read_b64_tr_b16 v[28:29], v6 offset:27648
  ds_read_b64_tr_b16 v[30:31], v6 offset:28160
  ds_read_b64_tr_b16 v[32:33], v7 offset:27648
  ds_read_b64_tr_b16 v[34:35], v7 offset:28160
  ds_read_b64_tr_b16 v[36:37], v8 offset:6912
  ds_read_b64_tr_b16 v[38:39], v8 offset:7040
  buffer_load_dwordx4 v[240:243], v4, s[8:11], s57 offen offset:128
  s_waitcnt lgkmcnt(6)
  v_mfma_f32_32x32x16_bf16 v[64:79], v[52:55], v[184:187], v[64:79]
  v_xor_b32 v200, v20, v200
  v_xor_b32 v201, v21, v201
  v_xor_b32 v202, v22, v202
  v_xor_b32 v203, v23, v203
  v_mfma_f32_32x32x16_bf16 v[80:95], v[56:59], v[184:187], v[80:95]
  v_xor_b32_dpp v196, v16, v196 quad_perm:[1,0,3,2] row_mask:0xf bank_mask:0xf
  v_xor_b32_dpp v197, v17, v197 quad_perm:[1,0,3,2] row_mask:0xf bank_mask:0xf
  v_xor_b32_dpp v198, v18, v198 quad_perm:[1,0,3,2] row_mask:0xf bank_mask:0xf
  v_mfma_f32_32x32x16_bf16 v[96:111], v[184:187], v[60:63], v[96:111]
  v_xor_b32_dpp v199, v19, v199 quad_perm:[1,0,3,2] row_mask:0xf bank_mask:0xf
  v_xor_b32_dpp v204, v20, v204 quad_perm:[1,0,3,2] row_mask:0xf bank_mask:0xf
  v_xor_b32_dpp v205, v21, v205 quad_perm:[1,0,3,2] row_mask:0xf bank_mask:0xf
  s_barrier
  ds_read_b64_tr_b16 v[40:41], v6 offset:32768
  ds_read_b64_tr_b16 v[42:43], v6 offset:33280
  ds_read_b64_tr_b16 v[44:45], v7 offset:32768
  ds_read_b64_tr_b16 v[46:47], v7 offset:33280
  ds_read_b64_tr_b16 v[48:49], v8 offset:8192
  ds_read_b64_tr_b16 v[50:51], v8 offset:8320
  buffer_load_dwordx4 v[244:247], v4, s[8:11], s57 offen offset:1152
  buffer_load_dwordx4 v[248:251], v4, s[8:11], s58 offen offset:128
  s_waitcnt lgkmcnt(6)
  v_mfma_f32_32x32x16_bf16 v[64:79], v[28:31], v[188:191], v[64:79]
  v_xor_b32_dpp v206, v22, v206 quad_perm:[1,0,3,2] row_mask:0xf bank_mask:0xf
  v_xor_b32_dpp v207, v23, v207 quad_perm:[1,0,3,2] row_mask:0xf bank_mask:0xf
  v_permlane16_swap_b32 v192, v200
  v_permlane16_swap_b32 v193, v201
  v_mfma_f32_32x32x16_bf16 v[80:95], v[32:35], v[188:191], v[80:95]
  v_permlane16_swap_b32 v194, v202
  v_permlane16_swap_b32 v195, v203
  v_permlane16_swap_b32 v196, v204
  v_mfma_f32_32x32x16_bf16 v[96:111], v[188:191], v[36:39], v[96:111]
  v_permlane16_swap_b32 v197, v205
  v_permlane16_swap_b32 v198, v206
  v_permlane16_swap_b32 v199, v207
  ds_read_b64_tr_b16 v[52:53], v6 offset:33792
  ds_read_b64_tr_b16 v[54:55], v6 offset:34304
  ds_read_b64_tr_b16 v[56:57], v7 offset:33792
  ds_read_b64_tr_b16 v[58:59], v7 offset:34304
  ds_read_b64_tr_b16 v[60:61], v8 offset:8448
  ds_read_b64_tr_b16 v[62:63], v8 offset:8576
  buffer_load_dwordx4 v[252:255], v4, s[8:11], s58 offen offset:1152
  s_waitcnt vmcnt(13)
  s_waitcnt lgkmcnt(6)
  v_mfma_f32_32x32x16_bf16 v[64:79], v[40:43], v[192:195], v[64:79]
  v_xor_b32_dpp v16, v212, v208 quad_perm:[1,0,3,2] row_mask:0xf bank_mask:0xf
  v_xor_b32_dpp v17, v213, v209 quad_perm:[1,0,3,2] row_mask:0xf bank_mask:0xf
  v_xor_b32_dpp v18, v214, v210 quad_perm:[1,0,3,2] row_mask:0xf bank_mask:0xf
  v_xor_b32_dpp v19, v215, v211 quad_perm:[1,0,3,2] row_mask:0xf bank_mask:0xf
  v_mfma_f32_32x32x16_bf16 v[80:95], v[44:47], v[192:195], v[80:95]
  v_xor_b32_dpp v20, v220, v216 quad_perm:[1,0,3,2] row_mask:0xf bank_mask:0xf
  v_xor_b32_dpp v21, v221, v217 quad_perm:[1,0,3,2] row_mask:0xf bank_mask:0xf
  v_xor_b32_dpp v22, v222, v218 quad_perm:[1,0,3,2] row_mask:0xf bank_mask:0xf
  v_mfma_f32_32x32x16_bf16 v[96:111], v[192:195], v[48:51], v[96:111]
  v_xor_b32_dpp v23, v223, v219 quad_perm:[1,0,3,2] row_mask:0xf bank_mask:0xf
  v_and_b32 v16, v24, v16
  v_and_b32 v17, v24, v17
  ds_read_b64_tr_b16 v[28:29], v6 offset:34816
  ds_read_b64_tr_b16 v[30:31], v6 offset:35328
  ds_read_b64_tr_b16 v[32:33], v7 offset:34816
  ds_read_b64_tr_b16 v[34:35], v7 offset:35328
  ds_read_b64_tr_b16 v[36:37], v8 offset:8704
  ds_read_b64_tr_b16 v[38:39], v8 offset:8832
  s_waitcnt lgkmcnt(6)
  v_mfma_f32_32x32x16_bf16 v[64:79], v[52:55], v[196:199], v[64:79]
  v_and_b32 v18, v24, v18
  v_and_b32 v19, v24, v19
  v_and_b32 v20, v24, v20
  v_and_b32 v21, v24, v21
  v_mfma_f32_32x32x16_bf16 v[80:95], v[56:59], v[196:199], v[80:95]
  v_and_b32 v22, v24, v22
  v_and_b32 v23, v24, v23
  v_xor_b32 v208, v16, v208
  v_mfma_f32_32x32x16_bf16 v[96:111], v[196:199], v[60:63], v[96:111]
  v_xor_b32 v209, v17, v209
  v_xor_b32 v210, v18, v210
  v_xor_b32 v211, v19, v211
  ds_read_b64_tr_b16 v[40:41], v6 offset:35840
  ds_read_b64_tr_b16 v[42:43], v6 offset:36352
  ds_read_b64_tr_b16 v[44:45], v7 offset:35840
  ds_read_b64_tr_b16 v[46:47], v7 offset:36352
  ds_read_b64_tr_b16 v[48:49], v8 offset:8960
  ds_read_b64_tr_b16 v[50:51], v8 offset:9088
  s_waitcnt lgkmcnt(6)
  v_mfma_f32_32x32x16_bf16 v[64:79], v[28:31], v[200:203], v[64:79]
  v_xor_b32 v216, v20, v216
  v_xor_b32 v217, v21, v217
  v_xor_b32 v218, v22, v218
  v_xor_b32 v219, v23, v219
  v_mfma_f32_32x32x16_bf16 v[80:95], v[32:35], v[200:203], v[80:95]
  v_xor_b32_dpp v212, v16, v212 quad_perm:[1,0,3,2] row_mask:0xf bank_mask:0xf
  v_xor_b32_dpp v213, v17, v213 quad_perm:[1,0,3,2] row_mask:0xf bank_mask:0xf
  v_xor_b32_dpp v214, v18, v214 quad_perm:[1,0,3,2] row_mask:0xf bank_mask:0xf
  v_mfma_f32_32x32x16_bf16 v[96:111], v[200:203], v[36:39], v[96:111]
  v_xor_b32_dpp v215, v19, v215 quad_perm:[1,0,3,2] row_mask:0xf bank_mask:0xf
  v_xor_b32_dpp v220, v20, v220 quad_perm:[1,0,3,2] row_mask:0xf bank_mask:0xf
  v_xor_b32_dpp v221, v21, v221 quad_perm:[1,0,3,2] row_mask:0xf bank_mask:0xf
  ds_read_b64_tr_b16 v[52:53], v6 offset:40960
  ds_read_b64_tr_b16 v[54:55], v6 offset:41472
  ds_read_b64_tr_b16 v[56:57], v7 offset:40960
  ds_read_b64_tr_b16 v[58:59], v7 offset:41472
  ds_read_b64_tr_b16 v[60:61], v8 offset:10240
  ds_read_b64_tr_b16 v[62:63], v8 offset:10368
  s_waitcnt lgkmcnt(6)
  v_mfma_f32_32x32x16_bf16 v[64:79], v[40:43], v[204:207], v[64:79]
  v_xor_b32_dpp v222, v22, v222 quad_perm:[1,0,3,2] row_mask:0xf bank_mask:0xf
  v_xor_b32_dpp v223, v23, v223 quad_perm:[1,0,3,2] row_mask:0xf bank_mask:0xf
  v_permlane16_swap_b32 v208, v216
  v_permlane16_swap_b32 v209, v217
  v_mfma_f32_32x32x16_bf16 v[80:95], v[44:47], v[204:207], v[80:95]
  v_permlane16_swap_b32 v210, v218
  v_permlane16_swap_b32 v211, v219
  v_permlane16_swap_b32 v212, v220
  v_mfma_f32_32x32x16_bf16 v[96:111], v[204:207], v[48:51], v[96:111]
  v_permlane16_swap_b32 v213, v221
  v_permlane16_swap_b32 v214, v222
  v_permlane16_swap_b32 v215, v223
  ds_read_b64_tr_b16 v[28:29], v6 offset:41984
  ds_read_b64_tr_b16 v[30:31], v6 offset:42496
  ds_read_b64_tr_b16 v[32:33], v7 offset:41984
  ds_read_b64_tr_b16 v[34:35], v7 offset:42496
  ds_read_b64_tr_b16 v[36:37], v8 offset:10496
  ds_read_b64_tr_b16 v[38:39], v8 offset:10624
  s_waitcnt vmcnt(4)
  s_waitcnt lgkmcnt(6)
  v_mfma_f32_32x32x16_bf16 v[64:79], v[52:55], v[208:211], v[64:79]
  v_xor_b32_dpp v16, v228, v224 quad_perm:[1,0,3,2] row_mask:0xf bank_mask:0xf
  v_xor_b32_dpp v17, v229, v225 quad_perm:[1,0,3,2] row_mask:0xf bank_mask:0xf
  v_xor_b32_dpp v18, v230, v226 quad_perm:[1,0,3,2] row_mask:0xf bank_mask:0xf
  v_xor_b32_dpp v19, v231, v227 quad_perm:[1,0,3,2] row_mask:0xf bank_mask:0xf
  v_mfma_f32_32x32x16_bf16 v[80:95], v[56:59], v[208:211], v[80:95]
  v_xor_b32_dpp v20, v236, v232 quad_perm:[1,0,3,2] row_mask:0xf bank_mask:0xf
  v_xor_b32_dpp v21, v237, v233 quad_perm:[1,0,3,2] row_mask:0xf bank_mask:0xf
  v_xor_b32_dpp v22, v238, v234 quad_perm:[1,0,3,2] row_mask:0xf bank_mask:0xf
  v_mfma_f32_32x32x16_bf16 v[96:111], v[208:211], v[60:63], v[96:111]
  v_xor_b32_dpp v23, v239, v235 quad_perm:[1,0,3,2] row_mask:0xf bank_mask:0xf
  v_and_b32 v16, v24, v16
  v_and_b32 v17, v24, v17
  ds_read_b64_tr_b16 v[40:41], v6 offset:43008
  ds_read_b64_tr_b16 v[42:43], v6 offset:43520
  ds_read_b64_tr_b16 v[44:45], v7 offset:43008
  ds_read_b64_tr_b16 v[46:47], v7 offset:43520
  ds_read_b64_tr_b16 v[48:49], v8 offset:10752
  ds_read_b64_tr_b16 v[50:51], v8 offset:10880
  s_waitcnt lgkmcnt(6)
  v_mfma_f32_32x32x16_bf16 v[64:79], v[28:31], v[212:215], v[64:79]
  v_and_b32 v18, v24, v18
  v_and_b32 v19, v24, v19
  v_and_b32 v20, v24, v20
  v_and_b32 v21, v24, v21
  v_mfma_f32_32x32x16_bf16 v[80:95], v[32:35], v[212:215], v[80:95]
  v_and_b32 v22, v24, v22
  v_and_b32 v23, v24, v23
  v_xor_b32 v224, v16, v224
  v_mfma_f32_32x32x16_bf16 v[96:111], v[212:215], v[36:39], v[96:111]
  v_xor_b32 v225, v17, v225
  v_xor_b32 v226, v18, v226
  v_xor_b32 v227, v19, v227
  ds_read_b64_tr_b16 v[52:53], v6 offset:44032
  ds_read_b64_tr_b16 v[54:55], v6 offset:44544
  ds_read_b64_tr_b16 v[56:57], v7 offset:44032
  ds_read_b64_tr_b16 v[58:59], v7 offset:44544
  ds_read_b64_tr_b16 v[60:61], v8 offset:11008
  ds_read_b64_tr_b16 v[62:63], v8 offset:11136
  s_waitcnt lgkmcnt(6)
  v_mfma_f32_32x32x16_bf16 v[64:79], v[40:43], v[216:219], v[64:79]
  v_xor_b32 v232, v20, v232
  v_xor_b32 v233, v21, v233
  v_xor_b32 v234, v22, v234
  v_xor_b32 v235, v23, v235
  v_mfma_f32_32x32x16_bf16 v[80:95], v[44:47], v[216:219], v[80:95]
  v_xor_b32_dpp v228, v16, v228 quad_perm:[1,0,3,2] row_mask:0xf bank_mask:0xf
  v_xor_b32_dpp v229, v17, v229 quad_perm:[1,0,3,2] row_mask:0xf bank_mask:0xf
  v_xor_b32_dpp v230, v18, v230 quad_perm:[1,0,3,2] row_mask:0xf bank_mask:0xf
  v_mfma_f32_32x32x16_bf16 v[96:111], v[216:219], v[48:51], v[96:111]
  v_xor_b32_dpp v231, v19, v231 quad_perm:[1,0,3,2] row_mask:0xf bank_mask:0xf
  v_xor_b32_dpp v236, v20, v236 quad_perm:[1,0,3,2] row_mask:0xf bank_mask:0xf
  v_xor_b32_dpp v237, v21, v237 quad_perm:[1,0,3,2] row_mask:0xf bank_mask:0xf
  s_barrier
  ds_read_b64_tr_b16 v[28:29], v6 offset:49152
  ds_read_b64_tr_b16 v[30:31], v6 offset:49664
  ds_read_b64_tr_b16 v[32:33], v7 offset:49152
  ds_read_b64_tr_b16 v[34:35], v7 offset:49664
  ds_read_b64_tr_b16 v[36:37], v8 offset:12288
  ds_read_b64_tr_b16 v[38:39], v8 offset:12416
  s_waitcnt lgkmcnt(6)
  v_mfma_f32_32x32x16_bf16 v[64:79], v[52:55], v[220:223], v[64:79]
  v_xor_b32_dpp v238, v22, v238 quad_perm:[1,0,3,2] row_mask:0xf bank_mask:0xf
  v_xor_b32_dpp v239, v23, v239 quad_perm:[1,0,3,2] row_mask:0xf bank_mask:0xf
  v_permlane16_swap_b32 v224, v232
  v_permlane16_swap_b32 v225, v233
  v_mfma_f32_32x32x16_bf16 v[80:95], v[56:59], v[220:223], v[80:95]
  v_permlane16_swap_b32 v226, v234
  v_permlane16_swap_b32 v227, v235
  v_permlane16_swap_b32 v228, v236
  v_mfma_f32_32x32x16_bf16 v[96:111], v[220:223], v[60:63], v[96:111]
  v_permlane16_swap_b32 v229, v237
  v_permlane16_swap_b32 v230, v238
  v_permlane16_swap_b32 v231, v239
  ds_read_b64_tr_b16 v[40:41], v6 offset:50176
  ds_read_b64_tr_b16 v[42:43], v6 offset:50688
  ds_read_b64_tr_b16 v[44:45], v7 offset:50176
  ds_read_b64_tr_b16 v[46:47], v7 offset:50688
  ds_read_b64_tr_b16 v[48:49], v8 offset:12544
  ds_read_b64_tr_b16 v[50:51], v8 offset:12672
  s_waitcnt vmcnt(0)
  s_waitcnt lgkmcnt(6)
  v_mfma_f32_32x32x16_bf16 v[64:79], v[28:31], v[224:227], v[64:79]
  v_xor_b32_dpp v16, v244, v240 quad_perm:[1,0,3,2] row_mask:0xf bank_mask:0xf
  v_xor_b32_dpp v17, v245, v241 quad_perm:[1,0,3,2] row_mask:0xf bank_mask:0xf
  v_xor_b32_dpp v18, v246, v242 quad_perm:[1,0,3,2] row_mask:0xf bank_mask:0xf
  v_xor_b32_dpp v19, v247, v243 quad_perm:[1,0,3,2] row_mask:0xf bank_mask:0xf
  v_mfma_f32_32x32x16_bf16 v[80:95], v[32:35], v[224:227], v[80:95]
  v_xor_b32_dpp v20, v252, v248 quad_perm:[1,0,3,2] row_mask:0xf bank_mask:0xf
  v_xor_b32_dpp v21, v253, v249 quad_perm:[1,0,3,2] row_mask:0xf bank_mask:0xf
  v_xor_b32_dpp v22, v254, v250 quad_perm:[1,0,3,2] row_mask:0xf bank_mask:0xf
  v_mfma_f32_32x32x16_bf16 v[96:111], v[224:227], v[36:39], v[96:111]
  v_xor_b32_dpp v23, v255, v251 quad_perm:[1,0,3,2] row_mask:0xf bank_mask:0xf
  v_and_b32 v16, v24, v16
  v_and_b32 v17, v24, v17
  ds_read_b64_tr_b16 v[52:53], v6 offset:51200
  ds_read_b64_tr_b16 v[54:55], v6 offset:51712
  ds_read_b64_tr_b16 v[56:57], v7 offset:51200
  ds_read_b64_tr_b16 v[58:59], v7 offset:51712
  ds_read_b64_tr_b16 v[60:61], v8 offset:12800
  ds_read_b64_tr_b16 v[62:63], v8 offset:12928
  s_waitcnt lgkmcnt(6)
  v_mfma_f32_32x32x16_bf16 v[64:79], v[40:43], v[228:231], v[64:79]
  v_and_b32 v18, v24, v18
  v_and_b32 v19, v24, v19
  v_and_b32 v20, v24, v20
  v_and_b32 v21, v24, v21
  v_mfma_f32_32x32x16_bf16 v[80:95], v[44:47], v[228:231], v[80:95]
  v_and_b32 v22, v24, v22
  v_and_b32 v23, v24, v23
  v_xor_b32 v240, v16, v240
  v_mfma_f32_32x32x16_bf16 v[96:111], v[228:231], v[48:51], v[96:111]
  v_xor_b32 v241, v17, v241
  v_xor_b32 v242, v18, v242
  v_xor_b32 v243, v19, v243
  ds_read_b64_tr_b16 v[28:29], v6 offset:52224
  ds_read_b64_tr_b16 v[30:31], v6 offset:52736
  ds_read_b64_tr_b16 v[32:33], v7 offset:52224
  ds_read_b64_tr_b16 v[34:35], v7 offset:52736
  ds_read_b64_tr_b16 v[36:37], v8 offset:13056
  ds_read_b64_tr_b16 v[38:39], v8 offset:13184
  s_waitcnt lgkmcnt(6)
  v_mfma_f32_32x32x16_bf16 v[64:79], v[52:55], v[232:235], v[64:79]
  v_xor_b32 v248, v20, v248
  v_xor_b32 v249, v21, v249
  v_xor_b32 v250, v22, v250
  v_xor_b32 v251, v23, v251
  v_mfma_f32_32x32x16_bf16 v[80:95], v[56:59], v[232:235], v[80:95]
  v_xor_b32_dpp v244, v16, v244 quad_perm:[1,0,3,2] row_mask:0xf bank_mask:0xf
  v_xor_b32_dpp v245, v17, v245 quad_perm:[1,0,3,2] row_mask:0xf bank_mask:0xf
  v_xor_b32_dpp v246, v18, v246 quad_perm:[1,0,3,2] row_mask:0xf bank_mask:0xf
  v_mfma_f32_32x32x16_bf16 v[96:111], v[232:235], v[60:63], v[96:111]
  v_xor_b32_dpp v247, v19, v247 quad_perm:[1,0,3,2] row_mask:0xf bank_mask:0xf
  v_xor_b32_dpp v252, v20, v252 quad_perm:[1,0,3,2] row_mask:0xf bank_mask:0xf
  v_xor_b32_dpp v253, v21, v253 quad_perm:[1,0,3,2] row_mask:0xf bank_mask:0xf
  ds_read_b64_tr_b16 v[40:41], v6 offset:57344
  ds_read_b64_tr_b16 v[42:43], v6 offset:57856
  ds_read_b64_tr_b16 v[44:45], v7 offset:57344
  ds_read_b64_tr_b16 v[46:47], v7 offset:57856
  ds_read_b64_tr_b16 v[48:49], v8 offset:14336
  ds_read_b64_tr_b16 v[50:51], v8 offset:14464
  s_waitcnt lgkmcnt(6)
  v_mfma_f32_32x32x16_bf16 v[64:79], v[28:31], v[236:239], v[64:79]
  v_xor_b32_dpp v254, v22, v254 quad_perm:[1,0,3,2] row_mask:0xf bank_mask:0xf
  v_xor_b32_dpp v255, v23, v255 quad_perm:[1,0,3,2] row_mask:0xf bank_mask:0xf
  v_permlane16_swap_b32 v240, v248
  v_permlane16_swap_b32 v241, v249
  v_mfma_f32_32x32x16_bf16 v[80:95], v[32:35], v[236:239], v[80:95]
  v_permlane16_swap_b32 v242, v250
  v_permlane16_swap_b32 v243, v251
  v_permlane16_swap_b32 v244, v252
  v_mfma_f32_32x32x16_bf16 v[96:111], v[236:239], v[36:39], v[96:111]
  v_permlane16_swap_b32 v245, v253
  v_permlane16_swap_b32 v246, v254
  v_permlane16_swap_b32 v247, v255
  ds_read_b64_tr_b16 v[52:53], v6 offset:58368
  ds_read_b64_tr_b16 v[54:55], v6 offset:58880
  ds_read_b64_tr_b16 v[56:57], v7 offset:58368
  ds_read_b64_tr_b16 v[58:59], v7 offset:58880
  ds_read_b64_tr_b16 v[60:61], v8 offset:14592
  ds_read_b64_tr_b16 v[62:63], v8 offset:14720
  s_waitcnt lgkmcnt(6)
  v_mfma_f32_32x32x16_bf16 v[64:79], v[40:43], v[240:243], v[64:79]
  v_mfma_f32_32x32x16_bf16 v[80:95], v[44:47], v[240:243], v[80:95]
  v_mfma_f32_32x32x16_bf16 v[96:111], v[240:243], v[48:51], v[96:111]
  ds_read_b64_tr_b16 v[28:29], v6 offset:59392
  ds_read_b64_tr_b16 v[30:31], v6 offset:59904
  ds_read_b64_tr_b16 v[32:33], v7 offset:59392
  ds_read_b64_tr_b16 v[34:35], v7 offset:59904
  ds_read_b64_tr_b16 v[36:37], v8 offset:14848
  ds_read_b64_tr_b16 v[38:39], v8 offset:14976
  s_waitcnt lgkmcnt(6)
  v_mfma_f32_32x32x16_bf16 v[64:79], v[52:55], v[244:247], v[64:79]
  v_mfma_f32_32x32x16_bf16 v[80:95], v[56:59], v[244:247], v[80:95]
  v_mfma_f32_32x32x16_bf16 v[96:111], v[244:247], v[60:63], v[96:111]
  ds_read_b64_tr_b16 v[40:41], v6 offset:60416
  ds_read_b64_tr_b16 v[42:43], v6 offset:60928
  ds_read_b64_tr_b16 v[44:45], v7 offset:60416
  ds_read_b64_tr_b16 v[46:47], v7 offset:60928
  ds_read_b64_tr_b16 v[48:49], v8 offset:15104
  ds_read_b64_tr_b16 v[50:51], v8 offset:15232
  s_waitcnt lgkmcnt(6)
  v_mfma_f32_32x32x16_bf16 v[64:79], v[28:31], v[248:251], v[64:79]
  v_mfma_f32_32x32x16_bf16 v[80:95], v[32:35], v[248:251], v[80:95]
  v_mfma_f32_32x32x16_bf16 v[96:111], v[248:251], v[36:39], v[96:111]
  s_waitcnt lgkmcnt(0)
  v_mfma_f32_32x32x16_bf16 v[64:79], v[40:43], v[252:255], v[64:79]
  v_mfma_f32_32x32x16_bf16 v[80:95], v[44:47], v[252:255], v[80:95]
  v_mfma_f32_32x32x16_bf16 v[96:111], v[252:255], v[48:51], v[96:111]
  s_nop 7
  s_nop 7
  v_cvt_pk_bf16_f32 v16, v96, v97
  v_cvt_pk_bf16_f32 v17, v98, v99
  v_cvt_pk_bf16_f32 v18, v100, v101
  v_cvt_pk_bf16_f32 v19, v102, v103
  v_cvt_pk_bf16_f32 v20, v104, v105
  v_cvt_pk_bf16_f32 v21, v106, v107
  v_cvt_pk_bf16_f32 v22, v108, v109
  v_cvt_pk_bf16_f32 v23, v110, v111
  v_lshlrev_b32 v10, 4, v3
  v_lshl_or_b32 v10, v2, 8, v10
  v_cmp_gt_u32 vcc, 16, v3
  s_lshl_b32 s46, s6, 10
  s_add_u32 s46, s46, 0x10000
  s_and_saveexec_b64 s[48:49], vcc
  buffer_store_dwordx4 v[16:19], v10, s[24:27], s46 offen
  buffer_store_dwordx4 v[20:23], v10, s[24:27], s46 offen offset:512
  s_mov_b64 exec, s[48:49]
  s_branch K1A_epi
K1A_plain:
  s_waitcnt vmcnt(21)
  s_barrier
  ds_read_b64_tr_b16 v[32:33], v6 offset:0
  ds_read_b64_tr_b16 v[34:35], v6 offset:512
  ds_read_b64_tr_b16 v[36:37], v7 offset:0
  ds_read_b64_tr_b16 v[38:39], v7 offset:512
  ds_read_b64_tr_b16 v[40:41], v6 offset:1024
  ds_read_b64_tr_b16 v[42:43], v6 offset:1536
  ds_read_b64_tr_b16 v[44:45], v7 offset:1024
  ds_read_b64_tr_b16 v[46:47], v7 offset:1536
  ds_read_b64_tr_b16 v[48:49], v6 offset:2048
  ds_read_b64_tr_b16 v[50:51], v6 offset:2560
  ds_read_b64_tr_b16 v[52:53], v7 offset:2048
  ds_read_b64_tr_b16 v[54:55], v7 offset:2560
  s_waitcnt vmcnt(17)
  v_xor_b32_dpp v16, v132, v128 quad_perm:[1,0,3,2] row_mask:0xf bank_mask:0xf
  v_xor_b32_dpp v17, v133, v129 quad_perm:[1,0,3,2] row_mask:0xf bank_mask:0xf
  v_xor_b32_dpp v18, v134, v130 quad_perm:[1,0,3,2] row_mask:0xf bank_mask:0xf
  v_xor_b32_dpp v19, v135, v131 quad_perm:[1,0,3,2] row_mask:0xf bank_mask:0xf
  v_xor_b32_dpp v20, v140, v136 quad_perm:[1,0,3,2] row_mask:0xf bank_mask:0xf
  v_xor_b32_dpp v21, v141, v137 quad_perm:[1,0,3,2] row_mask:0xf bank_mask:0xf
  v_xor_b32_dpp v22, v142, v138 quad_perm:[1,0,3,2] row_mask:0xf bank_mask:0xf
  v_xor_b32_dpp v23, v143, v139 quad_perm:[1,0,3,2] row_mask:0xf bank_mask:0xf
  v_and_b32 v16, v24, v16
  v_and_b32 v17, v24, v17
  v_and_b32 v18, v24, v18
  v_and_b32 v19, v24, v19
  v_and_b32 v20, v24, v20
  v_and_b32 v21, v24, v21
  v_and_b32 v22, v24, v22
  v_and_b32 v23, v24, v23
  v_xor_b32 v128, v16, v128
  v_xor_b32 v129, v17, v129
  v_xor_b32 v130, v18, v130
  v_xor_b32 v131, v19, v131
  v_xor_b32 v136, v20, v136
  v_xor_b32 v137, v21, v137
  v_xor_b32 v138, v22, v138
  v_xor_b32 v139, v23, v139
  v_xor_b32_dpp v132, v16, v132 quad_perm:[1,0,3,2] row_mask:0xf bank_mask:0xf
  v_xor_b32_dpp v133, v17, v133 quad_perm:[1,0,3,2] row_mask:0xf bank_mask:0xf
  v_xor_b32_dpp v134, v18, v134 quad_perm:[1,0,3,2] row_mask:0xf bank_mask:0xf
  v_xor_b32_dpp v135, v19, v135 quad_perm:[1,0,3,2] row_mask:0xf bank_mask:0xf
  v_xor_b32_dpp v140, v20, v140 quad_perm:[1,0,3,2] row_mask:0xf bank_mask:0xf
  v_xor_b32_dpp v141, v21, v141 quad_perm:[1,0,3,2] row_mask:0xf bank_mask:0xf
  v_xor_b32_dpp v142, v22, v142 quad_perm:[1,0,3,2] row_mask:0xf bank_mask:0xf
  v_xor_b32_dpp v143, v23, v143 quad_perm:[1,0,3,2] row_mask:0xf bank_mask:0xf
  v_permlane16_swap_b32 v128, v136
  v_permlane16_swap_b32 v129, v137
  v_permlane16_swap_b32 v130, v138
  v_permlane16_swap_b32 v131, v139
  v_permlane16_swap_b32 v132, v140
  v_permlane16_swap_b32 v133, v141
  v_permlane16_swap_b32 v134, v142
  v_permlane16_swap_b32 v135, v143
  s_waitcnt vmcnt(13)
  s_waitcnt lgkmcnt(8)
  v_mfma_f32_32x32x16_bf16 v[64:79], v[32:35], v[128:131], 0
  v_xor_b32_dpp v16, v148, v144 quad_perm:[1,0,3,2] row_mask:0xf bank_mask:0xf
  v_xor_b32_dpp v17, v149, v145 quad_perm:[1,0,3,2] row_mask:0xf bank_mask:0xf
  v_xor_b32_dpp v18, v150, v146 quad_perm:[1,0,3,2] row_mask:0xf bank_mask:0xf
  v_xor_b32_dpp v19, v151, v147 quad_perm:[1,0,3,2] row_mask:0xf bank_mask:0xf
  v_xor_b32_dpp v20, v156, v152 quad_perm:[1,0,3,2] row_mask:0xf bank_mask:0xf
  v_mfma_f32_32x32x16_bf16 v[80:95], v[36:39], v[128:131], 0
  v_xor_b32_dpp v21, v157, v153 quad_perm:[1,0,3,2] row_mask:0xf bank_mask:0xf
  v_xor_b32_dpp v22, v158, v154 quad_perm:[1,0,3,2] row_mask:0xf bank_mask:0xf
  v_xor_b32_dpp v23, v159, v155 quad_perm:[1,0,3,2] row_mask:0xf bank_mask:0xf
  v_and_b32 v16, v24, v16
  v_and_b32 v17, v24, v17
  ds_read_b64_tr_b16 v[56:57], v6 offset:3072
  ds_read_b64_tr_b16 v[58:59], v6 offset:3584
  ds_read_b64_tr_b16 v[60:61], v7 offset:3072
  ds_read_b64_tr_b16 v[62:63], v7 offset:3584
  s_add_u32 s55, s53, 2
  s_and_b32 s55, s55, 3
  s_mul_i32 s41, s55, 131072
  s_add_u32 s41, s41, s54
  s_lshl_b32 s57, s55, 8
  s_add_u32 s57, s57, s44
  s_lshl_b32 s42, s55, 12
  s_add_u32 s42, s42, s56
  s_mov_b32 m0, s40
  s_add_u32 s40, s40, 1024
  buffer_load_dwordx4 v5, s[12:15], s41 offen lds
  s_add_u32 s41, s41, 8192
  s_mov_b32 m0, s40
  s_add_u32 s40, s40, 1024
  buffer_load_dwordx4 v5, s[12:15], s41 offen lds
  s_add_u32 s41, s41, 8192
  s_waitcnt lgkmcnt(8)
  v_mfma_f32_32x32x16_bf16 v[64:79], v[40:43], v[132:135], v[64:79]
  v_and_b32 v18, v24, v18
  v_and_b32 v19, v24, v19
  v_and_b32 v20, v24, v20
  v_and_b32 v21, v24, v21
  v_and_b32 v22, v24, v22
  v_mfma_f32_32x32x16_bf16 v[80:95], v[44:47], v[132:135], v[80:95]
  v_and_b32 v23, v24, v23
  v_xor_b32 v144, v16, v144
  v_xor_b32 v145, v17, v145
  v_xor_b32 v146, v18, v146
  v_xor_b32 v147, v19, v147
  ds_read_b64_tr_b16 v[32:33], v6 offset:8192
  ds_read_b64_tr_b16 v[34:35], v6 offset:8704
  ds_read_b64_tr_b16 v[36:37], v7 offset:8192
  ds_read_b64_tr_b16 v[38:39], v7 offset:8704
  s_mov_b32 m0, s40
  s_add_u32 s40, s40, 1024
  buffer_load_dwordx4 v5, s[12:15], s41 offen lds
  s_add_u32 s41, s41, 8192
  s_mov_b32 m0, s40
  s_add_u32 s40, s40, 13312
  buffer_load_dwordx4 v5, s[12:15], s41 offen lds
  s_waitcnt lgkmcnt(8)
  v_mfma_f32_32x32x16_bf16 v[64:79], v[48:51], v[136:139], v[64:79]
  v_xor_b32 v152, v20, v152
  v_xor_b32 v153, v21, v153
  v_xor_b32 v154, v22, v154
  v_xor_b32 v155, v23, v155
  v_xor_b32_dpp v148, v16, v148 quad_perm:[1,0,3,2] row_mask:0xf bank_mask:0xf
  v_mfma_f32_32x32x16_bf16 v[80:95], v[52:55], v[136:139], v[80:95]
  v_xor_b32_dpp v149, v17, v149 quad_perm:[1,0,3,2] row_mask:0xf bank_mask:0xf
  v_xor_b32_dpp v150, v18, v150 quad_perm:[1,0,3,2] row_mask:0xf bank_mask:0xf
  v_xor_b32_dpp v151, v19, v151 quad_perm:[1,0,3,2] row_mask:0xf bank_mask:0xf
  v_xor_b32_dpp v156, v20, v156 quad_perm:[1,0,3,2] row_mask:0xf bank_mask:0xf
  v_xor_b32_dpp v157, v21, v157 quad_perm:[1,0,3,2] row_mask:0xf bank_mask:0xf
  ds_read_b64_tr_b16 v[40:41], v6 offset:9216
  ds_read_b64_tr_b16 v[42:43], v6 offset:9728
  ds_read_b64_tr_b16 v[44:45], v7 offset:9216
  ds_read_b64_tr_b16 v[46:47], v7 offset:9728
  s_mov_b32 m0, s43
  s_add_u32 s43, s43, 4096
  buffer_load_dwordx4 v13, s[20:23], s42 offen lds
  s_waitcnt lgkmcnt(8)
  v_mfma_f32_32x32x16_bf16 v[64:79], v[56:59], v[140:143], v[64:79]
  v_xor_b32_dpp v158, v22, v158 quad_perm:[1,0,3,2] row_mask:0xf bank_mask:0xf
  v_xor_b32_dpp v159, v23, v159 quad_perm:[1,0,3,2] row_mask:0xf bank_mask:0xf
  v_permlane16_swap_b32 v144, v152
  v_permlane16_swap_b32 v145, v153
  v_permlane16_swap_b32 v146, v154
  v_mfma_f32_32x32x16_bf16 v[80:95], v[60:63], v[140:143], v[80:95]
  v_permlane16_swap_b32 v147, v155
  v_permlane16_swap_b32 v148, v156
  v_permlane16_swap_b32 v149, v157
  v_permlane16_swap_b32 v150, v158
  v_permlane16_swap_b32 v151, v159
  ds_read_b64_tr_b16 v[48:49], v6 offset:10240
  ds_read_b64_tr_b16 v[50:51], v6 offset:10752
  ds_read_b64_tr_b16 v[52:53], v7 offset:10240
  ds_read_b64_tr_b16 v[54:55], v7 offset:10752
  buffer_load_dwordx4 v[192:195], v4, s[8:11], s57 offen offset:0
  buffer_load_dwordx4 v[196:199], v4, s[8:11], s57 offen offset:1024
  s_waitcnt vmcnt(11)
  s_waitcnt lgkmcnt(8)
  v_mfma_f32_32x32x16_bf16 v[64:79], v[32:35], v[144:147], v[64:79]
  v_xor_b32_dpp v16, v164, v160 quad_perm:[1,0,3,2] row_mask:0xf bank_mask:0xf
  v_xor_b32_dpp v17, v165, v161 quad_perm:[1,0,3,2] row_mask:0xf bank_mask:0xf
  v_xor_b32_dpp v18, v166, v162 quad_perm:[1,0,3,2] row_mask:0xf bank_mask:0xf
  v_xor_b32_dpp v19, v167, v163 quad_perm:[1,0,3,2] row_mask:0xf bank_mask:0xf
  v_xor_b32_dpp v20, v172, v168 quad_perm:[1,0,3,2] row_mask:0xf bank_mask:0xf
  v_mfma_f32_32x32x16_bf16 v[80:95], v[36:39], v[144:147], v[80:95]
  v_xor_b32_dpp v21, v173, v169 quad_perm:[1,0,3,2] row_mask:0xf bank_mask:0xf
  v_xor_b32_dpp v22, v174, v170 quad_perm:[1,0,3,2] row_mask:0xf bank_mask:0xf
  v_xor_b32_dpp v23, v175, v171 quad_perm:[1,0,3,2] row_mask:0xf bank_mask:0xf
  v_and_b32 v16, v24, v16
  v_and_b32 v17, v24, v17
  ds_read_b64_tr_b16 v[56:57], v6 offset:11264
  ds_read_b64_tr_b16 v[58:59], v6 offset:11776
  ds_read_b64_tr_b16 v[60:61], v7 offset:11264
  ds_read_b64_tr_b16 v[62:63], v7 offset:11776
  s_add_u32 s58, s57, 16384
  buffer_load_dwordx4 v[200:203], v4, s[8:11], s58 offen offset:0
  buffer_load_dwordx4 v[204:207], v4, s[8:11], s58 offen offset:1024
  s_waitcnt lgkmcnt(8)
  v_mfma_f32_32x32x16_bf16 v[64:79], v[40:43], v[148:151], v[64:79]
  v_and_b32 v18, v24, v18
  v_and_b32 v19, v24, v19
  v_and_b32 v20, v24, v20
  v_and_b32 v21, v24, v21
  v_and_b32 v22, v24, v22
  v_mfma_f32_32x32x16_bf16 v[80:95], v[44:47], v[148:151], v[80:95]
  v_and_b32 v23, v24, v23
  v_xor_b32 v160, v16, v160
  v_xor_b32 v161, v17, v161
  v_xor_b32 v162, v18, v162
  v_xor_b32 v163, v19, v163
  s_barrier
  ds_read_b64_tr_b16 v[32:33], v6 offset:16384
  ds_read_b64_tr_b16 v[34:35], v6 offset:16896
  ds_read_b64_tr_b16 v[36:37], v7 offset:16384
  ds_read_b64_tr_b16 v[38:39], v7 offset:16896
  buffer_load_dwordx4 v[208:211], v4, s[8:11], s57 offen offset:128
  s_waitcnt lgkmcnt(8)
  v_mfma_f32_32x32x16_bf16 v[64:79], v[48:51], v[152:155], v[64:79]
  v_xor_b32 v168, v20, v168
  v_xor_b32 v169, v21, v169
  v_xor_b32 v170, v22, v170
  v_xor_b32 v171, v23, v171
  v_xor_b32_dpp v164, v16, v164 quad_perm:[1,0,3,2] row_mask:0xf bank_mask:0xf
  v_mfma_f32_32x32x16_bf16 v[80:95], v[52:55], v[152:155], v[80:95]
  v_xor_b32_dpp v165, v17, v165 quad_perm:[1,0,3,2] row_mask:0xf bank_mask:0xf
  v_xor_b32_dpp v166, v18, v166 quad_perm:[1,0,3,2] row_mask:0xf bank_mask:0xf
  v_xor_b32_dpp v167, v19, v167 quad_perm:[1,0,3,2] row_mask:0xf bank_mask:0xf
  v_xor_b32_dpp v172, v20, v172 quad_perm:[1,0,3,2] row_mask:0xf bank_mask:0xf
  v_xor_b32_dpp v173, v21, v173 quad_perm:[1,0,3,2] row_mask:0xf bank_mask:0xf
  ds_read_b64_tr_b16 v[40:41], v6 offset:17408
  ds_read_b64_tr_b16 v[42:43], v6 offset:17920
  ds_read_b64_tr_b16 v[44:45], v7 offset:17408
  ds_read_b64_tr_b16 v[46:47], v7 offset:17920
  buffer_load_dwordx4 v[212:215], v4, s[8:11], s57 offen offset:1152
  buffer_load_dwordx4 v[216:219], v4, s[8:11], s58 offen offset:128
  s_waitcnt lgkmcnt(8)
  v_mfma_f32_32x32x16_bf16 v[64:79], v[56:59], v[156:159], v[64:79]
  v_xor_b32_dpp v174, v22, v174 quad_perm:[1,0,3,2] row_mask:0xf bank_mask:0xf
  v_xor_b32_dpp v175, v23, v175 quad_perm:[1,0,3,2] row_mask:0xf bank_mask:0xf
  v_permlane16_swap_b32 v160, v168
  v_permlane16_swap_b32 v161, v169
  v_permlane16_swap_b32 v162, v170
  v_mfma_f32_32x32x16_bf16 v[80:95], v[60:63], v[156:159], v[80:95]
  v_permlane16_swap_b32 v163, v171
  v_permlane16_swap_b32 v164, v172
  v_permlane16_swap_b32 v165, v173
  v_permlane16_swap_b32 v166, v174
  v_permlane16_swap_b32 v167, v175
  ds_read_b64_tr_b16 v[48:49], v6 offset:18432
  ds_read_b64_tr_b16 v[50:51], v6 offset:18944
  ds_read_b64_tr_b16 v[52:53], v7 offset:18432
  ds_read_b64_tr_b16 v[54:55], v7 offset:18944
  buffer_load_dwordx4 v[220:223], v4, s[8:11], s58 offen offset:1152
  s_waitcnt vmcnt(13)
  s_waitcnt lgkmcnt(8)
  v_mfma_f32_32x32x16_bf16 v[64:79], v[32:35], v[160:163], v[64:79]
  v_xor_b32_dpp v16, v180, v176 quad_perm:[1,0,3,2] row_mask:0xf bank_mask:0xf
  v_xor_b32_dpp v17, v181, v177 quad_perm:[1,0,3,2] row_mask:0xf bank_mask:0xf
  v_xor_b32_dpp v18, v182, v178 quad_perm:[1,0,3,2] row_mask:0xf bank_mask:0xf
  v_xor_b32_dpp v19, v183, v179 quad_perm:[1,0,3,2] row_mask:0xf bank_mask:0xf
  v_xor_b32_dpp v20, v188, v184 quad_perm:[1,0,3,2] row_mask:0xf bank_mask:0xf
  v_mfma_f32_32x32x16_bf16 v[80:95], v[36:39], v[160:163], v[80:95]
  v_xor_b32_dpp v21, v189, v185 quad_perm:[1,0,3,2] row_mask:0xf bank_mask:0xf
  v_xor_b32_dpp v22, v190, v186 quad_perm:[1,0,3,2] row_mask:0xf bank_mask:0xf
  v_xor_b32_dpp v23, v191, v187 quad_perm:[1,0,3,2] row_mask:0xf bank_mask:0xf
  v_and_b32 v16, v24, v16
  v_and_b32 v17, v24, v17
  ds_read_b64_tr_b16 v[56:57], v6 offset:19456
  ds_read_b64_tr_b16 v[58:59], v6 offset:19968
  ds_read_b64_tr_b16 v[60:61], v7 offset:19456
  ds_read_b64_tr_b16 v[62:63], v7 offset:19968
  s_add_u32 s55, s53, 3
  s_and_b32 s55, s55, 3
  s_mul_i32 s41, s55, 131072
  s_add_u32 s41, s41, s54
  s_lshl_b32 s57, s55, 8
  s_add_u32 s57, s57, s44
  s_lshl_b32 s42, s55, 12
  s_add_u32 s42, s42, s56
  s_mov_b32 m0, s40
  s_add_u32 s40, s40, 1024
  buffer_load_dwordx4 v5, s[12:15], s41 offen lds
  s_add_u32 s41, s41, 8192
  s_mov_b32 m0, s40
  s_add_u32 s40, s40, 1024
  buffer_load_dwordx4 v5, s[12:15], s41 offen lds
  s_add_u32 s41, s41, 8192
  s_waitcnt lgkmcnt(8)
  v_mfma_f32_32x32x16_bf16 v[64:79], v[40:43], v[164:167], v[64:79]
  v_and_b32 v18, v24, v18
  v_and_b32 v19, v24, v19
  v_and_b32 v20, v24, v20
  v_and_b32 v21, v24, v21
  v_and_b32 v22, v24, v22
  v_mfma_f32_32x32x16_bf16 v[80:95], v[44:47], v[164:167], v[80:95]
  v_and_b32 v23, v24, v23
  v_xor_b32 v176, v16, v176
  v_xor_b32 v177, v17, v177
  v_xor_b32 v178, v18, v178
  v_xor_b32 v179, v19, v179
  ds_read_b64_tr_b16 v[32:33], v6 offset:24576
  ds_read_b64_tr_b16 v[34:35], v6 offset:25088
  ds_read_b64_tr_b16 v[36:37], v7 offset:24576
  ds_read_b64_tr_b16 v[38:39], v7 offset:25088
  s_mov_b32 m0, s40
  s_add_u32 s40, s40, 1024
  buffer_load_dwordx4 v5, s[12:15], s41 offen lds
  s_add_u32 s41, s41, 8192
  s_mov_b32 m0, s40
  s_add_u32 s40, s40, 13312
  buffer_load_dwordx4 v5, s[12:15], s41 offen lds
  s_waitcnt lgkmcnt(8)
  v_mfma_f32_32x32x16_bf16 v[64:79], v[48:51], v[168:171], v[64:79]
  v_xor_b32 v184, v20, v184
  v_xor_b32 v185, v21, v185
  v_xor_b32 v186, v22, v186
  v_xor_b32 v187, v23, v187
  v_xor_b32_dpp v180, v16, v180 quad_perm:[1,0,3,2] row_mask:0xf bank_mask:0xf
  v_mfma_f32_32x32x16_bf16 v[80:95], v[52:55], v[168:171], v[80:95]
  v_xor_b32_dpp v181, v17, v181 quad_perm:[1,0,3,2] row_mask:0xf bank_mask:0xf
  v_xor_b32_dpp v182, v18, v182 quad_perm:[1,0,3,2] row_mask:0xf bank_mask:0xf
  v_xor_b32_dpp v183, v19, v183 quad_perm:[1,0,3,2] row_mask:0xf bank_mask:0xf
  v_xor_b32_dpp v188, v20, v188 quad_perm:[1,0,3,2] row_mask:0xf bank_mask:0xf
  v_xor_b32_dpp v189, v21, v189 quad_perm:[1,0,3,2] row_mask:0xf bank_mask:0xf
  ds_read_b64_tr_b16 v[40:41], v6 offset:25600
  ds_read_b64_tr_b16 v[42:43], v6 offset:26112
  ds_read_b64_tr_b16 v[44:45], v7 offset:25600
  ds_read_b64_tr_b16 v[46:47], v7 offset:26112
  s_mov_b32 m0, s43
  s_add_u32 s43, s43, 4096
  buffer_load_dwordx4 v13, s[20:23], s42 offen lds
  s_waitcnt lgkmcnt(8)
  v_mfma_f32_32x32x16_bf16 v[64:79], v[56:59], v[172:175], v[64:79]
  v_xor_b32_dpp v190, v22, v190 quad_perm:[1,0,3,2] row_mask:0xf bank_mask:0xf
  v_xor_b32_dpp v191, v23, v191 quad_perm:[1,0,3,2] row_mask:0xf bank_mask:0xf
  v_permlane16_swap_b32 v176, v184
  v_permlane16_swap_b32 v177, v185
  v_permlane16_swap_b32 v178, v186
  v_mfma_f32_32x32x16_bf16 v[80:95], v[60:63], v[172:175], v[80:95]
  v_permlane16_swap_b32 v179, v187
  v_permlane16_swap_b32 v180, v188
  v_permlane16_swap_b32 v181, v189
  v_permlane16_swap_b32 v182, v190
  v_permlane16_swap_b32 v183, v191
  ds_read_b64_tr_b16 v[48:49], v6 offset:26624
  ds_read_b64_tr_b16 v[50:51], v6 offset:27136
  ds_read_b64_tr_b16 v[52:53], v7 offset:26624
  ds_read_b64_tr_b16 v[54:55], v7 offset:27136
  buffer_load_dwordx4 v[224:227], v4, s[8:11], s57 offen offset:0
  buffer_load_dwordx4 v[228:231], v4, s[8:11], s57 offen offset:1024
  s_waitcnt vmcnt(11)
  s_waitcnt lgkmcnt(8)
  v_mfma_f32_32x32x16_bf16 v[64:79], v[32:35], v[176:179], v[64:79]
  v_xor_b32_dpp v16, v196, v192 quad_perm:[1,0,3,2] row_mask:0xf bank_mask:0xf
  v_xor_b32_dpp v17, v197, v193 quad_perm:[1,0,3,2] row_mask:0xf bank_mask:0xf
  v_xor_b32_dpp v18, v198, v194 quad_perm:[1,0,3,2] row_mask:0xf bank_mask:0xf
  v_xor_b32_dpp v19, v199, v195 quad_perm:[1,0,3,2] row_mask:0xf bank_mask:0xf
  v_xor_b32_dpp v20, v204, v200 quad_perm:[1,0,3,2] row_mask:0xf bank_mask:0xf
  v_mfma_f32_32x32x16_bf16 v[80:95], v[36:39], v[176:179], v[80:95]
  v_xor_b32_dpp v21, v205, v201 quad_perm:[1,0,3,2] row_mask:0xf bank_mask:0xf
  v_xor_b32_dpp v22, v206, v202 quad_perm:[1,0,3,2] row_mask:0xf bank_mask:0xf
  v_xor_b32_dpp v23, v207, v203 quad_perm:[1,0,3,2] row_mask:0xf bank_mask:0xf
  v_and_b32 v16, v24, v16
  v_and_b32 v17, v24, v17
  ds_read_b64_tr_b16 v[56:57], v6 offset:27648
  ds_read_b64_tr_b16 v[58:59], v6 offset:28160
  ds_read_b64_tr_b16 v[60:61], v7 offset:27648
  ds_read_b64_tr_b16 v[62:63], v7 offset:28160
  s_add_u32 s58, s57, 16384
  buffer_load_dwordx4 v[232:235], v4, s[8:11], s58 offen offset:0
  buffer_load_dwordx4 v[236:239], v4, s[8:11], s58 offen offset:1024
  s_waitcnt lgkmcnt(8)
  v_mfma_f32_32x32x16_bf16 v[64:79], v[40:43], v[180:183], v[64:79]
  v_and_b32 v18, v24, v18
  v_and_b32 v19, v24, v19
  v_and_b32 v20, v24, v20
  v_and_b32 v21, v24, v21
  v_and_b32 v22, v24, v22
  v_mfma_f32_32x32x16_bf16 v[80:95], v[44:47], v[180:183], v[80:95]
  v_and_b32 v23, v24, v23
  v_xor_b32 v192, v16, v192
  v_xor_b32 v193, v17, v193
  v_xor_b32 v194, v18, v194
  v_xor_b32 v195, v19, v195
  s_barrier
  ds_read_b64_tr_b16 v[32:33], v6 offset:32768
  ds_read_b64_tr_b16 v[34:35], v6 offset:33280
  ds_read_b64_tr_b16 v[36:37], v7 offset:32768
  ds_read_b64_tr_b16 v[38:39], v7 offset:33280
  buffer_load_dwordx4 v[240:243], v4, s[8:11], s57 offen offset:128
  s_waitcnt lgkmcnt(8)
  v_mfma_f32_32x32x16_bf16 v[64:79], v[48:51], v[184:187], v[64:79]
  v_xor_b32 v200, v20, v200
  v_xor_b32 v201, v21, v201
  v_xor_b32 v202, v22, v202
  v_xor_b32 v203, v23, v203
  v_xor_b32_dpp v196, v16, v196 quad_perm:[1,0,3,2] row_mask:0xf bank_mask:0xf
  v_mfma_f32_32x32x16_bf16 v[80:95], v[52:55], v[184:187], v[80:95]
  v_xor_b32_dpp v197, v17, v197 quad_perm:[1,0,3,2] row_mask:0xf bank_mask:0xf
  v_xor_b32_dpp v198, v18, v198 quad_perm:[1,0,3,2] row_mask:0xf bank_mask:0xf
  v_xor_b32_dpp v199, v19, v199 quad_perm:[1,0,3,2] row_mask:0xf bank_mask:0xf
  v_xor_b32_dpp v204, v20, v204 quad_perm:[1,0,3,2] row_mask:0xf bank_mask:0xf
  v_xor_b32_dpp v205, v21, v205 quad_perm:[1,0,3,2] row_mask:0xf bank_mask:0xf
  ds_read_b64_tr_b16 v[40:41], v6 offset:33792
  ds_read_b64_tr_b16 v[42:43], v6 offset:34304
  ds_read_b64_tr_b16 v[44:45], v7 offset:33792
  ds_read_b64_tr_b16 v[46:47], v7 offset:34304
  buffer_load_dwordx4 v[244:247], v4, s[8:11], s57 offen offset:1152
  buffer_load_dwordx4 v[248:251], v4, s[8:11], s58 offen offset:128
  s_waitcnt lgkmcnt(8)
  v_mfma_f32_32x32x16_bf16 v[64:79], v[56:59], v[188:191], v[64:79]
  v_xor_b32_dpp v206, v22, v206 quad_perm:[1,0,3,2] row_mask:0xf bank_mask:0xf
  v_xor_b32_dpp v207, v23, v207 quad_perm:[1,0,3,2] row_mask:0xf bank_mask:0xf
  v_permlane16_swap_b32 v192, v200
  v_permlane16_swap_b32 v193, v201
  v_permlane16_swap_b32 v194, v202
  v_mfma_f32_32x32x16_bf16 v[80:95], v[60:63], v[188:191], v[80:95]
  v_permlane16_swap_b32 v195, v203
  v_permlane16_swap_b32 v196, v204
  v_permlane16_swap_b32 v197, v205
  v_permlane16_swap_b32 v198, v206
  v_permlane16_swap_b32 v199, v207
  ds_read_b64_tr_b16 v[48:49], v6 offset:34816
  ds_read_b64_tr_b16 v[50:51], v6 offset:35328
  ds_read_b64_tr_b16 v[52:53], v7 offset:34816
  ds_read_b64_tr_b16 v[54:55], v7 offset:35328
  buffer_load_dwordx4 v[252:255], v4, s[8:11], s58 offen offset:1152
  s_waitcnt vmcnt(13)
  s_waitcnt lgkmcnt(8)
  v_mfma_f32_32x32x16_bf16 v[64:79], v[32:35], v[192:195], v[64:79]
  v_xor_b32_dpp v16, v212, v208 quad_perm:[1,0,3,2] row_mask:0xf bank_mask:0xf
  v_xor_b32_dpp v17, v213, v209 quad_perm:[1,0,3,2] row_mask:0xf bank_mask:0xf
  v_xor_b32_dpp v18, v214, v210 quad_perm:[1,0,3,2] row_mask:0xf bank_mask:0xf
  v_xor_b32_dpp v19, v215, v211 quad_perm:[1,0,3,2] row_mask:0xf bank_mask:0xf
  v_xor_b32_dpp v20, v220, v216 quad_perm:[1,0,3,2] row_mask:0xf bank_mask:0xf
  v_mfma_f32_32x32x16_bf16 v[80:95], v[36:39], v[192:195], v[80:95]
  v_xor_b32_dpp v21, v221, v217 quad_perm:[1,0,3,2] row_mask:0xf bank_mask:0xf
  v_xor_b32_dpp v22, v222, v218 quad_perm:[1,0,3,2] row_mask:0xf bank_mask:0xf
  v_xor_b32_dpp v23, v223, v219 quad_perm:[1,0,3,2] row_mask:0xf bank_mask:0xf
  v_and_b32 v16, v24, v16
  v_and_b32 v17, v24, v17
  ds_read_b64_tr_b16 v[56:57], v6 offset:35840
  ds_read_b64_tr_b16 v[58:59], v6 offset:36352
  ds_read_b64_tr_b16 v[60:61], v7 offset:35840
  ds_read_b64_tr_b16 v[62:63], v7 offset:36352
  s_waitcnt lgkmcnt(8)
  v_mfma_f32_32x32x16_bf16 v[64:79], v[40:43], v[196:199], v[64:79]
  v_and_b32 v18, v24, v18
  v_and_b32 v19, v24, v19
  v_and_b32 v20, v24, v20
  v_and_b32 v21, v24, v21
  v_and_b32 v22, v24, v22
  v_mfma_f32_32x32x16_bf16 v[80:95], v[44:47], v[196:199], v[80:95]
  v_and_b32 v23, v24, v23
  v_xor_b32 v208, v16, v208
  v_xor_b32 v209, v17, v209
  v_xor_b32 v210, v18, v210
  v_xor_b32 v211, v19, v211
  ds_read_b64_tr_b16 v[32:33], v6 offset:40960
  ds_read_b64_tr_b16 v[34:35], v6 offset:41472
  ds_read_b64_tr_b16 v[36:37], v7 offset:40960
  ds_read_b64_tr_b16 v[38:39], v7 offset:41472
  s_waitcnt lgkmcnt(8)
  v_mfma_f32_32x32x16_bf16 v[64:79], v[48:51], v[200:203], v[64:79]
  v_xor_b32 v216, v20, v216
  v_xor_b32 v217, v21, v217
  v_xor_b32 v218, v22, v218
  v_xor_b32 v219, v23, v219
  v_xor_b32_dpp v212, v16, v212 quad_perm:[1,0,3,2] row_mask:0xf bank_mask:0xf
  v_mfma_f32_32x32x16_bf16 v[80:95], v[52:55], v[200:203], v[80:95]
  v_xor_b32_dpp v213, v17, v213 quad_perm:[1,0,3,2] row_mask:0xf bank_mask:0xf
  v_xor_b32_dpp v214, v18, v214 quad_perm:[1,0,3,2] row_mask:0xf bank_mask:0xf
  v_xor_b32_dpp v215, v19, v215 quad_perm:[1,0,3,2] row_mask:0xf bank_mask:0xf
  v_xor_b32_dpp v220, v20, v220 quad_perm:[1,0,3,2] row_mask:0xf bank_mask:0xf
  v_xor_b32_dpp v221, v21, v221 quad_perm:[1,0,3,2] row_mask:0xf bank_mask:0xf
  ds_read_b64_tr_b16 v[40:41], v6 offset:41984
  ds_read_b64_tr_b16 v[42:43], v6 offset:42496
  ds_read_b64_tr_b16 v[44:45], v7 offset:41984
  ds_read_b64_tr_b16 v[46:47], v7 offset:42496
  s_waitcnt lgkmcnt(8)
  v_mfma_f32_32x32x16_bf16 v[64:79], v[56:59], v[204:207], v[64:79]
  v_xor_b32_dpp v222, v22, v222 quad_perm:[1,0,3,2] row_mask:0xf bank_mask:0xf
  v_xor_b32_dpp v223, v23, v223 quad_perm:[1,0,3,2] row_mask:0xf bank_mask:0xf
  v_permlane16_swap_b32 v208, v216
  v_permlane16_swap_b32 v209, v217
  v_permlane16_swap_b32 v210, v218
  v_mfma_f32_32x32x16_bf16 v[80:95], v[60:63], v[204:207], v[80:95]
  v_permlane16_swap_b32 v211, v219
  v_permlane16_swap_b32 v212, v220
  v_permlane16_swap_b32 v213, v221
  v_permlane16_swap_b32 v214, v222
  v_permlane16_swap_b32 v215, v223
  ds_read_b64_tr_b16 v[48:49], v6 offset:43008
  ds_read_b64_tr_b16 v[50:51], v6 offset:43520
  ds_read_b64_tr_b16 v[52:53], v7 offset:43008
  ds_read_b64_tr_b16 v[54:55], v7 offset:43520
  s_waitcnt vmcnt(4)
  s_waitcnt lgkmcnt(8)
  v_mfma_f32_32x32x16_bf16 v[64:79], v[32:35], v[208:211], v[64:79]
  v_xor_b32_dpp v16, v228, v224 quad_perm:[1,0,3,2] row_mask:0xf bank_mask:0xf
  v_xor_b32_dpp v17, v229, v225 quad_perm:[1,0,3,2] row_mask:0xf bank_mask:0xf
  v_xor_b32_dpp v18, v230, v226 quad_perm:[1,0,3,2] row_mask:0xf bank_mask:0xf
  v_xor_b32_dpp v19, v231, v227 quad_perm:[1,0,3,2] row_mask:0xf bank_mask:0xf
  v_xor_b32_dpp v20, v236, v232 quad_perm:[1,0,3,2] row_mask:0xf bank_mask:0xf
  v_mfma_f32_32x32x16_bf16 v[80:95], v[36:39], v[208:211], v[80:95]
  v_xor_b32_dpp v21, v237, v233 quad_perm:[1,0,3,2] row_mask:0xf bank_mask:0xf
  v_xor_b32_dpp v22, v238, v234 quad_perm:[1,0,3,2] row_mask:0xf bank_mask:0xf
  v_xor_b32_dpp v23, v239, v235 quad_perm:[1,0,3,2] row_mask:0xf bank_mask:0xf
  v_and_b32 v16, v24, v16
  v_and_b32 v17, v24, v17
  ds_read_b64_tr_b16 v[56:57], v6 offset:44032
  ds_read_b64_tr_b16 v[58:59], v6 offset:44544
  ds_read_b64_tr_b16 v[60:61], v7 offset:44032
  ds_read_b64_tr_b16 v[62:63], v7 offset:44544
  s_waitcnt lgkmcnt(8)
  v_mfma_f32_32x32x16_bf16 v[64:79], v[40:43], v[212:215], v[64:79]
  v_and_b32 v18, v24, v18
  v_and_b32 v19, v24, v19
  v_and_b32 v20, v24, v20
  v_and_b32 v21, v24, v21
  v_and_b32 v22, v24, v22
  v_mfma_f32_32x32x16_bf16 v[80:95], v[44:47], v[212:215], v[80:95]
  v_and_b32 v23, v24, v23
  v_xor_b32 v224, v16, v224
  v_xor_b32 v225, v17, v225
  v_xor_b32 v226, v18, v226
  v_xor_b32 v227, v19, v227
  s_barrier
  ds_read_b64_tr_b16 v[32:33], v6 offset:49152
  ds_read_b64_tr_b16 v[34:35], v6 offset:49664
  ds_read_b64_tr_b16 v[36:37], v7 offset:49152
  ds_read_b64_tr_b16 v[38:39], v7 offset:49664
  s_waitcnt lgkmcnt(8)
  v_mfma_f32_32x32x16_bf16 v[64:79], v[48:51], v[216:219], v[64:79]
  v_xor_b32 v232, v20, v232
  v_xor_b32 v233, v21, v233
  v_xor_b32 v234, v22, v234
  v_xor_b32 v235, v23, v235
  v_xor_b32_dpp v228, v16, v228 quad_perm:[1,0,3,2] row_mask:0xf bank_mask:0xf
  v_mfma_f32_32x32x16_bf16 v[80:95], v[52:55], v[216:219], v[80:95]
  v_xor_b32_dpp v229, v17, v229 quad_perm:[1,0,3,2] row_mask:0xf bank_mask:0xf
  v_xor_b32_dpp v230, v18, v230 quad_perm:[1,0,3,2] row_mask:0xf bank_mask:0xf
  v_xor_b32_dpp v231, v19, v231 quad_perm:[1,0,3,2] row_mask:0xf bank_mask:0xf
  v_xor_b32_dpp v236, v20, v236 quad_perm:[1,0,3,2] row_mask:0xf bank_mask:0xf
  v_xor_b32_dpp v237, v21, v237 quad_perm:[1,0,3,2] row_mask:0xf bank_mask:0xf
  ds_read_b64_tr_b16 v[40:41], v6 offset:50176
  ds_read_b64_tr_b16 v[42:43], v6 offset:50688
  ds_read_b64_tr_b16 v[44:45], v7 offset:50176
  ds_read_b64_tr_b16 v[46:47], v7 offset:50688
  s_waitcnt lgkmcnt(8)
  v_mfma_f32_32x32x16_bf16 v[64:79], v[56:59], v[220:223], v[64:79]
  v_xor_b32_dpp v238, v22, v238 quad_perm:[1,0,3,2] row_mask:0xf bank_mask:0xf
  v_xor_b32_dpp v239, v23, v239 quad_perm:[1,0,3,2] row_mask:0xf bank_mask:0xf
  v_permlane16_swap_b32 v224, v232
  v_permlane16_swap_b32 v225, v233
  v_permlane16_swap_b32 v226, v234
  v_mfma_f32_32x32x16_bf16 v[80:95], v[60:63], v[220:223], v[80:95]
  v_permlane16_swap_b32 v227, v235
  v_permlane16_swap_b32 v228, v236
  v_permlane16_swap_b32 v229, v237
  v_permlane16_swap_b32 v230, v238
  v_permlane16_swap_b32 v231, v239
  ds_read_b64_tr_b16 v[48:49], v6 offset:51200
  ds_read_b64_tr_b16 v[50:51], v6 offset:51712
  ds_read_b64_tr_b16 v[52:53], v7 offset:51200
  ds_read_b64_tr_b16 v[54:55], v7 offset:51712
  s_waitcnt vmcnt(0)
  s_waitcnt lgkmcnt(8)
  v_mfma_f32_32x32x16_bf16 v[64:79], v[32:35], v[224:227], v[64:79]
  v_xor_b32_dpp v16, v244, v240 quad_perm:[1,0,3,2] row_mask:0xf bank_mask:0xf
  v_xor_b32_dpp v17, v245, v241 quad_perm:[1,0,3,2] row_mask:0xf bank_mask:0xf
  v_xor_b32_dpp v18, v246, v242 quad_perm:[1,0,3,2] row_mask:0xf bank_mask:0xf
  v_xor_b32_dpp v19, v247, v243 quad_perm:[1,0,3,2] row_mask:0xf bank_mask:0xf
  v_xor_b32_dpp v20, v252, v248 quad_perm:[1,0,3,2] row_mask:0xf bank_mask:0xf
  v_mfma_f32_32x32x16_bf16 v[80:95], v[36:39], v[224:227], v[80:95]
  v_xor_b32_dpp v21, v253, v249 quad_perm:[1,0,3,2] row_mask:0xf bank_mask:0xf
  v_xor_b32_dpp v22, v254, v250 quad_perm:[1,0,3,2] row_mask:0xf bank_mask:0xf
  v_xor_b32_dpp v23, v255, v251 quad_perm:[1,0,3,2] row_mask:0xf bank_mask:0xf
  v_and_b32 v16, v24, v16
  v_and_b32 v17, v24, v17
  ds_read_b64_tr_b16 v[56:57], v6 offset:52224
  ds_read_b64_tr_b16 v[58:59], v6 offset:52736
  ds_read_b64_tr_b16 v[60:61], v7 offset:52224
  ds_read_b64_tr_b16 v[62:63], v7 offset:52736
  s_waitcnt lgkmcnt(8)
  v_mfma_f32_32x32x16_bf16 v[64:79], v[40:43], v[228:231], v[64:79]
  v_and_b32 v18, v24, v18
  v_and_b32 v19, v24, v19
  v_and_b32 v20, v24, v20
  v_and_b32 v21, v24, v21
  v_and_b32 v22, v24, v22
  v_mfma_f32_32x32x16_bf16 v[80:95], v[44:47], v[228:231], v[80:95]
  v_and_b32 v23, v24, v23
  v_xor_b32 v240, v16, v240
  v_xor_b32 v241, v17, v241
  v_xor_b32 v242, v18, v242
  v_xor_b32 v243, v19, v243
  ds_read_b64_tr_b16 v[32:33], v6 offset:57344
  ds_read_b64_tr_b16 v[34:35], v6 offset:57856
  ds_read_b64_tr_b16 v[36:37], v7 offset:57344
  ds_read_b64_tr_b16 v[38:39], v7 offset:57856
  s_waitcnt lgkmcnt(8)
  v_mfma_f32_32x32x16_bf16 v[64:79], v[48:51], v[232:235], v[64:79]
  v_xor_b32 v248, v20, v248
  v_xor_b32 v249, v21, v249
  v_xor_b32 v250, v22, v250
  v_xor_b32 v251, v23, v251
  v_xor_b32_dpp v244, v16, v244 quad_perm:[1,0,3,2] row_mask:0xf bank_mask:0xf
  v_mfma_f32_32x32x16_bf16 v[80:95], v[52:55], v[232:235], v[80:95]
  v_xor_b32_dpp v245, v17, v245 quad_perm:[1,0,3,2] row_mask:0xf bank_mask:0xf
  v_xor_b32_dpp v246, v18, v246 quad_perm:[1,0,3,2] row_mask:0xf bank_mask:0xf
  v_xor_b32_dpp v247, v19, v247 quad_perm:[1,0,3,2] row_mask:0xf bank_mask:0xf
  v_xor_b32_dpp v252, v20, v252 quad_perm:[1,0,3,2] row_mask:0xf bank_mask:0xf
  v_xor_b32_dpp v253, v21, v253 quad_perm:[1,0,3,2] row_mask:0xf bank_mask:0xf
  ds_read_b64_tr_b16 v[40:41], v6 offset:58368
  ds_read_b64_tr_b16 v[42:43], v6 offset:58880
  ds_read_b64_tr_b16 v[44:45], v7 offset:58368
  ds_read_b64_tr_b16 v[46:47], v7 offset:58880
  s_waitcnt lgkmcnt(8)
  v_mfma_f32_32x32x16_bf16 v[64:79], v[56:59], v[236:239], v[64:79]
  v_xor_b32_dpp v254, v22, v254 quad_perm:[1,0,3,2] row_mask:0xf bank_mask:0xf
  v_xor_b32_dpp v255, v23, v255 quad_perm:[1,0,3,2] row_mask:0xf bank_mask:0xf
  v_permlane16_swap_b32 v240, v248
  v_permlane16_swap_b32 v241, v249
  v_permlane16_swap_b32 v242, v250
  v_mfma_f32_32x32x16_bf16 v[80:95], v[60:63], v[236:239], v[80:95]
  v_permlane16_swap_b32 v243, v251
  v_permlane16_swap_b32 v244, v252
  v_permlane16_swap_b32 v245, v253
  v_permlane16_swap_b32 v246, v254
  v_permlane16_swap_b32 v247, v255
  ds_read_b64_tr_b16 v[48:49], v6 offset:59392
  ds_read_b64_tr_b16 v[50:51], v6 offset:59904
  ds_read_b64_tr_b16 v[52:53], v7 offset:59392
  ds_read_b64_tr_b16 v[54:55], v7 offset:59904
  s_waitcnt lgkmcnt(8)
  v_mfma_f32_32x32x16_bf16 v[64:79], v[32:35], v[240:243], v[64:79]
  v_mfma_f32_32x32x16_bf16 v[80:95], v[36:39], v[240:243], v[80:95]
  ds_read_b64_tr_b16 v[56:57], v6 offset:60416
  ds_read_b64_tr_b16 v[58:59], v6 offset:60928
  ds_read_b64_tr_b16 v[60:61], v7 offset:60416
  ds_read_b64_tr_b16 v[62:63], v7 offset:60928
  s_waitcnt lgkmcnt(8)
  v_mfma_f32_32x32x16_bf16 v[64:79], v[40:43], v[244:247], v[64:79]
  v_mfma_f32_32x32x16_bf16 v[80:95], v[44:47], v[244:247], v[80:95]
  s_waitcnt lgkmcnt(4)
  v_mfma_f32_32x32x16_bf16 v[64:79], v[48:51], v[248:251], v[64:79]
  v_mfma_f32_32x32x16_bf16 v[80:95], v[52:55], v[248:251], v[80:95]
  s_waitcnt lgkmcnt(0)
  v_mfma_f32_32x32x16_bf16 v[64:79], v[56:59], v[252:255], v[64:79]
  v_mfma_f32_32x32x16_bf16 v[80:95], v[60:63], v[252:255], v[80:95]
K1A_epi:
  s_add_u32 s44, s44, s45
  s_mov_b32 s47, 0x3eb8aa3b
  v_and_b32 v11, 14, v1
  v_bfe_u32 v10, v1, 4, 1
  v_lshlrev_b32 v10, 6, v10
  v_lshl_or_b32 v10, v2, 5, v10
  v_lshl_or_b32 v9, v11, 10, v10
  v_and_b32 v10, 1, v1
  v_lshl_or_b32 v9, v10, 4, v9
  v_sub_u32 v12, 0, v10
  s_nop 7
  v_mul_f32 v64, s47, v64
  v_mul_f32 v65, s47, v65
  v_mul_f32 v66, s47, v66
  v_mul_f32 v67, s47, v67
  v_mul_f32 v68, s47, v68
  v_mul_f32 v69, s47, v69
  v_mul_f32 v70, s47, v70
  v_mul_f32 v71, s47, v71
  v_mul_f32 v72, s47, v72
  v_mul_f32 v73, s47, v73
  v_mul_f32 v74, s47, v74
  v_mul_f32 v75, s47, v75
  v_mul_f32 v76, s47, v76
  v_mul_f32 v77, s47, v77
  v_mul_f32 v78, s47, v78
  v_mul_f32 v79, s47, v79
  v_mul_f32 v80, s47, v80
  v_mul_f32 v81, s47, v81
  v_mul_f32 v82, s47, v82
  v_mul_f32 v83, s47, v83
  v_mul_f32 v84, s47, v84
  v_mul_f32 v85, s47, v85
  v_mul_f32 v86, s47, v86
  v_mul_f32 v87, s47, v87
  v_mul_f32 v88, s47, v88
  v_mul_f32 v89, s47, v89
  v_mul_f32 v90, s47, v90
  v_mul_f32 v91, s47, v91
  v_mul_f32 v92, s47, v92
  v_mul_f32 v93, s47, v93
  v_mul_f32 v94, s47, v94
  v_mul_f32 v95, s47, v95
  v_cvt_pk_bf16_f32 v32, v64, v65
  v_cvt_pk_bf16_f32 v33, v66, v67
  v_cvt_pk_bf16_f32 v34, v68, v69
  v_cvt_pk_bf16_f32 v35, v70, v71
  v_cvt_pk_bf16_f32 v36, v72, v73
  v_cvt_pk_bf16_f32 v37, v74, v75
  v_cvt_pk_bf16_f32 v38, v76, v77
  v_cvt_pk_bf16_f32 v39, v78, v79
  v_cvt_pk_bf16_f32 v40, v80, v81
  v_cvt_pk_bf16_f32 v41, v82, v83
  v_cvt_pk_bf16_f32 v42, v84, v85
  v_cvt_pk_bf16_f32 v43, v86, v87
  v_cvt_pk_bf16_f32 v44, v88, v89
  v_cvt_pk_bf16_f32 v45, v90, v91
  v_cvt_pk_bf16_f32 v46, v92, v93
  v_cvt_pk_bf16_f32 v47, v94, v95
  s_nop 1
  v_permlane32_swap_b32 v32, v36
  v_permlane32_swap_b32 v33, v37
  v_permlane32_swap_b32 v34, v38
  v_permlane32_swap_b32 v35, v39
  v_permlane32_swap_b32 v40, v44
  v_permlane32_swap_b32 v41, v45
  v_permlane32_swap_b32 v42, v46
  v_permlane32_swap_b32 v43, v47
  s_nop 1
  v_xor_b32_dpp v48, v36, v32 quad_perm:[1,0,3,2] row_mask:0xf bank_mask:0xf
  v_xor_b32_dpp v49, v37, v33 quad_perm:[1,0,3,2] row_mask:0xf bank_mask:0xf
  v_xor_b32_dpp v50, v38, v34 quad_perm:[1,0,3,2] row_mask:0xf bank_mask:0xf
  v_xor_b32_dpp v51, v39, v35 quad_perm:[1,0,3,2] row_mask:0xf bank_mask:0xf
  v_xor_b32_dpp v52, v44, v40 quad_perm:[1,0,3,2] row_mask:0xf bank_mask:0xf
  v_xor_b32_dpp v53, v45, v41 quad_perm:[1,0,3,2] row_mask:0xf bank_mask:0xf
  v_xor_b32_dpp v54, v46, v42 quad_perm:[1,0,3,2] row_mask:0xf bank_mask:0xf
  v_xor_b32_dpp v55, v47, v43 quad_perm:[1,0,3,2] row_mask:0xf bank_mask:0xf
  v_and_b32 v48, v12, v48
  v_and_b32 v49, v12, v49
  v_and_b32 v50, v12, v50
  v_and_b32 v51, v12, v51
  v_and_b32 v52, v12, v52
  v_and_b32 v53, v12, v53
  v_and_b32 v54, v12, v54
  v_and_b32 v55, v12, v55
  v_xor_b32 v32, v48, v32
  v_xor_b32 v33, v49, v33
  v_xor_b32 v34, v50, v34
  v_xor_b32 v35, v51, v35
  v_xor_b32 v40, v52, v40
  v_xor_b32 v41, v53, v41
  v_xor_b32 v42, v54, v42
  v_xor_b32 v43, v55, v43
  v_xor_b32_dpp v36, v48, v36 quad_perm:[1,0,3,2] row_mask:0xf bank_mask:0xf
  v_xor_b32_dpp v37, v49, v37 quad_perm:[1,0,3,2] row_mask:0xf bank_mask:0xf
  v_xor_b32_dpp v38, v50, v38 quad_perm:[1,0,3,2] row_mask:0xf bank_mask:0xf
  v_xor_b32_dpp v39, v51, v39 quad_perm:[1,0,3,2] row_mask:0xf bank_mask:0xf
  v_xor_b32_dpp v44, v52, v44 quad_perm:[1,0,3,2] row_mask:0xf bank_mask:0xf
  v_xor_b32_dpp v45, v53, v45 quad_perm:[1,0,3,2] row_mask:0xf bank_mask:0xf
  v_xor_b32_dpp v46, v54, v46 quad_perm:[1,0,3,2] row_mask:0xf bank_mask:0xf
  v_xor_b32_dpp v47, v55, v47 quad_perm:[1,0,3,2] row_mask:0xf bank_mask:0xf
  v_permlane16_swap_b32 v32, v40
  v_permlane16_swap_b32 v33, v41
  v_permlane16_swap_b32 v34, v42
  v_permlane16_swap_b32 v35, v43
  v_permlane16_swap_b32 v36, v44
  v_permlane16_swap_b32 v37, v45
  v_permlane16_swap_b32 v38, v46
  v_permlane16_swap_b32 v39, v47
  buffer_store_dwordx4 v[32:35], v9, s[16:19], s44 offen sc0 sc1
  s_add_u32 s44, s44, 1024
  buffer_store_dwordx4 v[36:39], v9, s[16:19], s44 offen sc0 sc1
  s_add_u32 s44, s44, 15360
  buffer_store_dwordx4 v[40:43], v9, s[16:19], s44 offen sc0 sc1
  s_add_u32 s44, s44, 1024
  buffer_store_dwordx4 v[44:47], v9, s[16:19], s44 offen sc0 sc1
  s_endpgm
K1_b:
  s_mov_b32 s8, s72
  s_mov_b32 s9, s73
  s_mov_b32 s10, 2097152
  s_mov_b32 s11, 0x00020000
  s_add_u32 s16, s78, 3145728
  s_addc_u32 s17, s79, 0
  s_mov_b32 s18, 2097152
  s_mov_b32 s19, 0x00020000
  s_mov_b32 s12, s80
  s_mov_b32 s13, s81
  s_mov_b32 s14, 1052672
  s_mov_b32 s15, 0x00020000
  s_mov_b32 s20, s82
  s_mov_b32 s21, s83
  s_mov_b32 s22, 1052672
  s_mov_b32 s23, 0x00020000
  s_add_u32 s24, s78, 13631488
  s_addc_u32 s25, s79, 0
  s_mov_b32 s26, 2105344
  s_mov_b32 s27, 0x00020000
  s_lshl_b32 s7, s4, 3
  s_add_u32 s7, s7, s5
  s_and_b32 s59, s7, 1
  s_bfe_u32 s50, s7, 0x30001
  s_lshr_b32 s51, s7, 4
  s_lshl_b32 s52, s51, 7
  s_lshl_b32 s7, s50, 2
  s_add_u32 s52, s52, s7
  s_add_u32 s52, s52, s3
  s_mul_i32 s52, s52, 1028
  s_lshl_b32 s7, s59, 8
  v_lshl_add_u32 v58, v1, 1, s7
  v_and_b32 v59, 3, v1
  v_lshrrev_b32 v57, 2, v1
  v_lshl_or_b32 v59, v59, 6, v57
  v_mul_u32_u24 v59, 514, v59
  s_add_u32 s7, s52, 0
  buffer_load_ushort v20, v58, s[12:15], s7 offen offset:0
  buffer_load_ushort v64, v58, s[20:23], s7 offen offset:0
  buffer_load_ushort v24, v58, s[12:15], s7 offen offset:128
  buffer_load_ushort v68, v58, s[20:23], s7 offen offset:128
  s_add_u32 s7, s52, 32896
  buffer_load_ushort v21, v58, s[12:15], s7 offen offset:0
  buffer_load_ushort v65, v58, s[20:23], s7 offen offset:0
  buffer_load_ushort v25, v58, s[12:15], s7 offen offset:128
  buffer_load_ushort v69, v58, s[20:23], s7 offen offset:128
  s_add_u32 s7, s52, 65792
  buffer_load_ushort v22, v58, s[12:15], s7 offen offset:0
  buffer_load_ushort v66, v58, s[20:23], s7 offen offset:0
  buffer_load_ushort v26, v58, s[12:15], s7 offen offset:128
  buffer_load_ushort v70, v58, s[20:23], s7 offen offset:128
  s_add_u32 s7, s52, 98688
  buffer_load_ushort v23, v58, s[12:15], s7 offen offset:0
  buffer_load_ushort v67, v58, s[20:23], s7 offen offset:0
  buffer_load_ushort v27, v58, s[12:15], s7 offen offset:128
  buffer_load_ushort v71, v58, s[20:23], s7 offen offset:128
  s_add_u32 s7, s52, 514
  buffer_load_ushort v28, v58, s[12:15], s7 offen offset:0
  buffer_load_ushort v72, v58, s[20:23], s7 offen offset:0
  buffer_load_ushort v60, v58, s[12:15], s7 offen offset:128
  buffer_load_ushort v76, v58, s[20:23], s7 offen offset:128
  s_add_u32 s7, s52, 33410
  buffer_load_ushort v29, v58, s[12:15], s7 offen offset:0
  buffer_load_ushort v73, v58, s[20:23], s7 offen offset:0
  buffer_load_ushort v61, v58, s[12:15], s7 offen offset:128
  buffer_load_ushort v77, v58, s[20:23], s7 offen offset:128
  s_add_u32 s7, s52, 66306
  buffer_load_ushort v30, v58, s[12:15], s7 offen offset:0
  buffer_load_ushort v74, v58, s[20:23], s7 offen offset:0
  buffer_load_ushort v62, v58, s[12:15], s7 offen offset:128
  buffer_load_ushort v78, v58, s[20:23], s7 offen offset:128
  s_add_u32 s7, s52, 99202
  buffer_load_ushort v31, v58, s[12:15], s7 offen offset:0
  buffer_load_ushort v75, v58, s[20:23], s7 offen offset:0
  buffer_load_ushort v63, v58, s[12:15], s7 offen offset:128
  buffer_load_ushort v79, v58, s[20:23], s7 offen offset:128
  s_mov_b64 exec, 0xff
  buffer_load_ushort v56, v59, s[12:15], s52 offen offset:512
  buffer_load_ushort v80, v59, s[20:23], s52 offen offset:512
  s_mov_b64 exec, -1
  s_lshr_b32 s52, s50, 1
  s_lshl_b32 s52, s52, 11
  s_and_b32 s50, s50, 1
  s_lshl_b32 s50, s50, 7
  s_add_u32 s52, s52, s50
  s_lshl_b32 s51, s51, 8
  s_add_u32 s52, s52, s51
  s_lshl_b32 s51, s3, 5
  s_add_u32 s51, s51, s52
  s_add_u32 s51, s51, 2097152
  s_lshl_b32 s59, s59, 20
  s_add_u32 s52, s52, s59
  s_lshl_b32 s59, s3, 18
  s_add_u32 s52, s52, s59
  v_and_b32 v11, 14, v1
  v_lshrrev_b32 v10, 1, v11
  v_xor_b32 v10, v10, v11
  v_and_b32 v10, 4, v10
  v_lshl_or_b32 v12, v10, 1, v10
  v_xor_b32 v12, v12, v11
  v_mov_b32 v11, v12
  v_lshrrev_b32 v10, 4, v1
  v_lshlrev_b32 v10, 5, v10
  v_lshl_or_b32 v4, v11, 15, v10
  v_and_b32 v10, 1, v1
  v_lshl_or_b32 v4, v10, 4, v4
  s_lshl_b32 s6, s4, 2
  s_add_u32 s6, s6, s3
  s_and_b32 s44, s6, 1
  s_lshl_b32 s44, s44, 20
  s_lshr_b32 s45, s6, 1
  s_lshl_b32 s45, s45, 10
  s_add_u32 s44, s44, s45
  s_lshl_b32 s53, s5, 1
  s_and_b32 s53, s53, 0
  s_add_u32 s57, s53, 0
  s_and_b32 s57, s57, 7
  s_lshl_b32 s57, s57, 6
  s_add_u32 s57, s57, s44
  s_add_u32 s55, s57, 0
  buffer_load_dwordx4 v[128:131], v4, s[8:11], s55 offen offset:0
  s_add_u32 s55, s57, 32768
  buffer_load_dwordx4 v[132:135], v4, s[8:11], s55 offen offset:0
  s_add_u32 s55, s57, 524288
  buffer_load_dwordx4 v[136:139], v4, s[8:11], s55 offen offset:0
  s_add_u32 s55, s57, 557056
  buffer_load_dwordx4 v[140:143], v4, s[8:11], s55 offen offset:0
  s_add_u32 s55, s57, 0
  buffer_load_dwordx4 v[192:195], v4, s[8:11], s55 offen offset:512
  s_add_u32 s55, s57, 32768
  buffer_load_dwordx4 v[196:199], v4, s[8:11], s55 offen offset:512
  s_add_u32 s55, s57, 524288
  buffer_load_dwordx4 v[200:203], v4, s[8:11], s55 offen offset:512
  s_add_u32 s55, s57, 557056
  buffer_load_dwordx4 v[204:207], v4, s[8:11], s55 offen offset:512
  s_lshl_b32 s7, s5, 6
  s_add_u32 s7, s7, 0
  v_add_u32 v10, s7, v3
  v_lshrrev_b32 v11, 1, v10
  v_and_b32 v12, 1, v10
  v_cmp_eq_u32 vcc, 1, v10
  v_mov_b32 v13, 0x100
  v_cvt_f32_u32 v12, v12
  v_cndmask_b32 v11, v11, v13, vcc
  v_mul_f32 v12, 0x3e800000, v12
  v_cndmask_b32 v16, v12, 0, vcc
  v_cvt_f32_u32 v14, v11
  v_mul_f32 v14, 0x3b000000, v14
  v_lshlrev_b32 v11, 31, v11
  v_or_b32 v18, 1.0, v11
  s_lshl_b32 s7, s5, 6
  s_add_u32 s7, s7, 32
  v_add_u32 v10, s7, v3
  v_lshrrev_b32 v11, 1, v10
  v_and_b32 v12, 1, v10
  v_cmp_eq_u32 vcc, 1, v10
  v_mov_b32 v13, 0x100
  v_cvt_f32_u32 v12, v12
  v_cndmask_b32 v11, v11, v13, vcc
  v_mul_f32 v12, 0x3e800000, v12
  v_cndmask_b32 v17, v12, 0, vcc
  v_cvt_f32_u32 v15, v11
  v_mul_f32 v15, 0x3b000000, v15
  v_lshlrev_b32 v11, 31, v11
  v_or_b32 v19, 1.0, v11
  s_lshl_b32 s56, s53, 1
  s_add_u32 s56, s56, s3
  s_lshl_b32 s7, s3, 11
  v_lshl_add_u32 v7, v1, 4, s7
  v_lshlrev_b32 v6, 4, v1
  s_add_u32 s7, s56, 0
  s_and_b32 s58, s7, 3
  s_and_b32 s7, s7, 12
  s_lshl_b32 s7, s7, 1
  s_add_u32 s7, s7, s58
  s_lshl_b32 s7, s7, 3
  v_lshl_add_u32 v0, v2, 5, s7
  v_cvt_f32_u32 v0, v0
  v_fma_f32 v8, v14, v0, v16
  v_fract_f32 v8, v8
  v_cos_f32 v32, v8
  v_fma_f32 v33, v14, 1.0, v8
  v_cos_f32 v33, v33
  v_fma_f32 v34, v14, 2.0, v8
  v_cos_f32 v34, v34
  s_mov_b32 s60, 0x40400000
  v_fma_f32 v35, v14, s60, v8
  v_cos_f32 v35, v35
  v_fma_f32 v36, v14, 4.0, v8
  v_cos_f32 v36, v36
  s_mov_b32 s60, 0x40a00000
  v_fma_f32 v37, v14, s60, v8
  v_cos_f32 v37, v37
  s_mov_b32 s60, 0x40c00000
  v_fma_f32 v38, v14, s60, v8
  v_cos_f32 v38, v38
  s_mov_b32 s60, 0x40e00000
  v_fma_f32 v39, v14, s60, v8
  v_cos_f32 v39, v39
  s_nop 0
  v_cvt_pk_bf16_f32 v40, v32, v33
  v_cvt_pk_bf16_f32 v41, v34, v35
  v_cvt_pk_bf16_f32 v42, v36, v37
  v_cvt_pk_bf16_f32 v43, v38, v39
  ds_write_b128 v7, v[40:43] offset:0
  s_add_u32 s57, s53, 2
  s_and_b32 s57, s57, 7
  s_lshl_b32 s57, s57, 6
  s_add_u32 s57, s57, s44
  s_add_u32 s55, s57, 0
  buffer_load_dwordx4 v[144:147], v4, s[8:11], s55 offen offset:0
  s_add_u32 s55, s57, 32768
  buffer_load_dwordx4 v[148:151], v4, s[8:11], s55 offen offset:0
  v_fma_f32 v8, v15, v0, v17
  v_fract_f32 v8, v8
  v_cos_f32 v44, v8
  v_fma_f32 v45, v15, 1.0, v8
  v_cos_f32 v45, v45
  v_fma_f32 v46, v15, 2.0, v8
  v_cos_f32 v46, v46
  s_mov_b32 s60, 0x40400000
  v_fma_f32 v47, v15, s60, v8
  v_cos_f32 v47, v47
  v_fma_f32 v48, v15, 4.0, v8
  v_cos_f32 v48, v48
  s_mov_b32 s60, 0x40a00000
  v_fma_f32 v49, v15, s60, v8
  v_cos_f32 v49, v49
  s_mov_b32 s60, 0x40c00000
  v_fma_f32 v50, v15, s60, v8
  v_cos_f32 v50, v50
  s_mov_b32 s60, 0x40e00000
  v_fma_f32 v51, v15, s60, v8
  v_cos_f32 v51, v51
  s_nop 0
  v_cvt_pk_bf16_f32 v52, v44, v45
  v_cvt_pk_bf16_f32 v53, v46, v47
  v_cvt_pk_bf16_f32 v54, v48, v49
  v_cvt_pk_bf16_f32 v55, v50, v51
  ds_write_b128 v7, v[52:55] offset:1024
  s_add_u32 s55, s57, 524288
  buffer_load_dwordx4 v[152:155], v4, s[8:11], s55 offen offset:0
  s_add_u32 s55, s57, 557056
  buffer_load_dwordx4 v[156:159], v4, s[8:11], s55 offen offset:0
  s_add_u32 s7, s56, 4
  s_and_b32 s58, s7, 3
  s_and_b32 s7, s7, 12
  s_lshl_b32 s7, s7, 1
  s_add_u32 s7, s7, s58
  s_lshl_b32 s7, s7, 3
  v_lshl_add_u32 v0, v2, 5, s7
  v_cvt_f32_u32 v0, v0
  v_fma_f32 v8, v14, v0, v16
  v_fract_f32 v8, v8
  v_cos_f32 v32, v8
  v_fma_f32 v33, v14, 1.0, v8
  v_cos_f32 v33, v33
  v_fma_f32 v34, v14, 2.0, v8
  v_cos_f32 v34, v34
  s_mov_b32 s60, 0x40400000
  v_fma_f32 v35, v14, s60, v8
  v_cos_f32 v35, v35
  v_fma_f32 v36, v14, 4.0, v8
  v_cos_f32 v36, v36
  s_mov_b32 s60, 0x40a00000
  v_fma_f32 v37, v14, s60, v8
  v_cos_f32 v37, v37
  s_mov_b32 s60, 0x40c00000
  v_fma_f32 v38, v14, s60, v8
  v_cos_f32 v38, v38
  s_mov_b32 s60, 0x40e00000
  v_fma_f32 v39, v14, s60, v8
  v_cos_f32 v39, v39
  s_nop 0
  v_cvt_pk_bf16_f32 v40, v32, v33
  v_cvt_pk_bf16_f32 v41, v34, v35
  v_cvt_pk_bf16_f32 v42, v36, v37
  v_cvt_pk_bf16_f32 v43, v38, v39
  ds_write_b128 v7, v[40:43] offset:8192
  s_add_u32 s55, s57, 0
  buffer_load_dwordx4 v[208:211], v4, s[8:11], s55 offen offset:512
  s_add_u32 s55, s57, 32768
  buffer_load_dwordx4 v[212:215], v4, s[8:11], s55 offen offset:512
  v_fma_f32 v8, v15, v0, v17
  v_fract_f32 v8, v8
  v_cos_f32 v44, v8
  v_fma_f32 v45, v15, 1.0, v8
  v_cos_f32 v45, v45
  v_fma_f32 v46, v15, 2.0, v8
  v_cos_f32 v46, v46
  s_mov_b32 s60, 0x40400000
  v_fma_f32 v47, v15, s60, v8
  v_cos_f32 v47, v47
  v_fma_f32 v48, v15, 4.0, v8
  v_cos_f32 v48, v48
  s_mov_b32 s60, 0x40a00000
  v_fma_f32 v49, v15, s60, v8
  v_cos_f32 v49, v49
  s_mov_b32 s60, 0x40c00000
  v_fma_f32 v50, v15, s60, v8
  v_cos_f32 v50, v50
  s_mov_b32 s60, 0x40e00000
  v_fma_f32 v51, v15, s60, v8
  v_cos_f32 v51, v51
  s_nop 0
  v_cvt_pk_bf16_f32 v52, v44, v45
  v_cvt_pk_bf16_f32 v53, v46, v47
  v_cvt_pk_bf16_f32 v54, v48, v49
  v_cvt_pk_bf16_f32 v55, v50, v51
  ds_write_b128 v7, v[52:55] offset:9216
  s_add_u32 s55, s57, 524288
  buffer_load_dwordx4 v[216:219], v4, s[8:11], s55 offen offset:512
  s_add_u32 s55, s57, 557056
  buffer_load_dwordx4 v[220:223], v4, s[8:11], s55 offen offset:512
  s_add_u32 s7, s56, 8
  s_and_b32 s58, s7, 3
  s_and_b32 s7, s7, 12
  s_lshl_b32 s7, s7, 1
  s_add_u32 s7, s7, s58
  s_lshl_b32 s7, s7, 3
  v_lshl_add_u32 v0, v2, 5, s7
  v_cvt_f32_u32 v0, v0
  v_fma_f32 v8, v14, v0, v16
  v_fract_f32 v8, v8
  v_cos_f32 v32, v8
  v_fma_f32 v33, v14, 1.0, v8
  v_cos_f32 v33, v33
  v_fma_f32 v34, v14, 2.0, v8
  v_cos_f32 v34, v34
  s_mov_b32 s60, 0x40400000
  v_fma_f32 v35, v14, s60, v8
  v_cos_f32 v35, v35
  v_fma_f32 v36, v14, 4.0, v8
  v_cos_f32 v36, v36
  s_mov_b32 s60, 0x40a00000
  v_fma_f32 v37, v14, s60, v8
  v_cos_f32 v37, v37
  s_mov_b32 s60, 0x40c00000
  v_fma_f32 v38, v14, s60, v8
  v_cos_f32 v38, v38
  s_mov_b32 s60, 0x40e00000
  v_fma_f32 v39, v14, s60, v8
  v_cos_f32 v39, v39
  s_nop 0
  v_cvt_pk_bf16_f32 v40, v32, v33
  v_cvt_pk_bf16_f32 v41, v34, v35
  v_cvt_pk_bf16_f32 v42, v36, v37
  v_cvt_pk_bf16_f32 v43, v38, v39
  ds_write_b128 v7, v[40:43] offset:16384
  s_add_u32 s57, s53, 4
  s_and_b32 s57, s57, 7
  s_lshl_b32 s57, s57, 6
  s_add_u32 s57, s57, s44
  s_add_u32 s55, s57, 0
  buffer_load_dwordx4 v[160:163], v4, s[8:11], s55 offen offset:0
  s_add_u32 s55, s57, 32768
  buffer_load_dwordx4 v[164:167], v4, s[8:11], s55 offen offset:0
  v_fma_f32 v8, v15, v0, v17
  v_fract_f32 v8, v8
  v_cos_f32 v44, v8
  v_fma_f32 v45, v15, 1.0, v8
  v_cos_f32 v45, v45
  v_fma_f32 v46, v15, 2.0, v8
  v_cos_f32 v46, v46
  s_mov_b32 s60, 0x40400000
  v_fma_f32 v47, v15, s60, v8
  v_cos_f32 v47, v47
  v_fma_f32 v48, v15, 4.0, v8
  v_cos_f32 v48, v48
  s_mov_b32 s60, 0x40a00000
  v_fma_f32 v49, v15, s60, v8
  v_cos_f32 v49, v49
  s_mov_b32 s60, 0x40c00000
  v_fma_f32 v50, v15, s60, v8
  v_cos_f32 v50, v50
  s_mov_b32 s60, 0x40e00000
  v_fma_f32 v51, v15, s60, v8
  v_cos_f32 v51, v51
  s_nop 0
  v_cvt_pk_bf16_f32 v52, v44, v45
  v_cvt_pk_bf16_f32 v53, v46, v47
  v_cvt_pk_bf16_f32 v54, v48, v49
  v_cvt_pk_bf16_f32 v55, v50, v51
  ds_write_b128 v7, v[52:55] offset:17408
  s_add_u32 s55, s57, 524288
  buffer_load_dwordx4 v[168:171], v4, s[8:11], s55 offen offset:0
  s_add_u32 s55, s57, 557056
  buffer_load_dwordx4 v[172:175], v4, s[8:11], s55 offen offset:0
  s_add_u32 s7, s56, 12
  s_and_b32 s58, s7, 3
  s_and_b32 s7, s7, 12
  s_lshl_b32 s7, s7, 1
  s_add_u32 s7, s7, s58
  s_lshl_b32 s7, s7, 3
  v_lshl_add_u32 v0, v2, 5, s7
  v_cvt_f32_u32 v0, v0
  v_fma_f32 v8, v14, v0, v16
  v_fract_f32 v8, v8
  v_cos_f32 v32, v8
  v_fma_f32 v33, v14, 1.0, v8
  v_cos_f32 v33, v33
  v_fma_f32 v34, v14, 2.0, v8
  v_cos_f32 v34, v34
  s_mov_b32 s60, 0x40400000
  v_fma_f32 v35, v14, s60, v8
  v_cos_f32 v35, v35
  v_fma_f32 v36, v14, 4.0, v8
  v_cos_f32 v36, v36
  s_mov_b32 s60, 0x40a00000
  v_fma_f32 v37, v14, s60, v8
  v_cos_f32 v37, v37
  s_mov_b32 s60, 0x40c00000
  v_fma_f32 v38, v14, s60, v8
  v_cos_f32 v38, v38
  s_mov_b32 s60, 0x40e00000
  v_fma_f32 v39, v14, s60, v8
  v_cos_f32 v39, v39
  s_nop 0
  v_cvt_pk_bf16_f32 v40, v32, v33
  v_cvt_pk_bf16_f32 v41, v34, v35
  v_cvt_pk_bf16_f32 v42, v36, v37
  v_cvt_pk_bf16_f32 v43, v38, v39
  ds_write_b128 v7, v[40:43] offset:24576
  s_add_u32 s55, s57, 0
  buffer_load_dwordx4 v[224:227], v4, s[8:11], s55 offen offset:512
  s_add_u32 s55, s57, 32768
  buffer_load_dwordx4 v[228:231], v4, s[8:11], s55 offen offset:512
  v_fma_f32 v8, v15, v0, v17
  v_fract_f32 v8, v8
  v_cos_f32 v44, v8
  v_fma_f32 v45, v15, 1.0, v8
  v_cos_f32 v45, v45
  v_fma_f32 v46, v15, 2.0, v8
  v_cos_f32 v46, v46
  s_mov_b32 s60, 0x40400000
  v_fma_f32 v47, v15, s60, v8
  v_cos_f32 v47, v47
  v_fma_f32 v48, v15, 4.0, v8
  v_cos_f32 v48, v48
  s_mov_b32 s60, 0x40a00000
  v_fma_f32 v49, v15, s60, v8
  v_cos_f32 v49, v49
  s_mov_b32 s60, 0x40c00000
  v_fma_f32 v50, v15, s60, v8
  v_cos_f32 v50, v50
  s_mov_b32 s60, 0x40e00000
  v_fma_f32 v51, v15, s60, v8
  v_cos_f32 v51, v51
  s_nop 0
  v_cvt_pk_bf16_f32 v52, v44, v45
  v_cvt_pk_bf16_f32 v53, v46, v47
  v_cvt_pk_bf16_f32 v54, v48, v49
  v_cvt_pk_bf16_f32 v55, v50, v51
  ds_write_b128 v7, v[52:55] offset:25600
  s_add_u32 s55, s57, 524288
  buffer_load_dwordx4 v[232:235], v4, s[8:11], s55 offen offset:512
  s_add_u32 s55, s57, 557056
  buffer_load_dwordx4 v[236:239], v4, s[8:11], s55 offen offset:512
  s_waitcnt vmcnt(24)
  v_lshl_or_b32 v20, v64, 16, v20
  v_lshl_or_b32 v21, v65, 16, v21
  v_lshl_or_b32 v22, v66, 16, v22
  v_lshl_or_b32 v23, v67, 16, v23
  v_lshl_or_b32 v24, v68, 16, v24
  v_lshl_or_b32 v25, v69, 16, v25
  v_lshl_or_b32 v26, v70, 16, v26
  v_lshl_or_b32 v27, v71, 16, v27
  v_lshl_or_b32 v28, v72, 16, v28
  v_lshl_or_b32 v29, v73, 16, v29
  v_lshl_or_b32 v30, v74, 16, v30
  v_lshl_or_b32 v31, v75, 16, v31
  v_lshl_or_b32 v60, v76, 16, v60
  v_lshl_or_b32 v61, v77, 16, v61
  v_lshl_or_b32 v62, v78, 16, v62
  v_lshl_or_b32 v63, v79, 16, v63
  v_lshl_or_b32 v56, v80, 16, v56
  s_lshl_b32 s7, s3, 1
  v_and_b32 v57, 7, v1
  v_xor_b32 v58, s7, v57
  v_lshlrev_b32 v58, 4, v58
  v_lshl_or_b32 v58, v1, 7, v58
  v_xor_b32 v59, 16, v58
  ds_write_b128 v58, v[20:23] offset:32768
  ds_write_b128 v58, v[24:27] offset:40960
  ds_write_b128 v59, v[28:31] offset:32768
  ds_write_b128 v59, v[60:63] offset:40960
  v_lshrrev_b32 v58, 3, v1
  v_xor_b32 v59, v58, v57
  v_lshlrev_b32 v59, 4, v59
  v_lshl_or_b32 v59, v58, 7, v59
  s_lshl_b32 s7, s3, 12
  v_add_u32 v59, s7, v59
  v_lshlrev_b32 v57, 4, v57
  v_lshl_or_b32 v57, v58, 13, v57
  s_waitcnt lgkmcnt(0)
  s_barrier
  ds_read_b128 v[20:23], v59 offset:32768
  ds_read_b128 v[24:27], v59 offset:33792
  ds_read_b128 v[28:31], v59 offset:34816
  ds_read_b128 v[60:63], v59 offset:35840
  ds_read_b128 v[32:35], v6 offset:0
  ds_read_b128 v[36:39], v6 offset:1024
  ds_read_b128 v[40:43], v6 offset:2048
  ds_read_b128 v[44:47], v6 offset:3072
  v_and_b32 v8, 1, v1
  v_sub_u32 v8, 0, v8
  s_waitcnt vmcnt(20)
  v_xor_b32_dpp v10, v132, v128 quad_perm:[1,0,3,2] row_mask:0xf bank_mask:0xf
  v_xor_b32_dpp v11, v133, v129 quad_perm:[1,0,3,2] row_mask:0xf bank_mask:0xf
  v_xor_b32_dpp v12, v134, v130 quad_perm:[1,0,3,2] row_mask:0xf bank_mask:0xf
  v_xor_b32_dpp v13, v135, v131 quad_perm:[1,0,3,2] row_mask:0xf bank_mask:0xf
  v_xor_b32_dpp v14, v140, v136 quad_perm:[1,0,3,2] row_mask:0xf bank_mask:0xf
  v_xor_b32_dpp v15, v141, v137 quad_perm:[1,0,3,2] row_mask:0xf bank_mask:0xf
  v_xor_b32_dpp v16, v142, v138 quad_perm:[1,0,3,2] row_mask:0xf bank_mask:0xf
  v_xor_b32_dpp v17, v143, v139 quad_perm:[1,0,3,2] row_mask:0xf bank_mask:0xf
  v_and_b32 v10, v8, v10
  v_and_b32 v11, v8, v11
  v_and_b32 v12, v8, v12
  v_and_b32 v13, v8, v13
  v_and_b32 v14, v8, v14
  v_and_b32 v15, v8, v15
  v_and_b32 v16, v8, v16
  v_and_b32 v17, v8, v17
  v_xor_b32 v128, v10, v128
  v_xor_b32 v129, v11, v129
  v_xor_b32 v130, v12, v130
  v_xor_b32 v131, v13, v131
  v_xor_b32 v136, v14, v136
  v_xor_b32 v137, v15, v137
  v_xor_b32 v138, v16, v138
  v_xor_b32 v139, v17, v139
  v_xor_b32_dpp v132, v10, v132 quad_perm:[1,0,3,2] row_mask:0xf bank_mask:0xf
  v_xor_b32_dpp v133, v11, v133 quad_perm:[1,0,3,2] row_mask:0xf bank_mask:0xf
  v_xor_b32_dpp v134, v12, v134 quad_perm:[1,0,3,2] row_mask:0xf bank_mask:0xf
  v_xor_b32_dpp v135, v13, v135 quad_perm:[1,0,3,2] row_mask:0xf bank_mask:0xf
  v_xor_b32_dpp v140, v14, v140 quad_perm:[1,0,3,2] row_mask:0xf bank_mask:0xf
  v_xor_b32_dpp v141, v15, v141 quad_perm:[1,0,3,2] row_mask:0xf bank_mask:0xf
  v_xor_b32_dpp v142, v16, v142 quad_perm:[1,0,3,2] row_mask:0xf bank_mask:0xf
  v_xor_b32_dpp v143, v17, v143 quad_perm:[1,0,3,2] row_mask:0xf bank_mask:0xf
  v_permlane16_swap_b32 v128, v136
  v_permlane16_swap_b32 v129, v137
  v_permlane16_swap_b32 v130, v138
  v_permlane16_swap_b32 v131, v139
  v_permlane16_swap_b32 v132, v140
  v_permlane16_swap_b32 v133, v141
  v_permlane16_swap_b32 v134, v142
  v_permlane16_swap_b32 v135, v143
  s_waitcnt vmcnt(16)
  v_xor_b32_dpp v10, v196, v192 quad_perm:[1,0,3,2] row_mask:0xf bank_mask:0xf
  v_xor_b32_dpp v11, v197, v193 quad_perm:[1,0,3,2] row_mask:0xf bank_mask:0xf
  v_xor_b32_dpp v12, v198, v194 quad_perm:[1,0,3,2] row_mask:0xf bank_mask:0xf
  v_xor_b32_dpp v13, v199, v195 quad_perm:[1,0,3,2] row_mask:0xf bank_mask:0xf
  v_xor_b32_dpp v14, v204, v200 quad_perm:[1,0,3,2] row_mask:0xf bank_mask:0xf
  v_xor_b32_dpp v15, v205, v201 quad_perm:[1,0,3,2] row_mask:0xf bank_mask:0xf
  v_xor_b32_dpp v16, v206, v202 quad_perm:[1,0,3,2] row_mask:0xf bank_mask:0xf
  v_xor_b32_dpp v17, v207, v203 quad_perm:[1,0,3,2] row_mask:0xf bank_mask:0xf
  v_and_b32 v10, v8, v10
  v_and_b32 v11, v8, v11
  v_and_b32 v12, v8, v12
  v_and_b32 v13, v8, v13
  v_and_b32 v14, v8, v14
  v_and_b32 v15, v8, v15
  v_and_b32 v16, v8, v16
  v_and_b32 v17, v8, v17
  v_xor_b32 v192, v10, v192
  v_xor_b32 v193, v11, v193
  v_xor_b32 v194, v12, v194
  v_xor_b32 v195, v13, v195
  v_xor_b32 v200, v14, v200
  v_xor_b32 v201, v15, v201
  v_xor_b32 v202, v16, v202
  v_xor_b32 v203, v17, v203
  v_xor_b32_dpp v196, v10, v196 quad_perm:[1,0,3,2] row_mask:0xf bank_mask:0xf
  v_xor_b32_dpp v197, v11, v197 quad_perm:[1,0,3,2] row_mask:0xf bank_mask:0xf
  v_xor_b32_dpp v198, v12, v198 quad_perm:[1,0,3,2] row_mask:0xf bank_mask:0xf
  v_xor_b32_dpp v199, v13, v199 quad_perm:[1,0,3,2] row_mask:0xf bank_mask:0xf
  v_xor_b32_dpp v204, v14, v204 quad_perm:[1,0,3,2] row_mask:0xf bank_mask:0xf
  v_xor_b32_dpp v205, v15, v205 quad_perm:[1,0,3,2] row_mask:0xf bank_mask:0xf
  v_xor_b32_dpp v206, v16, v206 quad_perm:[1,0,3,2] row_mask:0xf bank_mask:0xf
  v_xor_b32_dpp v207, v17, v207 quad_perm:[1,0,3,2] row_mask:0xf bank_mask:0xf
  v_permlane16_swap_b32 v192, v200
  v_permlane16_swap_b32 v193, v201
  v_permlane16_swap_b32 v194, v202
  v_permlane16_swap_b32 v195, v203
  v_permlane16_swap_b32 v196, v204
  v_permlane16_swap_b32 v197, v205
  v_permlane16_swap_b32 v198, v206
  v_permlane16_swap_b32 v199, v207
  s_waitcnt vmcnt(12)
  s_waitcnt lgkmcnt(2)
  s_add_u32 s57, s53, 6
  s_and_b32 s57, s57, 7
  s_lshl_b32 s57, s57, 6
  s_add_u32 s57, s57, s44
  s_add_u32 s55, s57, 0
  buffer_load_dwordx4 v[176:179], v4, s[8:11], s55 offen offset:0
  s_add_u32 s55, s57, 32768
  buffer_load_dwordx4 v[180:183], v4, s[8:11], s55 offen offset:0
  v_mfma_f32_32x32x16_bf16 v[64:79], v[128:131], v[32:35], 0
  v_xor_b32_dpp v10, v148, v144 quad_perm:[1,0,3,2] row_mask:0xf bank_mask:0xf
  v_xor_b32_dpp v11, v149, v145 quad_perm:[1,0,3,2] row_mask:0xf bank_mask:0xf
  v_xor_b32_dpp v12, v150, v146 quad_perm:[1,0,3,2] row_mask:0xf bank_mask:0xf
  v_xor_b32_dpp v13, v151, v147 quad_perm:[1,0,3,2] row_mask:0xf bank_mask:0xf
  v_xor_b32_dpp v14, v156, v152 quad_perm:[1,0,3,2] row_mask:0xf bank_mask:0xf
  v_mfma_f32_32x32x16_bf16 v[80:95], v[128:131], v[36:39], 0
  v_xor_b32_dpp v15, v157, v153 quad_perm:[1,0,3,2] row_mask:0xf bank_mask:0xf
  v_xor_b32_dpp v16, v158, v154 quad_perm:[1,0,3,2] row_mask:0xf bank_mask:0xf
  v_xor_b32_dpp v17, v159, v155 quad_perm:[1,0,3,2] row_mask:0xf bank_mask:0xf
  v_and_b32 v10, v8, v10
  v_and_b32 v11, v8, v11
  v_mfma_f32_32x32x16_bf16 v[96:111], v[192:195], v[32:35], 0
  v_and_b32 v12, v8, v12
  v_and_b32 v13, v8, v13
  v_and_b32 v14, v8, v14
  v_and_b32 v15, v8, v15
  v_and_b32 v16, v8, v16
  v_mfma_f32_32x32x16_bf16 v[112:127], v[192:195], v[36:39], 0
  v_and_b32 v17, v8, v17
  v_xor_b32 v144, v10, v144
  v_xor_b32 v145, v11, v145
  v_xor_b32 v146, v12, v146
  v_xor_b32 v147, v13, v147
  ds_read_b128 v[48:51], v6 offset:4096
  ds_read_b128 v[52:55], v6 offset:5120
  s_waitcnt lgkmcnt(2)
  s_add_u32 s55, s57, 524288
  buffer_load_dwordx4 v[184:187], v4, s[8:11], s55 offen offset:0
  s_add_u32 s55, s57, 557056
  buffer_load_dwordx4 v[188:191], v4, s[8:11], s55 offen offset:0
  v_mfma_f32_32x32x16_bf16 v[64:79], v[132:135], v[40:43], v[64:79]
  v_xor_b32 v152, v14, v152
  v_xor_b32 v153, v15, v153
  v_xor_b32 v154, v16, v154
  v_xor_b32 v155, v17, v155
  v_xor_b32_dpp v148, v10, v148 quad_perm:[1,0,3,2] row_mask:0xf bank_mask:0xf
  v_mfma_f32_32x32x16_bf16 v[80:95], v[132:135], v[44:47], v[80:95]
  v_xor_b32_dpp v149, v11, v149 quad_perm:[1,0,3,2] row_mask:0xf bank_mask:0xf
  v_xor_b32_dpp v150, v12, v150 quad_perm:[1,0,3,2] row_mask:0xf bank_mask:0xf
  v_xor_b32_dpp v151, v13, v151 quad_perm:[1,0,3,2] row_mask:0xf bank_mask:0xf
  v_xor_b32_dpp v156, v14, v156 quad_perm:[1,0,3,2] row_mask:0xf bank_mask:0xf
  v_xor_b32_dpp v157, v15, v157 quad_perm:[1,0,3,2] row_mask:0xf bank_mask:0xf
  v_mfma_f32_32x32x16_bf16 v[96:111], v[196:199], v[40:43], v[96:111]
  v_xor_b32_dpp v158, v16, v158 quad_perm:[1,0,3,2] row_mask:0xf bank_mask:0xf
  v_xor_b32_dpp v159, v17, v159 quad_perm:[1,0,3,2] row_mask:0xf bank_mask:0xf
  v_permlane16_swap_b32 v144, v152
  v_permlane16_swap_b32 v145, v153
  v_permlane16_swap_b32 v146, v154
  v_mfma_f32_32x32x16_bf16 v[112:127], v[196:199], v[44:47], v[112:127]
  v_permlane16_swap_b32 v147, v155
  v_permlane16_swap_b32 v148, v156
  v_permlane16_swap_b32 v149, v157
  v_permlane16_swap_b32 v150, v158
  v_permlane16_swap_b32 v151, v159
  ds_read_b128 v[32:35], v6 offset:6144
  ds_read_b128 v[36:39], v6 offset:7168
  s_waitcnt vmcnt(12)
  s_waitcnt lgkmcnt(2)
  s_add_u32 s55, s57, 0
  buffer_load_dwordx4 v[240:243], v4, s[8:11], s55 offen offset:512
  s_add_u32 s55, s57, 32768
  buffer_load_dwordx4 v[244:247], v4, s[8:11], s55 offen offset:512
  v_mfma_f32_32x32x16_bf16 v[64:79], v[136:139], v[48:51], v[64:79]
  v_xor_b32_dpp v10, v212, v208 quad_perm:[1,0,3,2] row_mask:0xf bank_mask:0xf
  v_xor_b32_dpp v11, v213, v209 quad_perm:[1,0,3,2] row_mask:0xf bank_mask:0xf
  v_xor_b32_dpp v12, v214, v210 quad_perm:[1,0,3,2] row_mask:0xf bank_mask:0xf
  v_xor_b32_dpp v13, v215, v211 quad_perm:[1,0,3,2] row_mask:0xf bank_mask:0xf
  v_xor_b32_dpp v14, v220, v216 quad_perm:[1,0,3,2] row_mask:0xf bank_mask:0xf
  v_mfma_f32_32x32x16_bf16 v[80:95], v[136:139], v[52:55], v[80:95]
  v_xor_b32_dpp v15, v221, v217 quad_perm:[1,0,3,2] row_mask:0xf bank_mask:0xf
  v_xor_b32_dpp v16, v222, v218 quad_perm:[1,0,3,2] row_mask:0xf bank_mask:0xf
  v_xor_b32_dpp v17, v223, v219 quad_perm:[1,0,3,2] row_mask:0xf bank_mask:0xf
  v_and_b32 v10, v8, v10
  v_and_b32 v11, v8, v11
  v_mfma_f32_32x32x16_bf16 v[96:111], v[200:203], v[48:51], v[96:111]
  v_and_b32 v12, v8, v12
  v_and_b32 v13, v8, v13
  v_and_b32 v14, v8, v14
  v_and_b32 v15, v8, v15
  v_and_b32 v16, v8, v16
  v_mfma_f32_32x32x16_bf16 v[112:127], v[200:203], v[52:55], v[112:127]
  v_and_b32 v17, v8, v17
  v_xor_b32 v208, v10, v208
  v_xor_b32 v209, v11, v209
  v_xor_b32 v210, v12, v210
  v_xor_b32 v211, v13, v211
  ds_read_b128 v[40:43], v6 offset:8192
  ds_read_b128 v[44:47], v6 offset:9216
  s_waitcnt lgkmcnt(2)
  s_add_u32 s55, s57, 524288
  buffer_load_dwordx4 v[248:251], v4, s[8:11], s55 offen offset:512
  s_add_u32 s55, s57, 557056
  buffer_load_dwordx4 v[252:255], v4, s[8:11], s55 offen offset:512
  v_mfma_f32_32x32x16_bf16 v[64:79], v[140:143], v[32:35], v[64:79]
  v_xor_b32 v216, v14, v216
  v_xor_b32 v217, v15, v217
  v_xor_b32 v218, v16, v218
  v_xor_b32 v219, v17, v219
  v_xor_b32_dpp v212, v10, v212 quad_perm:[1,0,3,2] row_mask:0xf bank_mask:0xf
  v_mfma_f32_32x32x16_bf16 v[80:95], v[140:143], v[36:39], v[80:95]
  v_xor_b32_dpp v213, v11, v213 quad_perm:[1,0,3,2] row_mask:0xf bank_mask:0xf
  v_xor_b32_dpp v214, v12, v214 quad_perm:[1,0,3,2] row_mask:0xf bank_mask:0xf
  v_xor_b32_dpp v215, v13, v215 quad_perm:[1,0,3,2] row_mask:0xf bank_mask:0xf
  v_xor_b32_dpp v220, v14, v220 quad_perm:[1,0,3,2] row_mask:0xf bank_mask:0xf
  v_xor_b32_dpp v221, v15, v221 quad_perm:[1,0,3,2] row_mask:0xf bank_mask:0xf
  v_mfma_f32_32x32x16_bf16 v[96:111], v[204:207], v[32:35], v[96:111]
  v_xor_b32_dpp v222, v16, v222 quad_perm:[1,0,3,2] row_mask:0xf bank_mask:0xf
  v_xor_b32_dpp v223, v17, v223 quad_perm:[1,0,3,2] row_mask:0xf bank_mask:0xf
  v_permlane16_swap_b32 v208, v216
  v_permlane16_swap_b32 v209, v217
  v_permlane16_swap_b32 v210, v218
  v_mfma_f32_32x32x16_bf16 v[112:127], v[204:207], v[36:39], v[112:127]
  v_permlane16_swap_b32 v211, v219
  v_permlane16_swap_b32 v212, v220
  v_permlane16_swap_b32 v213, v221
  v_permlane16_swap_b32 v214, v222
  v_permlane16_swap_b32 v215, v223
  ds_read_b128 v[48:51], v6 offset:10240
  ds_read_b128 v[52:55], v6 offset:11264
  s_waitcnt vmcnt(12)
  s_waitcnt lgkmcnt(2)
  v_mfma_f32_32x32x16_bf16 v[64:79], v[144:147], v[40:43], v[64:79]
  v_xor_b32_dpp v10, v164, v160 quad_perm:[1,0,3,2] row_mask:0xf bank_mask:0xf
  v_xor_b32_dpp v11, v165, v161 quad_perm:[1,0,3,2] row_mask:0xf bank_mask:0xf
  v_xor_b32_dpp v12, v166, v162 quad_perm:[1,0,3,2] row_mask:0xf bank_mask:0xf
  v_xor_b32_dpp v13, v167, v163 quad_perm:[1,0,3,2] row_mask:0xf bank_mask:0xf
  v_xor_b32_dpp v14, v172, v168 quad_perm:[1,0,3,2] row_mask:0xf bank_mask:0xf
  v_mfma_f32_32x32x16_bf16 v[80:95], v[144:147], v[44:47], v[80:95]
  v_xor_b32_dpp v15, v173, v169 quad_perm:[1,0,3,2] row_mask:0xf bank_mask:0xf
  v_xor_b32_dpp v16, v174, v170 quad_perm:[1,0,3,2] row_mask:0xf bank_mask:0xf
  v_xor_b32_dpp v17, v175, v171 quad_perm:[1,0,3,2] row_mask:0xf bank_mask:0xf
  v_and_b32 v10, v8, v10
  v_and_b32 v11, v8, v11
  v_mfma_f32_32x32x16_bf16 v[96:111], v[208:211], v[40:43], v[96:111]
  v_and_b32 v12, v8, v12
  v_and_b32 v13, v8, v13
  v_and_b32 v14, v8, v14
  v_and_b32 v15, v8, v15
  v_and_b32 v16, v8, v16
  v_mfma_f32_32x32x16_bf16 v[112:127], v[208:211], v[44:47], v[112:127]
  v_and_b32 v17, v8, v17
  v_xor_b32 v160, v10, v160
  v_xor_b32 v161, v11, v161
  v_xor_b32 v162, v12, v162
  v_xor_b32 v163, v13, v163
  ds_read_b128 v[32:35], v6 offset:12288
  ds_read_b128 v[36:39], v6 offset:13312
  s_waitcnt lgkmcnt(2)
  v_mfma_f32_32x32x16_bf16 v[64:79], v[148:151], v[48:51], v[64:79]
  v_xor_b32 v168, v14, v168
  v_xor_b32 v169, v15, v169
  v_xor_b32 v170, v16, v170
  v_xor_b32 v171, v17, v171
  v_xor_b32_dpp v164, v10, v164 quad_perm:[1,0,3,2] row_mask:0xf bank_mask:0xf
  v_mfma_f32_32x32x16_bf16 v[80:95], v[148:151], v[52:55], v[80:95]
  v_xor_b32_dpp v165, v11, v165 quad_perm:[1,0,3,2] row_mask:0xf bank_mask:0xf
  v_xor_b32_dpp v166, v12, v166 quad_perm:[1,0,3,2] row_mask:0xf bank_mask:0xf
  v_xor_b32_dpp v167, v13, v167 quad_perm:[1,0,3,2] row_mask:0xf bank_mask:0xf
  v_xor_b32_dpp v172, v14, v172 quad_perm:[1,0,3,2] row_mask:0xf bank_mask:0xf
  v_xor_b32_dpp v173, v15, v173 quad_perm:[1,0,3,2] row_mask:0xf bank_mask:0xf
  v_mfma_f32_32x32x16_bf16 v[96:111], v[212:215], v[48:51], v[96:111]
  v_xor_b32_dpp v174, v16, v174 quad_perm:[1,0,3,2] row_mask:0xf bank_mask:0xf
  v_xor_b32_dpp v175, v17, v175 quad_perm:[1,0,3,2] row_mask:0xf bank_mask:0xf
  v_permlane16_swap_b32 v160, v168
  v_permlane16_swap_b32 v161, v169
  v_permlane16_swap_b32 v162, v170
  v_mfma_f32_32x32x16_bf16 v[112:127], v[212:215], v[52:55], v[112:127]
  v_permlane16_swap_b32 v163, v171
  v_permlane16_swap_b32 v164, v172
  v_permlane16_swap_b32 v165, v173
  v_permlane16_swap_b32 v166, v174
  v_permlane16_swap_b32 v167, v175
  ds_read_b128 v[40:43], v6 offset:14336
  ds_read_b128 v[44:47], v6 offset:15360
  s_waitcnt vmcnt(8)
  s_waitcnt lgkmcnt(2)
  v_mfma_f32_32x32x16_bf16 v[64:79], v[152:155], v[32:35], v[64:79]
  v_xor_b32_dpp v10, v228, v224 quad_perm:[1,0,3,2] row_mask:0xf bank_mask:0xf
  v_xor_b32_dpp v11, v229, v225 quad_perm:[1,0,3,2] row_mask:0xf bank_mask:0xf
  v_xor_b32_dpp v12, v230, v226 quad_perm:[1,0,3,2] row_mask:0xf bank_mask:0xf
  v_xor_b32_dpp v13, v231, v227 quad_perm:[1,0,3,2] row_mask:0xf bank_mask:0xf
  v_xor_b32_dpp v14, v236, v232 quad_perm:[1,0,3,2] row_mask:0xf bank_mask:0xf
  v_mfma_f32_32x32x16_bf16 v[80:95], v[152:155], v[36:39], v[80:95]
  v_xor_b32_dpp v15, v237, v233 quad_perm:[1,0,3,2] row_mask:0xf bank_mask:0xf
  v_xor_b32_dpp v16, v238, v234 quad_perm:[1,0,3,2] row_mask:0xf bank_mask:0xf
  v_xor_b32_dpp v17, v239, v235 quad_perm:[1,0,3,2] row_mask:0xf bank_mask:0xf
  v_and_b32 v10, v8, v10
  v_and_b32 v11, v8, v11
  v_mfma_f32_32x32x16_bf16 v[96:111], v[216:219], v[32:35], v[96:111]
  v_and_b32 v12, v8, v12
  v_and_b32 v13, v8, v13
  v_and_b32 v14, v8, v14
  v_and_b32 v15, v8, v15
  v_and_b32 v16, v8, v16
  v_mfma_f32_32x32x16_bf16 v[112:127], v[216:219], v[36:39], v[112:127]
  v_and_b32 v17, v8, v17
  v_xor_b32 v224, v10, v224
  v_xor_b32 v225, v11, v225
  v_xor_b32 v226, v12, v226
  v_xor_b32 v227, v13, v227
  ds_read_b128 v[48:51], v6 offset:16384
  ds_read_b128 v[52:55], v6 offset:17408
  s_waitcnt lgkmcnt(2)
  v_mfma_f32_32x32x16_bf16 v[64:79], v[156:159], v[40:43], v[64:79]
  v_xor_b32 v232, v14, v232
  v_xor_b32 v233, v15, v233
  v_xor_b32 v234, v16, v234
  v_xor_b32 v235, v17, v235
  v_xor_b32_dpp v228, v10, v228 quad_perm:[1,0,3,2] row_mask:0xf bank_mask:0xf
  v_mfma_f32_32x32x16_bf16 v[80:95], v[156:159], v[44:47], v[80:95]
  v_xor_b32_dpp v229, v11, v229 quad_perm:[1,0,3,2] row_mask:0xf bank_mask:0xf
  v_xor_b32_dpp v230, v12, v230 quad_perm:[1,0,3,2] row_mask:0xf bank_mask:0xf
  v_xor_b32_dpp v231, v13, v231 quad_perm:[1,0,3,2] row_mask:0xf bank_mask:0xf
  v_xor_b32_dpp v236, v14, v236 quad_perm:[1,0,3,2] row_mask:0xf bank_mask:0xf
  v_xor_b32_dpp v237, v15, v237 quad_perm:[1,0,3,2] row_mask:0xf bank_mask:0xf
  v_mfma_f32_32x32x16_bf16 v[96:111], v[220:223], v[40:43], v[96:111]
  v_xor_b32_dpp v238, v16, v238 quad_perm:[1,0,3,2] row_mask:0xf bank_mask:0xf
  v_xor_b32_dpp v239, v17, v239 quad_perm:[1,0,3,2] row_mask:0xf bank_mask:0xf
  v_permlane16_swap_b32 v224, v232
  v_permlane16_swap_b32 v225, v233
  v_permlane16_swap_b32 v226, v234
  v_mfma_f32_32x32x16_bf16 v[112:127], v[220:223], v[44:47], v[112:127]
  v_permlane16_swap_b32 v227, v235
  v_permlane16_swap_b32 v228, v236
  v_permlane16_swap_b32 v229, v237
  v_permlane16_swap_b32 v230, v238
  v_permlane16_swap_b32 v231, v239
  ds_read_b128 v[32:35], v6 offset:18432
  ds_read_b128 v[36:39], v6 offset:19456
  s_waitcnt vmcnt(4)
  s_waitcnt lgkmcnt(2)
  v_mfma_f32_32x32x16_bf16 v[64:79], v[160:163], v[48:51], v[64:79]
  v_xor_b32_dpp v10, v180, v176 quad_perm:[1,0,3,2] row_mask:0xf bank_mask:0xf
  v_xor_b32_dpp v11, v181, v177 quad_perm:[1,0,3,2] row_mask:0xf bank_mask:0xf
  v_xor_b32_dpp v12, v182, v178 quad_perm:[1,0,3,2] row_mask:0xf bank_mask:0xf
  v_xor_b32_dpp v13, v183, v179 quad_perm:[1,0,3,2] row_mask:0xf bank_mask:0xf
  v_xor_b32_dpp v14, v188, v184 quad_perm:[1,0,3,2] row_mask:0xf bank_mask:0xf
  v_mfma_f32_32x32x16_bf16 v[80:95], v[160:163], v[52:55], v[80:95]
  v_xor_b32_dpp v15, v189, v185 quad_perm:[1,0,3,2] row_mask:0xf bank_mask:0xf
  v_xor_b32_dpp v16, v190, v186 quad_perm:[1,0,3,2] row_mask:0xf bank_mask:0xf
  v_xor_b32_dpp v17, v191, v187 quad_perm:[1,0,3,2] row_mask:0xf bank_mask:0xf
  v_and_b32 v10, v8, v10
  v_and_b32 v11, v8, v11
  v_mfma_f32_32x32x16_bf16 v[96:111], v[224:227], v[48:51], v[96:111]
  v_and_b32 v12, v8, v12
  v_and_b32 v13, v8, v13
  v_and_b32 v14, v8, v14
  v_and_b32 v15, v8, v15
  v_and_b32 v16, v8, v16
  v_mfma_f32_32x32x16_bf16 v[112:127], v[224:227], v[52:55], v[112:127]
  v_and_b32 v17, v8, v17
  v_xor_b32 v176, v10, v176
  v_xor_b32 v177, v11, v177
  v_xor_b32 v178, v12, v178
  v_xor_b32 v179, v13, v179
  ds_read_b128 v[40:43], v6 offset:20480
  ds_read_b128 v[44:47], v6 offset:21504
  s_waitcnt lgkmcnt(2)
  v_mfma_f32_32x32x16_bf16 v[64:79], v[164:167], v[32:35], v[64:79]
  v_xor_b32 v184, v14, v184
  v_xor_b32 v185, v15, v185
  v_xor_b32 v186, v16, v186
  v_xor_b32 v187, v17, v187
  v_xor_b32_dpp v180, v10, v180 quad_perm:[1,0,3,2] row_mask:0xf bank_mask:0xf
  v_mfma_f32_32x32x16_bf16 v[80:95], v[164:167], v[36:39], v[80:95]
  v_xor_b32_dpp v181, v11, v181 quad_perm:[1,0,3,2] row_mask:0xf bank_mask:0xf
  v_xor_b32_dpp v182, v12, v182 quad_perm:[1,0,3,2] row_mask:0xf bank_mask:0xf
  v_xor_b32_dpp v183, v13, v183 quad_perm:[1,0,3,2] row_mask:0xf bank_mask:0xf
  v_xor_b32_dpp v188, v14, v188 quad_perm:[1,0,3,2] row_mask:0xf bank_mask:0xf
  v_xor_b32_dpp v189, v15, v189 quad_perm:[1,0,3,2] row_mask:0xf bank_mask:0xf
  v_mfma_f32_32x32x16_bf16 v[96:111], v[228:231], v[32:35], v[96:111]
  v_xor_b32_dpp v190, v16, v190 quad_perm:[1,0,3,2] row_mask:0xf bank_mask:0xf
  v_xor_b32_dpp v191, v17, v191 quad_perm:[1,0,3,2] row_mask:0xf bank_mask:0xf
  v_permlane16_swap_b32 v176, v184
  v_permlane16_swap_b32 v177, v185
  v_permlane16_swap_b32 v178, v186
  v_mfma_f32_32x32x16_bf16 v[112:127], v[228:231], v[36:39], v[112:127]
  v_permlane16_swap_b32 v179, v187
  v_permlane16_swap_b32 v180, v188
  v_permlane16_swap_b32 v181, v189
  v_permlane16_swap_b32 v182, v190
  v_permlane16_swap_b32 v183, v191
  ds_read_b128 v[48:51], v6 offset:22528
  ds_read_b128 v[52:55], v6 offset:23552
  s_waitcnt vmcnt(0)
  s_waitcnt lgkmcnt(2)
  buffer_store_dwordx4 v[20:23], v57, s[24:27], s52 offen sc0 sc1
  s_add_u32 s52, s52, 65536
  v_mfma_f32_32x32x16_bf16 v[64:79], v[168:171], v[40:43], v[64:79]
  v_xor_b32_dpp v10, v244, v240 quad_perm:[1,0,3,2] row_mask:0xf bank_mask:0xf
  v_xor_b32_dpp v11, v245, v241 quad_perm:[1,0,3,2] row_mask:0xf bank_mask:0xf
  v_xor_b32_dpp v12, v246, v242 quad_perm:[1,0,3,2] row_mask:0xf bank_mask:0xf
  v_xor_b32_dpp v13, v247, v243 quad_perm:[1,0,3,2] row_mask:0xf bank_mask:0xf
  v_xor_b32_dpp v14, v252, v248 quad_perm:[1,0,3,2] row_mask:0xf bank_mask:0xf
  v_mfma_f32_32x32x16_bf16 v[80:95], v[168:171], v[44:47], v[80:95]
  v_xor_b32_dpp v15, v253, v249 quad_perm:[1,0,3,2] row_mask:0xf bank_mask:0xf
  v_xor_b32_dpp v16, v254, v250 quad_perm:[1,0,3,2] row_mask:0xf bank_mask:0xf
  v_xor_b32_dpp v17, v255, v251 quad_perm:[1,0,3,2] row_mask:0xf bank_mask:0xf
  v_and_b32 v10, v8, v10
  v_and_b32 v11, v8, v11
  v_mfma_f32_32x32x16_bf16 v[96:111], v[232:235], v[40:43], v[96:111]
  v_and_b32 v12, v8, v12
  v_and_b32 v13, v8, v13
  v_and_b32 v14, v8, v14
  v_and_b32 v15, v8, v15
  v_and_b32 v16, v8, v16
  v_mfma_f32_32x32x16_bf16 v[112:127], v[232:235], v[44:47], v[112:127]
  v_and_b32 v17, v8, v17
  v_xor_b32 v240, v10, v240
  v_xor_b32 v241, v11, v241
  v_xor_b32 v242, v12, v242
  v_xor_b32 v243, v13, v243
  ds_read_b128 v[32:35], v6 offset:24576
  ds_read_b128 v[36:39], v6 offset:25600
  s_waitcnt lgkmcnt(2)
  buffer_store_dwordx4 v[24:27], v57, s[24:27], s52 offen sc0 sc1
  s_add_u32 s52, s52, 65536
  v_mfma_f32_32x32x16_bf16 v[64:79], v[172:175], v[48:51], v[64:79]
  v_xor_b32 v248, v14, v248
  v_xor_b32 v249, v15, v249
  v_xor_b32 v250, v16, v250
  v_xor_b32 v251, v17, v251
  v_xor_b32_dpp v244, v10, v244 quad_perm:[1,0,3,2] row_mask:0xf bank_mask:0xf
  v_mfma_f32_32x32x16_bf16 v[80:95], v[172:175], v[52:55], v[80:95]
  v_xor_b32_dpp v245, v11, v245 quad_perm:[1,0,3,2] row_mask:0xf bank_mask:0xf
  v_xor_b32_dpp v246, v12, v246 quad_perm:[1,0,3,2] row_mask:0xf bank_mask:0xf
  v_xor_b32_dpp v247, v13, v247 quad_perm:[1,0,3,2] row_mask:0xf bank_mask:0xf
  v_xor_b32_dpp v252, v14, v252 quad_perm:[1,0,3,2] row_mask:0xf bank_mask:0xf
  v_xor_b32_dpp v253, v15, v253 quad_perm:[1,0,3,2] row_mask:0xf bank_mask:0xf
  v_mfma_f32_32x32x16_bf16 v[96:111], v[236:239], v[48:51], v[96:111]
  v_xor_b32_dpp v254, v16, v254 quad_perm:[1,0,3,2] row_mask:0xf bank_mask:0xf
  v_xor_b32_dpp v255, v17, v255 quad_perm:[1,0,3,2] row_mask:0xf bank_mask:0xf
  v_permlane16_swap_b32 v240, v248
  v_permlane16_swap_b32 v241, v249
  v_permlane16_swap_b32 v242, v250
  v_mfma_f32_32x32x16_bf16 v[112:127], v[236:239], v[52:55], v[112:127]
  v_permlane16_swap_b32 v243, v251
  v_permlane16_swap_b32 v244, v252
  v_permlane16_swap_b32 v245, v253
  v_permlane16_swap_b32 v246, v254
  v_permlane16_swap_b32 v247, v255
  ds_read_b128 v[40:43], v6 offset:26624
  ds_read_b128 v[44:47], v6 offset:27648
  s_waitcnt lgkmcnt(2)
  buffer_store_dwordx4 v[28:31], v57, s[24:27], s52 offen sc0 sc1
  s_add_u32 s52, s52, 65536
  v_mfma_f32_32x32x16_bf16 v[64:79], v[176:179], v[32:35], v[64:79]
  v_mfma_f32_32x32x16_bf16 v[80:95], v[176:179], v[36:39], v[80:95]
  v_mfma_f32_32x32x16_bf16 v[96:111], v[240:243], v[32:35], v[96:111]
  v_mfma_f32_32x32x16_bf16 v[112:127], v[240:243], v[36:39], v[112:127]
  ds_read_b128 v[48:51], v6 offset:28672
  ds_read_b128 v[52:55], v6 offset:29696
  s_waitcnt lgkmcnt(2)
  buffer_store_dwordx4 v[60:63], v57, s[24:27], s52 offen sc0 sc1
  s_add_u32 s52, s52, 65536
  v_mfma_f32_32x32x16_bf16 v[64:79], v[180:183], v[40:43], v[64:79]
  v_mfma_f32_32x32x16_bf16 v[80:95], v[180:183], v[44:47], v[80:95]
  v_mfma_f32_32x32x16_bf16 v[96:111], v[244:247], v[40:43], v[96:111]
  v_mfma_f32_32x32x16_bf16 v[112:127], v[244:247], v[44:47], v[112:127]
  ds_read_b128 v[32:35], v6 offset:30720
  ds_read_b128 v[36:39], v6 offset:31744
  s_waitcnt lgkmcnt(2)
  v_lshlrev_b32 v57, 2, v1
  s_mov_b64 exec, 0xff
  buffer_store_dword v56, v57, s[24:27], s51 offen
  s_mov_b64 exec, -1
  v_mfma_f32_32x32x16_bf16 v[64:79], v[184:187], v[48:51], v[64:79]
  v_mfma_f32_32x32x16_bf16 v[80:95], v[184:187], v[52:55], v[80:95]
  v_mfma_f32_32x32x16_bf16 v[96:111], v[248:251], v[48:51], v[96:111]
  v_mfma_f32_32x32x16_bf16 v[112:127], v[248:251], v[52:55], v[112:127]
  s_waitcnt lgkmcnt(0)
  v_mfma_f32_32x32x16_bf16 v[64:79], v[188:191], v[32:35], v[64:79]
  v_mfma_f32_32x32x16_bf16 v[80:95], v[188:191], v[36:39], v[80:95]
  v_mfma_f32_32x32x16_bf16 v[96:111], v[252:255], v[32:35], v[96:111]
  v_mfma_f32_32x32x16_bf16 v[112:127], v[252:255], v[36:39], v[112:127]
  v_and_b32 v11, 28, v1
  v_lshl_or_b32 v11, v2, 1, v11
  v_and_b32 v10, 3, v1
  v_lshlrev_b32 v10, 4, v10
  v_lshl_or_b32 v9, v11, 12, v10
  v_bfe_i32 v12, v1, 0, 1
  v_bfe_i32 v13, v1, 1, 1
  s_lshl_b32 s44, s5, 18
  s_lshl_b32 s45, s6, 6
  s_add_u32 s44, s44, s45
  s_add_u32 s45, s44, 0x20000
  s_nop 7
  v_fma_f32 v64, v96, v18, v64
  v_fma_f32 v65, v97, v18, v65
  v_fma_f32 v66, v98, v18, v66
  v_fma_f32 v67, v99, v18, v67
  v_fma_f32 v68, v100, v18, v68
  v_fma_f32 v69, v101, v18, v69
  v_fma_f32 v70, v102, v18, v70
  v_fma_f32 v71, v103, v18, v71
  v_fma_f32 v72, v104, v18, v72
  v_fma_f32 v73, v105, v18, v73
  v_fma_f32 v74, v106, v18, v74
  v_fma_f32 v75, v107, v18, v75
  v_fma_f32 v76, v108, v18, v76
  v_fma_f32 v77, v109, v18, v77
  v_fma_f32 v78, v110, v18, v78
  v_fma_f32 v79, v111, v18, v79
  v_cvt_pk_bf16_f32 v32, v64, v65
  v_cvt_pk_bf16_f32 v33, v66, v67
  v_cvt_pk_bf16_f32 v34, v68, v69
  v_cvt_pk_bf16_f32 v35, v70, v71
  v_cvt_pk_bf16_f32 v36, v72, v73
  v_cvt_pk_bf16_f32 v37, v74, v75
  v_cvt_pk_bf16_f32 v38, v76, v77
  v_cvt_pk_bf16_f32 v39, v78, v79
  s_nop 1
  v_xor_b32_dpp v48, v36, v32 quad_perm:[2,3,0,1] row_mask:0xf bank_mask:0xf
  v_xor_b32_dpp v49, v37, v33 quad_perm:[2,3,0,1] row_mask:0xf bank_mask:0xf
  v_xor_b32_dpp v50, v38, v34 quad_perm:[2,3,0,1] row_mask:0xf bank_mask:0xf
  v_xor_b32_dpp v51, v39, v35 quad_perm:[2,3,0,1] row_mask:0xf bank_mask:0xf
  v_and_b32 v48, v13, v48
  v_and_b32 v49, v13, v49
  v_and_b32 v50, v13, v50
  v_and_b32 v51, v13, v51
  v_xor_b32 v32, v48, v32
  v_xor_b32 v33, v49, v33
  v_xor_b32 v34, v50, v34
  v_xor_b32 v35, v51, v35
  v_xor_b32_dpp v36, v48, v36 quad_perm:[2,3,0,1] row_mask:0xf bank_mask:0xf
  v_xor_b32_dpp v37, v49, v37 quad_perm:[2,3,0,1] row_mask:0xf bank_mask:0xf
  v_xor_b32_dpp v38, v50, v38 quad_perm:[2,3,0,1] row_mask:0xf bank_mask:0xf
  v_xor_b32_dpp v39, v51, v39 quad_perm:[2,3,0,1] row_mask:0xf bank_mask:0xf
  s_nop 1
  v_permlane32_swap_b32 v32, v36
  v_permlane32_swap_b32 v33, v37
  v_permlane32_swap_b32 v34, v38
  v_permlane32_swap_b32 v35, v39
  s_nop 1
  v_xor_b32_dpp v48, v36, v32 quad_perm:[1,0,3,2] row_mask:0xf bank_mask:0xf
  v_xor_b32_dpp v49, v37, v33 quad_perm:[1,0,3,2] row_mask:0xf bank_mask:0xf
  v_xor_b32_dpp v50, v38, v34 quad_perm:[1,0,3,2] row_mask:0xf bank_mask:0xf
  v_xor_b32_dpp v51, v39, v35 quad_perm:[1,0,3,2] row_mask:0xf bank_mask:0xf
  v_and_b32 v48, v12, v48
  v_and_b32 v49, v12, v49
  v_and_b32 v50, v12, v50
  v_and_b32 v51, v12, v51
  v_xor_b32 v32, v48, v32
  v_xor_b32 v33, v49, v33
  v_xor_b32 v34, v50, v34
  v_xor_b32 v35, v51, v35
  v_xor_b32_dpp v36, v48, v36 quad_perm:[1,0,3,2] row_mask:0xf bank_mask:0xf
  v_xor_b32_dpp v37, v49, v37 quad_perm:[1,0,3,2] row_mask:0xf bank_mask:0xf
  v_xor_b32_dpp v38, v50, v38 quad_perm:[1,0,3,2] row_mask:0xf bank_mask:0xf
  v_xor_b32_dpp v39, v51, v39 quad_perm:[1,0,3,2] row_mask:0xf bank_mask:0xf
  buffer_store_dwordx4 v[32:35], v9, s[16:19], s44 offen sc0 sc1
  s_add_u32 s44, s44, 4096
  buffer_store_dwordx4 v[36:39], v9, s[16:19], s44 offen sc0 sc1
  v_fma_f32 v80, v112, v19, v80
  v_fma_f32 v81, v113, v19, v81
  v_fma_f32 v82, v114, v19, v82
  v_fma_f32 v83, v115, v19, v83
  v_fma_f32 v84, v116, v19, v84
  v_fma_f32 v85, v117, v19, v85
  v_fma_f32 v86, v118, v19, v86
  v_fma_f32 v87, v119, v19, v87
  v_fma_f32 v88, v120, v19, v88
  v_fma_f32 v89, v121, v19, v89
  v_fma_f32 v90, v122, v19, v90
  v_fma_f32 v91, v123, v19, v91
  v_fma_f32 v92, v124, v19, v92
  v_fma_f32 v93, v125, v19, v93
  v_fma_f32 v94, v126, v19, v94
  v_fma_f32 v95, v127, v19, v95
  v_cvt_pk_bf16_f32 v40, v80, v81
  v_cvt_pk_bf16_f32 v41, v82, v83
  v_cvt_pk_bf16_f32 v42, v84, v85
  v_cvt_pk_bf16_f32 v43, v86, v87
  v_cvt_pk_bf16_f32 v44, v88, v89
  v_cvt_pk_bf16_f32 v45, v90, v91
  v_cvt_pk_bf16_f32 v46, v92, v93
  v_cvt_pk_bf16_f32 v47, v94, v95
  s_nop 1
  v_xor_b32_dpp v48, v44, v40 quad_perm:[2,3,0,1] row_mask:0xf bank_mask:0xf
  v_xor_b32_dpp v49, v45, v41 quad_perm:[2,3,0,1] row_mask:0xf bank_mask:0xf
  v_xor_b32_dpp v50, v46, v42 quad_perm:[2,3,0,1] row_mask:0xf bank_mask:0xf
  v_xor_b32_dpp v51, v47, v43 quad_perm:[2,3,0,1] row_mask:0xf bank_mask:0xf
  v_and_b32 v48, v13, v48
  v_and_b32 v49, v13, v49
  v_and_b32 v50, v13, v50
  v_and_b32 v51, v13, v51
  v_xor_b32 v40, v48, v40
  v_xor_b32 v41, v49, v41
  v_xor_b32 v42, v50, v42
  v_xor_b32 v43, v51, v43
  v_xor_b32_dpp v44, v48, v44 quad_perm:[2,3,0,1] row_mask:0xf bank_mask:0xf
  v_xor_b32_dpp v45, v49, v45 quad_perm:[2,3,0,1] row_mask:0xf bank_mask:0xf
  v_xor_b32_dpp v46, v50, v46 quad_perm:[2,3,0,1] row_mask:0xf bank_mask:0xf
  v_xor_b32_dpp v47, v51, v47 quad_perm:[2,3,0,1] row_mask:0xf bank_mask:0xf
  s_nop 1
  v_permlane32_swap_b32 v40, v44
  v_permlane32_swap_b32 v41, v45
  v_permlane32_swap_b32 v42, v46
  v_permlane32_swap_b32 v43, v47
  s_nop 1
  v_xor_b32_dpp v48, v44, v40 quad_perm:[1,0,3,2] row_mask:0xf bank_mask:0xf
  v_xor_b32_dpp v49, v45, v41 quad_perm:[1,0,3,2] row_mask:0xf bank_mask:0xf
  v_xor_b32_dpp v50, v46, v42 quad_perm:[1,0,3,2] row_mask:0xf bank_mask:0xf
  v_xor_b32_dpp v51, v47, v43 quad_perm:[1,0,3,2] row_mask:0xf bank_mask:0xf
  v_and_b32 v48, v12, v48
  v_and_b32 v49, v12, v49
  v_and_b32 v50, v12, v50
  v_and_b32 v51, v12, v51
  v_xor_b32 v40, v48, v40
  v_xor_b32 v41, v49, v41
  v_xor_b32 v42, v50, v42
  v_xor_b32 v43, v51, v43
  v_xor_b32_dpp v44, v48, v44 quad_perm:[1,0,3,2] row_mask:0xf bank_mask:0xf
  v_xor_b32_dpp v45, v49, v45 quad_perm:[1,0,3,2] row_mask:0xf bank_mask:0xf
  v_xor_b32_dpp v46, v50, v46 quad_perm:[1,0,3,2] row_mask:0xf bank_mask:0xf
  v_xor_b32_dpp v47, v51, v47 quad_perm:[1,0,3,2] row_mask:0xf bank_mask:0xf
  buffer_store_dwordx4 v[40:43], v9, s[16:19], s45 offen sc0 sc1
  s_add_u32 s45, s45, 4096
  buffer_store_dwordx4 v[44:47], v9, s[16:19], s45 offen sc0 sc1
  s_endpgm
K1_tab:
  s_add_u32 s16, s78, 10485760
  s_addc_u32 s17, s79, 0
  s_mov_b32 s18, 106496
  s_mov_b32 s19, 0x00020000
  v_and_b32 v14, 15, v1
  v_lshrrev_b32 v15, 4, v1
  v_lshlrev_b32 v9, 4, v1
  s_mul_i32 s44, s3, 26624
  s_lshr_b32 s5, s3, 1
  s_and_b32 s4, s3, 1
  s_lshl_b32 s6, s5, 5
  v_and_b32 v10, 12, v14
  v_and_b32 v11, 3, v14
  v_lshl_add_u32 v10, v10, 1, v11
  v_add_u32 v10, s6, v10
  v_cvt_f32_u32 v16, v10
  v_add_f32 v17, 4.0, v16
  v_cvt_f32_u32 v18, v14
  v_add_f32 v19, 0x41800000, v18
  v_cvt_f32_u32 v20, v15
  s_cmp_lg_u32 s2, 256
  s_cbranch_scc1 K1_t0
  v_mul_f32 v21, 0x3c800000, v16
  v_mul_f32 v22, 0x41000000, v20
  v_add_f32 v22, 0x00000000, v22
  v_mul_f32 v22, v22, v21
  v_fract_f32 v22, v22
  v_cos_f32 v32, v22
  v_fma_f32 v33, v21, 1.0, v22
  v_cos_f32 v33, v33
  v_fma_f32 v34, v21, 2.0, v22
  v_cos_f32 v34, v34
  s_mov_b32 s60, 0x40400000
  v_fma_f32 v35, v21, s60, v22
  v_cos_f32 v35, v35
  v_fma_f32 v36, v21, 4.0, v22
  v_cos_f32 v36, v36
  s_mov_b32 s60, 0x40a00000
  v_fma_f32 v37, v21, s60, v22
  v_cos_f32 v37, v37
  s_mov_b32 s60, 0x40c00000
  v_fma_f32 v38, v21, s60, v22
  v_cos_f32 v38, v38
  s_mov_b32 s60, 0x40e00000
  v_fma_f32 v39, v21, s60, v22
  v_cos_f32 v39, v39
  s_nop 0
  v_cvt_pk_bf16_f32 v64, v32, v33
  v_cvt_pk_bf16_f32 v65, v34, v35
  v_cvt_pk_bf16_f32 v66, v36, v37
  v_cvt_pk_bf16_f32 v67, v38, v39
  v_sin_f32 v40, v22
  v_fma_f32 v41, v21, 1.0, v22
  v_sin_f32 v41, v41
  v_fma_f32 v42, v21, 2.0, v22
  v_sin_f32 v42, v42
  s_mov_b32 s60, 0x40400000
  v_fma_f32 v43, v21, s60, v22
  v_sin_f32 v43, v43
  v_fma_f32 v44, v21, 4.0, v22
  v_sin_f32 v44, v44
  s_mov_b32 s60, 0x40a00000
  v_fma_f32 v45, v21, s60, v22
  v_sin_f32 v45, v45
  s_mov_b32 s60, 0x40c00000
  v_fma_f32 v46, v21, s60, v22
  v_sin_f32 v46, v46
  s_mov_b32 s60, 0x40e00000
  v_fma_f32 v47, v21, s60, v22
  v_sin_f32 v47, v47
  s_nop 0
  v_cvt_pk_bf16_f32 v68, v40, v41
  v_cvt_pk_bf16_f32 v69, v42, v43
  v_cvt_pk_bf16_f32 v70, v44, v45
  v_cvt_pk_bf16_f32 v71, v46, v47
  v_xor_b32 v72, 0x80008000, v68
  v_xor_b32 v73, 0x80008000, v69
  v_xor_b32 v74, 0x80008000, v70
  v_xor_b32 v75, 0x80008000, v71
  s_add_u32 s45, s44, 0
  buffer_store_dwordx4 v[64:67], v9, s[16:19], s45 offen
  s_add_u32 s45, s44, 1024
  buffer_store_dwordx4 v[68:71], v9, s[16:19], s45 offen
  s_add_u32 s45, s44, 2048
  buffer_store_dwordx4 v[72:75], v9, s[16:19], s45 offen
K1_t0:
  s_cmp_lg_u32 s2, 257
  s_cbranch_scc1 K1_t3
  v_mul_f32 v21, 0x3c800000, v16
  v_mul_f32 v22, 0x41000000, v20
  v_add_f32 v22, 0x42000000, v22
  v_mul_f32 v22, v22, v21
  v_fract_f32 v22, v22
  v_cos_f32 v32, v22
  v_fma_f32 v33, v21, 1.0, v22
  v_cos_f32 v33, v33
  v_fma_f32 v34, v21, 2.0, v22
  v_cos_f32 v34, v34
  s_mov_b32 s60, 0x40400000
  v_fma_f32 v35, v21, s60, v22
  v_cos_f32 v35, v35
  v_fma_f32 v36, v21, 4.0, v22
  v_cos_f32 v36, v36
  s_mov_b32 s60, 0x40a00000
  v_fma_f32 v37, v21, s60, v22
  v_cos_f32 v37, v37
  s_mov_b32 s60, 0x40c00000
  v_fma_f32 v38, v21, s60, v22
  v_cos_f32 v38, v38
  s_mov_b32 s60, 0x40e00000
  v_fma_f32 v39, v21, s60, v22
  v_cos_f32 v39, v39
  s_nop 0
  v_cvt_pk_bf16_f32 v76, v32, v33
  v_cvt_pk_bf16_f32 v77, v34, v35
  v_cvt_pk_bf16_f32 v78, v36, v37
  v_cvt_pk_bf16_f32 v79, v38, v39
  v_sin_f32 v40, v22
  v_fma_f32 v41, v21, 1.0, v22
  v_sin_f32 v41, v41
  v_fma_f32 v42, v21, 2.0, v22
  v_sin_f32 v42, v42
  s_mov_b32 s60, 0x40400000
  v_fma_f32 v43, v21, s60, v22
  v_sin_f32 v43, v43
  v_fma_f32 v44, v21, 4.0, v22
  v_sin_f32 v44, v44
  s_mov_b32 s60, 0x40a00000
  v_fma_f32 v45, v21, s60, v22
  v_sin_f32 v45, v45
  s_mov_b32 s60, 0x40c00000
  v_fma_f32 v46, v21, s60, v22
  v_sin_f32 v46, v46
  s_mov_b32 s60, 0x40e00000
  v_fma_f32 v47, v21, s60, v22
  v_sin_f32 v47, v47
  s_nop 0
  v_cvt_pk_bf16_f32 v80, v40, v41
  v_cvt_pk_bf16_f32 v81, v42, v43
  v_cvt_pk_bf16_f32 v82, v44, v45
  v_cvt_pk_bf16_f32 v83, v46, v47
  v_xor_b32 v84, 0x80008000, v80
  v_xor_b32 v85, 0x80008000, v81
  v_xor_b32 v86, 0x80008000, v82
  v_xor_b32 v87, 0x80008000, v83
  s_add_u32 s45, s44, 3072
  buffer_store_dwordx4 v[76:79], v9, s[16:19], s45 offen
  s_add_u32 s45, s44, 4096
  buffer_store_dwordx4 v[80:83], v9, s[16:19], s45 offen
  s_add_u32 s45, s44, 5120
  buffer_store_dwordx4 v[84:87], v9, s[16:19], s45 offen
K1_t3:
  s_cmp_lg_u32 s2, 258
  s_cbranch_scc1 K1_t6
  v_mul_f32 v21, 0x3c800000, v17
  v_mul_f32 v22, 0x41000000, v20
  v_add_f32 v22, 0x00000000, v22
  v_mul_f32 v22, v22, v21
  v_fract_f32 v22, v22
  v_cos_f32 v32, v22
  v_fma_f32 v33, v21, 1.0, v22
  v_cos_f32 v33, v33
  v_fma_f32 v34, v21, 2.0, v22
  v_cos_f32 v34, v34
  s_mov_b32 s60, 0x40400000
  v_fma_f32 v35, v21, s60, v22
  v_cos_f32 v35, v35
  v_fma_f32 v36, v21, 4.0, v22
  v_cos_f32 v36, v36
  s_mov_b32 s60, 0x40a00000
  v_fma_f32 v37, v21, s60, v22
  v_cos_f32 v37, v37
  s_mov_b32 s60, 0x40c00000
  v_fma_f32 v38, v21, s60, v22
  v_cos_f32 v38, v38
  s_mov_b32 s60, 0x40e00000
  v_fma_f32 v39, v21, s60, v22
  v_cos_f32 v39, v39
  s_nop 0
  v_cvt_pk_bf16_f32 v88, v32, v33
  v_cvt_pk_bf16_f32 v89, v34, v35
  v_cvt_pk_bf16_f32 v90, v36, v37
  v_cvt_pk_bf16_f32 v91, v38, v39
  v_sin_f32 v40, v22
  v_fma_f32 v41, v21, 1.0, v22
  v_sin_f32 v41, v41
  v_fma_f32 v42, v21, 2.0, v22
  v_sin_f32 v42, v42
  s_mov_b32 s60, 0x40400000
  v_fma_f32 v43, v21, s60, v22
  v_sin_f32 v43, v43
  v_fma_f32 v44, v21, 4.0, v22
  v_sin_f32 v44, v44
  s_mov_b32 s60, 0x40a00000
  v_fma_f32 v45, v21, s60, v22
  v_sin_f32 v45, v45
  s_mov_b32 s60, 0x40c00000
  v_fma_f32 v46, v21, s60, v22
  v_sin_f32 v46, v46
  s_mov_b32 s60, 0x40e00000
  v_fma_f32 v47, v21, s60, v22
  v_sin_f32 v47, v47
  s_nop 0
  v_cvt_pk_bf16_f32 v92, v40, v41
  v_cvt_pk_bf16_f32 v93, v42, v43
  v_cvt_pk_bf16_f32 v94, v44, v45
  v_cvt_pk_bf16_f32 v95, v46, v47
  v_xor_b32 v96, 0x80008000, v92
  v_xor_b32 v97, 0x80008000, v93
  v_xor_b32 v98, 0x80008000, v94
  v_xor_b32 v99, 0x80008000, v95
  s_add_u32 s45, s44, 6144
  buffer_store_dwordx4 v[88:91], v9, s[16:19], s45 offen
  s_add_u32 s45, s44, 7168
  buffer_store_dwordx4 v[92:95], v9, s[16:19], s45 offen
  s_add_u32 s45, s44, 8192
  buffer_store_dwordx4 v[96:99], v9, s[16:19], s45 offen
K1_t6:
  s_cmp_lg_u32 s2, 259
  s_cbranch_scc1 K1_t9
  v_mul_f32 v21, 0x3c800000, v17
  v_mul_f32 v22, 0x41000000, v20
  v_add_f32 v22, 0x42000000, v22
  v_mul_f32 v22, v22, v21
  v_fract_f32 v22, v22
  v_cos_f32 v32, v22
  v_fma_f32 v33, v21, 1.0, v22
  v_cos_f32 v33, v33
  v_fma_f32 v34, v21, 2.0, v22
  v_cos_f32 v34, v34
  s_mov_b32 s60, 0x40400000
  v_fma_f32 v35, v21, s60, v22
  v_cos_f32 v35, v35
  v_fma_f32 v36, v21, 4.0, v22
  v_cos_f32 v36, v36
  s_mov_b32 s60, 0x40a00000
  v_fma_f32 v37, v21, s60, v22
  v_cos_f32 v37, v37
  s_mov_b32 s60, 0x40c00000
  v_fma_f32 v38, v21, s60, v22
  v_cos_f32 v38, v38
  s_mov_b32 s60, 0x40e00000
  v_fma_f32 v39, v21, s60, v22
  v_cos_f32 v39, v39
  s_nop 0
  v_cvt_pk_bf16_f32 v100, v32, v33
  v_cvt_pk_bf16_f32 v101, v34, v35
  v_cvt_pk_bf16_f32 v102, v36, v37
  v_cvt_pk_bf16_f32 v103, v38, v39
  v_sin_f32 v40, v22
  v_fma_f32 v41, v21, 1.0, v22
  v_sin_f32 v41, v41
  v_fma_f32 v42, v21, 2.0, v22
  v_sin_f32 v42, v42
  s_mov_b32 s60, 0x40400000
  v_fma_f32 v43, v21, s60, v22
  v_sin_f32 v43, v43
  v_fma_f32 v44, v21, 4.0, v22
  v_sin_f32 v44, v44
  s_mov_b32 s60, 0x40a00000
  v_fma_f32 v45, v21, s60, v22
  v_sin_f32 v45, v45
  s_mov_b32 s60, 0x40c00000
  v_fma_f32 v46, v21, s60, v22
  v_sin_f32 v46, v46
  s_mov_b32 s60, 0x40e00000
  v_fma_f32 v47, v21, s60, v22
  v_sin_f32 v47, v47
  s_nop 0
  v_cvt_pk_bf16_f32 v104, v40, v41
  v_cvt_pk_bf16_f32 v105, v42, v43
  v_cvt_pk_bf16_f32 v106, v44, v45
  v_cvt_pk_bf16_f32 v107, v46, v47
  v_xor_b32 v108, 0x80008000, v104
  v_xor_b32 v109, 0x80008000, v105
  v_xor_b32 v110, 0x80008000, v106
  v_xor_b32 v111, 0x80008000, v107
  s_add_u32 s45, s44, 9216
  buffer_store_dwordx4 v[100:103], v9, s[16:19], s45 offen
  s_add_u32 s45, s44, 10240
  buffer_store_dwordx4 v[104:107], v9, s[16:19], s45 offen
  s_add_u32 s45, s44, 11264
  buffer_store_dwordx4 v[108:111], v9, s[16:19], s45 offen
K1_t9:
  s_cmp_lg_u32 s2, 256
  s_cbranch_scc1 K1_t12
  v_mul_f32 v21, 0x3d000000, v18
  v_mul_f32 v22, 4.0, v20
  v_mul_f32 v22, v22, v21
  v_fract_f32 v22, v22
  v_cos_f32 v32, v22
  v_fma_f32 v33, v21, 1.0, v22
  v_cos_f32 v33, v33
  v_fma_f32 v34, v21, 2.0, v22
  v_cos_f32 v34, v34
  s_mov_b32 s60, 0x40400000
  v_fma_f32 v35, v21, s60, v22
  v_cos_f32 v35, v35
  s_mov_b32 s60, 0x41800000
  v_fma_f32 v36, v21, s60, v22
  v_cos_f32 v36, v36
  s_mov_b32 s60, 0x41880000
  v_fma_f32 v37, v21, s60, v22
  v_cos_f32 v37, v37
  s_mov_b32 s60, 0x41900000
  v_fma_f32 v38, v21, s60, v22
  v_cos_f32 v38, v38
  s_mov_b32 s60, 0x41980000
  v_fma_f32 v39, v21, s60, v22
  v_cos_f32 v39, v39
  s_nop 0
  v_cvt_pk_bf16_f32 v112, v32, v33
  v_cvt_pk_bf16_f32 v113, v34, v35
  v_cvt_pk_bf16_f32 v114, v36, v37
  v_cvt_pk_bf16_f32 v115, v38, v39
  v_sin_f32 v40, v22
  v_fma_f32 v41, v21, 1.0, v22
  v_sin_f32 v41, v41
  v_fma_f32 v42, v21, 2.0, v22
  v_sin_f32 v42, v42
  s_mov_b32 s60, 0x40400000
  v_fma_f32 v43, v21, s60, v22
  v_sin_f32 v43, v43
  s_mov_b32 s60, 0x41800000
  v_fma_f32 v44, v21, s60, v22
  v_sin_f32 v44, v44
  s_mov_b32 s60, 0x41880000
  v_fma_f32 v45, v21, s60, v22
  v_sin_f32 v45, v45
  s_mov_b32 s60, 0x41900000
  v_fma_f32 v46, v21, s60, v22
  v_sin_f32 v46, v46
  s_mov_b32 s60, 0x41980000
  v_fma_f32 v47, v21, s60, v22
  v_sin_f32 v47, v47
  s_nop 0
  v_cvt_pk_bf16_f32 v116, v40, v41
  v_cvt_pk_bf16_f32 v117, v42, v43
  v_cvt_pk_bf16_f32 v118, v44, v45
  v_cvt_pk_bf16_f32 v119, v46, v47
  v_xor_b32 v120, 0x80008000, v116
  v_xor_b32 v121, 0x80008000, v117
  v_xor_b32 v122, 0x80008000, v118
  v_xor_b32 v123, 0x80008000, v119
  s_add_u32 s45, s44, 12288
  buffer_store_dwordx4 v[112:115], v9, s[16:19], s45 offen
  s_add_u32 s45, s44, 13312
  buffer_store_dwordx4 v[116:119], v9, s[16:19], s45 offen
  s_add_u32 s45, s44, 14336
  buffer_store_dwordx4 v[120:123], v9, s[16:19], s45 offen
K1_t12:
  s_cmp_lg_u32 s2, 257
  s_cbranch_scc1 K1_t15
  v_mul_f32 v21, 0x3d000000, v19
  v_mul_f32 v22, 4.0, v20
  v_mul_f32 v22, v22, v21
  v_fract_f32 v22, v22
  v_cos_f32 v32, v22
  v_fma_f32 v33, v21, 1.0, v22
  v_cos_f32 v33, v33
  v_fma_f32 v34, v21, 2.0, v22
  v_cos_f32 v34, v34
  s_mov_b32 s60, 0x40400000
  v_fma_f32 v35, v21, s60, v22
  v_cos_f32 v35, v35
  s_mov_b32 s60, 0x41800000
  v_fma_f32 v36, v21, s60, v22
  v_cos_f32 v36, v36
  s_mov_b32 s60, 0x41880000
  v_fma_f32 v37, v21, s60, v22
  v_cos_f32 v37, v37
  s_mov_b32 s60, 0x41900000
  v_fma_f32 v38, v21, s60, v22
  v_cos_f32 v38, v38
  s_mov_b32 s60, 0x41980000
  v_fma_f32 v39, v21, s60, v22
  v_cos_f32 v39, v39
  s_nop 0
  v_cvt_pk_bf16_f32 v124, v32, v33
  v_cvt_pk_bf16_f32 v125, v34, v35
  v_cvt_pk_bf16_f32 v126, v36, v37
  v_cvt_pk_bf16_f32 v127, v38, v39
  v_sin_f32 v40, v22
  v_fma_f32 v41, v21, 1.0, v22
  v_sin_f32 v41, v41
  v_fma_f32 v42, v21, 2.0, v22
  v_sin_f32 v42, v42
  s_mov_b32 s60, 0x40400000
  v_fma_f32 v43, v21, s60, v22
  v_sin_f32 v43, v43
  s_mov_b32 s60, 0x41800000
  v_fma_f32 v44, v21, s60, v22
  v_sin_f32 v44, v44
  s_mov_b32 s60, 0x41880000
  v_fma_f32 v45, v21, s60, v22
  v_sin_f32 v45, v45
  s_mov_b32 s60, 0x41900000
  v_fma_f32 v46, v21, s60, v22
  v_sin_f32 v46, v46
  s_mov_b32 s60, 0x41980000
  v_fma_f32 v47, v21, s60, v22
  v_sin_f32 v47, v47
  s_nop 0
  v_cvt_pk_bf16_f32 v128, v40, v41
  v_cvt_pk_bf16_f32 v129, v42, v43
  v_cvt_pk_bf16_f32 v130, v44, v45
  v_cvt_pk_bf16_f32 v131, v46, v47
  v_xor_b32 v132, 0x80008000, v128
  v_xor_b32 v133, 0x80008000, v129
  v_xor_b32 v134, 0x80008000, v130
  v_xor_b32 v135, 0x80008000, v131
  s_add_u32 s45, s44, 15360
  buffer_store_dwordx4 v[124:127], v9, s[16:19], s45 offen
  s_add_u32 s45, s44, 16384
  buffer_store_dwordx4 v[128:131], v9, s[16:19], s45 offen
  s_add_u32 s45, s44, 17408
  buffer_store_dwordx4 v[132:135], v9, s[16:19], s45 offen
K1_t15:
  s_lshl_b32 s6, s4, 4
  v_lshl_add_u32 v23, v15, 2, s6
  v_cvt_f32_u32 v23, v23
  s_cmp_lg_u32 s2, 258
  s_cbranch_scc1 K1_t18
  v_mul_f32 v21, 0x3a000000, v16
  v_mul_f32 v22, v21, v23
  v_cos_f32 v136, v22
  v_sin_f32 v140, v22
  v_add_f32 v22, v22, v21
  v_cos_f32 v137, v22
  v_sin_f32 v141, v22
  v_add_f32 v22, v22, v21
  v_cos_f32 v138, v22
  v_sin_f32 v142, v22
  v_add_f32 v22, v22, v21
  v_cos_f32 v139, v22
  v_sin_f32 v143, v22
  s_nop 0
  s_add_u32 s45, s44, 18432
  buffer_store_dwordx4 v[136:139], v9, s[16:19], s45 offen
  s_add_u32 s45, s44, 19456
  buffer_store_dwordx4 v[140:143], v9, s[16:19], s45 offen
K1_t18:
  s_cmp_lg_u32 s2, 259
  s_cbranch_scc1 K1_t20
  v_mul_f32 v21, 0x3a000000, v17
  v_mul_f32 v22, v21, v23
  v_cos_f32 v144, v22
  v_sin_f32 v148, v22
  v_add_f32 v22, v22, v21
  v_cos_f32 v145, v22
  v_sin_f32 v149, v22
  v_add_f32 v22, v22, v21
  v_cos_f32 v146, v22
  v_sin_f32 v150, v22
  v_add_f32 v22, v22, v21
  v_cos_f32 v147, v22
  v_sin_f32 v151, v22
  s_nop 0
  s_add_u32 s45, s44, 20480
  buffer_store_dwordx4 v[144:147], v9, s[16:19], s45 offen
  s_add_u32 s45, s44, 21504
  buffer_store_dwordx4 v[148:151], v9, s[16:19], s45 offen
K1_t20:
  s_lshl_b32 s6, s3, 4
  v_lshl_add_u32 v23, v15, 2, s6
  v_cvt_f32_u32 v23, v23
  s_cmp_lg_u32 s2, 258
  s_cbranch_scc1 K1_t22
  v_mul_f32 v21, 0x3a000000, v18
  v_mul_f32 v22, v21, v23
  v_cos_f32 v152, v22
  v_sin_f32 v156, v22
  v_add_f32 v22, v22, v21
  v_cos_f32 v153, v22
  v_sin_f32 v157, v22
  v_add_f32 v22, v22, v21
  v_cos_f32 v154, v22
  v_sin_f32 v158, v22
  v_add_f32 v22, v22, v21
  v_cos_f32 v155, v22
  v_sin_f32 v159, v22
  s_nop 0
  v_mul_f32 v152, 0x3a000000, v152
  v_mul_f32 v153, 0x3a000000, v153
  v_mul_f32 v154, 0x3a000000, v154
  v_mul_f32 v155, 0x3a000000, v155
  v_mul_f32 v156, 0x3a000000, v156
  v_mul_f32 v157, 0x3a000000, v157
  v_mul_f32 v158, 0x3a000000, v158
  v_mul_f32 v159, 0x3a000000, v159
  s_nop 0
  s_add_u32 s45, s44, 22528
  buffer_store_dwordx4 v[152:155], v9, s[16:19], s45 offen
  s_add_u32 s45, s44, 23552
  buffer_store_dwordx4 v[156:159], v9, s[16:19], s45 offen
K1_t22:
  s_cmp_lg_u32 s2, 259
  s_cbranch_scc1 K1_t24
  v_mul_f32 v21, 0x3a000000, v19
  v_mul_f32 v22, v21, v23
  v_cos_f32 v160, v22
  v_sin_f32 v164, v22
  v_add_f32 v22, v22, v21
  v_cos_f32 v161, v22
  v_sin_f32 v165, v22
  v_add_f32 v22, v22, v21
  v_cos_f32 v162, v22
  v_sin_f32 v166, v22
  v_add_f32 v22, v22, v21
  v_cos_f32 v163, v22
  v_sin_f32 v167, v22
  s_nop 0
  v_mul_f32 v160, 0x3a000000, v160
  v_mul_f32 v161, 0x3a000000, v161
  v_mul_f32 v162, 0x3a000000, v162
  v_mul_f32 v163, 0x3a000000, v163
  v_mul_f32 v164, 0x3a000000, v164
  v_mul_f32 v165, 0x3a000000, v165
  v_mul_f32 v166, 0x3a000000, v166
  v_mul_f32 v167, 0x3a000000, v167
  s_nop 0
  s_add_u32 s45, s44, 24576
  buffer_store_dwordx4 v[160:163], v9, s[16:19], s45 offen
  s_add_u32 s45, s44, 25600
  buffer_store_dwordx4 v[164:167], v9, s[16:19], s45 offen
K1_t24:
K1_exit:
  s_endpgm
  .p2align 8
  .globl k2_kernel
  .type k2_kernel,@function
k2_kernel:
  s_cmp_ge_u32 s2, 256
  s_cbranch_scc1 K2_exit
  s_load_dwordx2 s[78:79], s[0:1], 80
  v_lshrrev_b32 v4, 6, v0
  v_and_b32 v1, 63, v0
  v_readfirstlane_b32 s3, v4
  v_lshrrev_b32 v2, 5, v1
  v_and_b32 v3, 31, v1
  v_cmp_gt_u32 s[48:49], 16, v3
  s_waitcnt lgkmcnt(0)
  s_cmp_ge_u32 s3, 8
  s_cbranch_scc1 K2_fft
  s_mov_b32 s8, s78
  s_mov_b32 s9, s79
  s_mov_b32 s10, 2097152
  s_mov_b32 s11, 0x00020000
  s_add_u32 s12, s78, 2097152
  s_addc_u32 s13, s79, 0
  s_mov_b32 s14, 131072
  s_mov_b32 s15, 0x00020000
  s_add_u32 s16, s78, 5242880
  s_addc_u32 s17, s79, 0
  s_mov_b32 s18, 2097152
  s_mov_b32 s19, 0x00020000
  v_lshlrev_b32 v11, 4, v2
  v_lshl_or_b32 v11, v3, 5, v11
  s_lshl_b32 s6, s2, 3
  s_add_u32 s6, s6, s3
  s_lshl_b32 s6, s6, 10
  buffer_load_dwordx4 v[4:7], v11, s[8:11], s6 offen
  v_lshlrev_b32 v9, 4, v1
  s_lshl_b32 s40, s3, 10
  s_mov_b32 m0, s40
  s_add_u32 s41, s40, 0x10000
  buffer_load_dwordx4 v9, s[12:15], s40 offen lds
  s_mov_b32 m0, s41
  s_add_u32 s40, s40, 8192
  buffer_load_dwordx4 v9, s[12:15], s41 offen lds
  s_mov_b32 m0, s40
  s_add_u32 s41, s40, 0x10000
  buffer_load_dwordx4 v9, s[12:15], s40 offen lds
  s_mov_b32 m0, s41
  s_add_u32 s40, s40, 8192
  buffer_load_dwordx4 v9, s[12:15], s41 offen lds
  s_mov_b32 m0, s40
  s_add_u32 s41, s40, 0x10000
  buffer_load_dwordx4 v9, s[12:15], s40 offen lds
  s_mov_b32 m0, s41
  s_add_u32 s40, s40, 8192
  buffer_load_dwordx4 v9, s[12:15], s41 offen lds
  v_mov_b32 v12, 0x3f803f80
  v_mov_b32 v13, 0x3f803f80
  s_lshl_b32 s7, s3, 9
  s_add_u32 s7, s7, 131072
  v_lshl_add_u32 v14, v1, 3, s7
  ds_write_b64 v14, v[12:13]
  v_lshlrev_b32 v14, 4, v3
  v_lshl_or_b32 v14, v2, 8, v14
  v_add_u32 v14, 65536, v14
  v_cmp_gt_u32 vcc, 16, v3
  v_mov_b32 v15, 131072
  v_mov_b32 v12, 0x1000
  v_cndmask_b32 v8, v15, v14, vcc
  v_cndmask_b32 v10, 0, v12, vcc
  s_waitcnt vmcnt(4) lgkmcnt(0)
  s_barrier
  ds_read_b128 v[72:75], v9 offset:0
  ds_read_b128 v[76:79], v9 offset:1024
  ds_read_b128 v[80:83], v8 offset:0
  ds_read_b128 v[84:87], v8 offset:512
  s_waitcnt lgkmcnt(3)
  v_mfma_f32_32x32x16_bf16 v[16:31], v[72:75], v[4:7], 0
  s_nop 7
  s_nop 3
  s_waitcnt lgkmcnt(0)
  v_mfma_f32_32x32x16_bf16 v[32:47], v[76:79], v[4:7], 0
  ds_read_b128 v[72:75], v9 offset:2048
  v_exp_f32 v16, v16
  v_exp_f32 v17, v17
  v_exp_f32 v18, v18
  v_exp_f32 v19, v19
  ds_read_b128 v[88:91], v8 offset:1024
  ds_read_b128 v[92:95], v8 offset:1536
  v_cvt_pk_bf16_f32 v64, v16, v17
  v_exp_f32 v20, v20
  v_exp_f32 v21, v21
  v_cvt_pk_bf16_f32 v65, v18, v19
  v_exp_f32 v22, v22
  v_exp_f32 v23, v23
  v_cvt_pk_bf16_f32 v66, v20, v21
  v_exp_f32 v24, v24
  v_cvt_pk_bf16_f32 v67, v22, v23
  v_exp_f32 v25, v25
  v_exp_f32 v26, v26
  v_mfma_f32_32x32x16_bf16 v[48:63], v[80:83], v[64:67], 0
  v_exp_f32 v27, v27
  v_cvt_pk_bf16_f32 v68, v24, v25
  v_exp_f32 v28, v28
  v_exp_f32 v29, v29
  v_cvt_pk_bf16_f32 v69, v26, v27
  v_exp_f32 v30, v30
  v_exp_f32 v31, v31
  v_cvt_pk_bf16_f32 v70, v28, v29
  v_cvt_pk_bf16_f32 v71, v30, v31
  s_waitcnt lgkmcnt(0)
  v_mfma_f32_32x32x16_bf16 v[16:31], v[72:75], v[4:7], 0
  ds_read_b128 v[76:79], v9 offset:3072
  v_exp_f32 v32, v32
  v_exp_f32 v33, v33
  v_exp_f32 v34, v34
  v_exp_f32 v35, v35
  v_mfma_f32_32x32x16_bf16 v[48:63], v[84:87], v[68:71], v[48:63]
  ds_read_b128 v[80:83], v8 offset:2048
  ds_read_b128 v[84:87], v8 offset:2560
  v_cvt_pk_bf16_f32 v64, v32, v33
  v_exp_f32 v36, v36
  v_exp_f32 v37, v37
  v_cvt_pk_bf16_f32 v65, v34, v35
  v_exp_f32 v38, v38
  v_exp_f32 v39, v39
  v_cvt_pk_bf16_f32 v66, v36, v37
  v_exp_f32 v40, v40
  v_cvt_pk_bf16_f32 v67, v38, v39
  v_exp_f32 v41, v41
  v_exp_f32 v42, v42
  v_mfma_f32_32x32x16_bf16 v[48:63], v[88:91], v[64:67], v[48:63]
  v_exp_f32 v43, v43
  v_cvt_pk_bf16_f32 v68, v40, v41
  v_exp_f32 v44, v44
  v_exp_f32 v45, v45
  v_cvt_pk_bf16_f32 v69, v42, v43
  v_exp_f32 v46, v46
  v_exp_f32 v47, v47
  v_cvt_pk_bf16_f32 v70, v44, v45
  v_cvt_pk_bf16_f32 v71, v46, v47
  s_waitcnt lgkmcnt(0)
  v_mfma_f32_32x32x16_bf16 v[32:47], v[76:79], v[4:7], 0
  ds_read_b128 v[72:75], v9 offset:4096
  v_exp_f32 v16, v16
  v_exp_f32 v17, v17
  v_exp_f32 v18, v18
  v_exp_f32 v19, v19
  v_mfma_f32_32x32x16_bf16 v[48:63], v[92:95], v[68:71], v[48:63]
  ds_read_b128 v[88:91], v8 offset:3072
  ds_read_b128 v[92:95], v8 offset:3584
  v_cvt_pk_bf16_f32 v64, v16, v17
  v_exp_f32 v20, v20
  v_exp_f32 v21, v21
  v_cvt_pk_bf16_f32 v65, v18, v19
  v_exp_f32 v22, v22
  v_exp_f32 v23, v23
  v_cvt_pk_bf16_f32 v66, v20, v21
  v_exp_f32 v24, v24
  v_cvt_pk_bf16_f32 v67, v22, v23
  v_exp_f32 v25, v25
  v_exp_f32 v26, v26
  v_mfma_f32_32x32x16_bf16 v[48:63], v[80:83], v[64:67], v[48:63]
  v_exp_f32 v27, v27
  v_cvt_pk_bf16_f32 v68, v24, v25
  v_exp_f32 v28, v28
  v_exp_f32 v29, v29
  v_cvt_pk_bf16_f32 v69, v26, v27
  v_exp_f32 v30, v30
  v_exp_f32 v31, v31
  v_cvt_pk_bf16_f32 v70, v28, v29
  v_cvt_pk_bf16_f32 v71, v30, v31
  s_waitcnt lgkmcnt(0)
  v_mfma_f32_32x32x16_bf16 v[16:31], v[72:75], v[4:7], 0
  ds_read_b128 v[76:79], v9 offset:5120
  v_exp_f32 v32, v32
  v_exp_f32 v33, v33
  v_exp_f32 v34, v34
  v_exp_f32 v35, v35
  v_mfma_f32_32x32x16_bf16 v[48:63], v[84:87], v[68:71], v[48:63]
  v_add_u32 v8, v8, v10
  ds_read_b128 v[80:83], v8 offset:0
  ds_read_b128 v[84:87], v8 offset:512
  v_cvt_pk_bf16_f32 v64, v32, v33
  v_exp_f32 v36, v36
  v_exp_f32 v37, v37
  v_cvt_pk_bf16_f32 v65, v34, v35
  v_exp_f32 v38, v38
  v_exp_f32 v39, v39
  v_cvt_pk_bf16_f32 v66, v36, v37
  v_exp_f32 v40, v40
  v_cvt_pk_bf16_f32 v67, v38, v39
  v_exp_f32 v41, v41
  v_exp_f32 v42, v42
  v_mfma_f32_32x32x16_bf16 v[48:63], v[88:91], v[64:67], v[48:63]
  v_exp_f32 v43, v43
  v_cvt_pk_bf16_f32 v68, v40, v41
  v_exp_f32 v44, v44
  v_exp_f32 v45, v45
  v_cvt_pk_bf16_f32 v69, v42, v43
  v_exp_f32 v46, v46
  v_exp_f32 v47, v47
  v_cvt_pk_bf16_f32 v70, v44, v45
  v_cvt_pk_bf16_f32 v71, v46, v47
  s_waitcnt lgkmcnt(0)
  v_mfma_f32_32x32x16_bf16 v[32:47], v[76:79], v[4:7], 0
  ds_read_b128 v[72:75], v9 offset:6144
  v_exp_f32 v16, v16
  v_exp_f32 v17, v17
  v_exp_f32 v18, v18
  v_exp_f32 v19, v19
  v_mfma_f32_32x32x16_bf16 v[48:63], v[92:95], v[68:71], v[48:63]
  ds_read_b128 v[88:91], v8 offset:1024
  ds_read_b128 v[92:95], v8 offset:1536
  v_cvt_pk_bf16_f32 v64, v16, v17
  v_exp_f32 v20, v20
  v_exp_f32 v21, v21
  v_cvt_pk_bf16_f32 v65, v18, v19
  v_exp_f32 v22, v22
  v_exp_f32 v23, v23
  v_cvt_pk_bf16_f32 v66, v20, v21
  v_exp_f32 v24, v24
  v_cvt_pk_bf16_f32 v67, v22, v23
  v_exp_f32 v25, v25
  v_exp_f32 v26, v26
  v_mfma_f32_32x32x16_bf16 v[48:63], v[80:83], v[64:67], v[48:63]
  v_exp_f32 v27, v27
  v_cvt_pk_bf16_f32 v68, v24, v25
  v_exp_f32 v28, v28
  v_exp_f32 v29, v29
  v_cvt_pk_bf16_f32 v69, v26, v27
  v_exp_f32 v30, v30
  v_exp_f32 v31, v31
  v_cvt_pk_bf16_f32 v70, v28, v29
  v_cvt_pk_bf16_f32 v71, v30, v31
  s_waitcnt lgkmcnt(0)
  v_mfma_f32_32x32x16_bf16 v[16:31], v[72:75], v[4:7], 0
  ds_read_b128 v[76:79], v9 offset:7168
  v_exp_f32 v32, v32
  v_exp_f32 v33, v33
  v_exp_f32 v34, v34
  v_exp_f32 v35, v35
  v_mfma_f32_32x32x16_bf16 v[48:63], v[84:87], v[68:71], v[48:63]
  ds_read_b128 v[80:83], v8 offset:2048
  ds_read_b128 v[84:87], v8 offset:2560
  v_cvt_pk_bf16_f32 v64, v32, v33
  v_exp_f32 v36, v36
  v_exp_f32 v37, v37
  v_cvt_pk_bf16_f32 v65, v34, v35
  v_exp_f32 v38, v38
  v_exp_f32 v39, v39
  v_cvt_pk_bf16_f32 v66, v36, v37
  v_exp_f32 v40, v40
  v_cvt_pk_bf16_f32 v67, v38, v39
  v_exp_f32 v41, v41
  v_exp_f32 v42, v42
  v_mfma_f32_32x32x16_bf16 v[48:63], v[88:91], v[64:67], v[48:63]
  v_exp_f32 v43, v43
  v_cvt_pk_bf16_f32 v68, v40, v41
  v_exp_f32 v44, v44
  v_exp_f32 v45, v45
  v_cvt_pk_bf16_f32 v69, v42, v43
  v_exp_f32 v46, v46
  v_exp_f32 v47, v47
  v_cvt_pk_bf16_f32 v70, v44, v45
  v_cvt_pk_bf16_f32 v71, v46, v47
  s_waitcnt vmcnt(2) lgkmcnt(0)
  s_barrier
  s_mov_b32 m0, s40
  s_add_u32 s41, s40, 0x10000
  buffer_load_dwordx4 v9, s[12:15], s40 offen lds
  s_mov_b32 m0, s41
  s_add_u32 s40, s40, 8192
  buffer_load_dwordx4 v9, s[12:15], s41 offen lds
  v_mfma_f32_32x32x16_bf16 v[32:47], v[76:79], v[4:7], 0
  ds_read_b128 v[72:75], v9 offset:8192
  v_exp_f32 v16, v16
  v_exp_f32 v17, v17
  v_exp_f32 v18, v18
  v_exp_f32 v19, v19
  v_mfma_f32_32x32x16_bf16 v[48:63], v[92:95], v[68:71], v[48:63]
  ds_read_b128 v[88:91], v8 offset:3072
  ds_read_b128 v[92:95], v8 offset:3584
  v_cvt_pk_bf16_f32 v64, v16, v17
  v_exp_f32 v20, v20
  v_exp_f32 v21, v21
  v_cvt_pk_bf16_f32 v65, v18, v19
  v_exp_f32 v22, v22
  v_exp_f32 v23, v23
  v_cvt_pk_bf16_f32 v66, v20, v21
  v_exp_f32 v24, v24
  v_cvt_pk_bf16_f32 v67, v22, v23
  v_exp_f32 v25, v25
  v_exp_f32 v26, v26
  v_mfma_f32_32x32x16_bf16 v[48:63], v[80:83], v[64:67], v[48:63]
  v_exp_f32 v27, v27
  v_cvt_pk_bf16_f32 v68, v24, v25
  v_exp_f32 v28, v28
  v_exp_f32 v29, v29
  v_cvt_pk_bf16_f32 v69, v26, v27
  v_exp_f32 v30, v30
  v_exp_f32 v31, v31
  v_cvt_pk_bf16_f32 v70, v28, v29
  v_cvt_pk_bf16_f32 v71, v30, v31
  s_waitcnt lgkmcnt(0)
  v_mfma_f32_32x32x16_bf16 v[16:31], v[72:75], v[4:7], 0
  ds_read_b128 v[76:79], v9 offset:9216
  v_exp_f32 v32, v32
  v_exp_f32 v33, v33
  v_exp_f32 v34, v34
  v_exp_f32 v35, v35
  v_mfma_f32_32x32x16_bf16 v[48:63], v[84:87], v[68:71], v[48:63]
  v_add_u32 v8, v8, v10
  ds_read_b128 v[80:83], v8 offset:0
  ds_read_b128 v[84:87], v8 offset:512
  v_cvt_pk_bf16_f32 v64, v32, v33
  v_exp_f32 v36, v36
  v_exp_f32 v37, v37
  v_cvt_pk_bf16_f32 v65, v34, v35
  v_exp_f32 v38, v38
  v_exp_f32 v39, v39
  v_cvt_pk_bf16_f32 v66, v36, v37
  v_exp_f32 v40, v40
  v_cvt_pk_bf16_f32 v67, v38, v39
  v_exp_f32 v41, v41
  v_exp_f32 v42, v42
  v_mfma_f32_32x32x16_bf16 v[48:63], v[88:91], v[64:67], v[48:63]
  v_exp_f32 v43, v43
  v_cvt_pk_bf16_f32 v68, v40, v41
  v_exp_f32 v44, v44
  v_exp_f32 v45, v45
  v_cvt_pk_bf16_f32 v69, v42, v43
  v_exp_f32 v46, v46
  v_exp_f32 v47, v47
  v_cvt_pk_bf16_f32 v70, v44, v45
  v_cvt_pk_bf16_f32 v71, v46, v47
  s_waitcnt lgkmcnt(0)
  v_mfma_f32_32x32x16_bf16 v[32:47], v[76:79], v[4:7], 0
  ds_read_b128 v[72:75], v9 offset:10240
  v_exp_f32 v16, v16
  v_exp_f32 v17, v17
  v_exp_f32 v18, v18
  v_exp_f32 v19, v19
  v_mfma_f32_32x32x16_bf16 v[48:63], v[92:95], v[68:71], v[48:63]
  ds_read_b128 v[88:91], v8 offset:1024
  ds_read_b128 v[92:95], v8 offset:1536
  v_cvt_pk_bf16_f32 v64, v16, v17
  v_exp_f32 v20, v20
  v_exp_f32 v21, v21
  v_cvt_pk_bf16_f32 v65, v18, v19
  v_exp_f32 v22, v22
  v_exp_f32 v23, v23
  v_cvt_pk_bf16_f32 v66, v20, v21
  v_exp_f32 v24, v24
  v_cvt_pk_bf16_f32 v67, v22, v23
  v_exp_f32 v25, v25
  v_exp_f32 v26, v26
  v_mfma_f32_32x32x16_bf16 v[48:63], v[80:83], v[64:67], v[48:63]
  v_exp_f32 v27, v27
  v_cvt_pk_bf16_f32 v68, v24, v25
  v_exp_f32 v28, v28
  v_exp_f32 v29, v29
  v_cvt_pk_bf16_f32 v69, v26, v27
  v_exp_f32 v30, v30
  v_exp_f32 v31, v31
  v_cvt_pk_bf16_f32 v70, v28, v29
  v_cvt_pk_bf16_f32 v71, v30, v31
  s_waitcnt lgkmcnt(0)
  v_mfma_f32_32x32x16_bf16 v[16:31], v[72:75], v[4:7], 0
  ds_read_b128 v[76:79], v9 offset:11264
  v_exp_f32 v32, v32
  v_exp_f32 v33, v33
  v_exp_f32 v34, v34
  v_exp_f32 v35, v35
  v_mfma_f32_32x32x16_bf16 v[48:63], v[84:87], v[68:71], v[48:63]
  ds_read_b128 v[80:83], v8 offset:2048
  ds_read_b128 v[84:87], v8 offset:2560
  v_cvt_pk_bf16_f32 v64, v32, v33
  v_exp_f32 v36, v36
  v_exp_f32 v37, v37
  v_cvt_pk_bf16_f32 v65, v34, v35
  v_exp_f32 v38, v38
  v_exp_f32 v39, v39
  v_cvt_pk_bf16_f32 v66, v36, v37
  v_exp_f32 v40, v40
  v_cvt_pk_bf16_f32 v67, v38, v39
  v_exp_f32 v41, v41
  v_exp_f32 v42, v42
  v_mfma_f32_32x32x16_bf16 v[48:63], v[88:91], v[64:67], v[48:63]
  v_exp_f32 v43, v43
  v_cvt_pk_bf16_f32 v68, v40, v41
  v_exp_f32 v44, v44
  v_exp_f32 v45, v45
  v_cvt_pk_bf16_f32 v69, v42, v43
  v_exp_f32 v46, v46
  v_exp_f32 v47, v47
  v_cvt_pk_bf16_f32 v70, v44, v45
  v_cvt_pk_bf16_f32 v71, v46, v47
  s_waitcnt lgkmcnt(0)
  v_mfma_f32_32x32x16_bf16 v[32:47], v[76:79], v[4:7], 0
  ds_read_b128 v[72:75], v9 offset:12288
  v_exp_f32 v16, v16
  v_exp_f32 v17, v17
  v_exp_f32 v18, v18
  v_exp_f32 v19, v19
  v_mfma_f32_32x32x16_bf16 v[48:63], v[92:95], v[68:71], v[48:63]
  ds_read_b128 v[88:91], v8 offset:3072
  ds_read_b128 v[92:95], v8 offset:3584
  v_cvt_pk_bf16_f32 v64, v16, v17
  v_exp_f32 v20, v20
  v_exp_f32 v21, v21
  v_cvt_pk_bf16_f32 v65, v18, v19
  v_exp_f32 v22, v22
  v_exp_f32 v23, v23
  v_cvt_pk_bf16_f32 v66, v20, v21
  v_exp_f32 v24, v24
  v_cvt_pk_bf16_f32 v67, v22, v23
  v_exp_f32 v25, v25
  v_exp_f32 v26, v26
  v_mfma_f32_32x32x16_bf16 v[48:63], v[80:83], v[64:67], v[48:63]
  v_exp_f32 v27, v27
  v_cvt_pk_bf16_f32 v68, v24, v25
  v_exp_f32 v28, v28
  v_exp_f32 v29, v29
  v_cvt_pk_bf16_f32 v69, v26, v27
  v_exp_f32 v30, v30
  v_exp_f32 v31, v31
  v_cvt_pk_bf16_f32 v70, v28, v29
  v_cvt_pk_bf16_f32 v71, v30, v31
  s_waitcnt lgkmcnt(0)
  v_mfma_f32_32x32x16_bf16 v[16:31], v[72:75], v[4:7], 0
  ds_read_b128 v[76:79], v9 offset:13312
  v_exp_f32 v32, v32
  v_exp_f32 v33, v33
  v_exp_f32 v34, v34
  v_exp_f32 v35, v35
  v_mfma_f32_32x32x16_bf16 v[48:63], v[84:87], v[68:71], v[48:63]
  v_add_u32 v8, v8, v10
  ds_read_b128 v[80:83], v8 offset:0
  ds_read_b128 v[84:87], v8 offset:512
  v_cvt_pk_bf16_f32 v64, v32, v33
  v_exp_f32 v36, v36
  v_exp_f32 v37, v37
  v_cvt_pk_bf16_f32 v65, v34, v35
  v_exp_f32 v38, v38
  v_exp_f32 v39, v39
  v_cvt_pk_bf16_f32 v66, v36, v37
  v_exp_f32 v40, v40
  v_cvt_pk_bf16_f32 v67, v38, v39
  v_exp_f32 v41, v41
  v_exp_f32 v42, v42
  v_mfma_f32_32x32x16_bf16 v[48:63], v[88:91], v[64:67], v[48:63]
  v_exp_f32 v43, v43
  v_cvt_pk_bf16_f32 v68, v40, v41
  v_exp_f32 v44, v44
  v_exp_f32 v45, v45
  v_cvt_pk_bf16_f32 v69, v42, v43
  v_exp_f32 v46, v46
  v_exp_f32 v47, v47
  v_cvt_pk_bf16_f32 v70, v44, v45
  v_cvt_pk_bf16_f32 v71, v46, v47
  s_waitcnt lgkmcnt(0)
  v_mfma_f32_32x32x16_bf16 v[32:47], v[76:79], v[4:7], 0
  ds_read_b128 v[72:75], v9 offset:14336
  v_exp_f32 v16, v16
  v_exp_f32 v17, v17
  v_exp_f32 v18, v18
  v_exp_f32 v19, v19
  v_mfma_f32_32x32x16_bf16 v[48:63], v[92:95], v[68:71], v[48:63]
  ds_read_b128 v[88:91], v8 offset:1024
  ds_read_b128 v[92:95], v8 offset:1536
  v_cvt_pk_bf16_f32 v64, v16, v17
  v_exp_f32 v20, v20
  v_exp_f32 v21, v21
  v_cvt_pk_bf16_f32 v65, v18, v19
  v_exp_f32 v22, v22
  v_exp_f32 v23, v23
  v_cvt_pk_bf16_f32 v66, v20, v21
  v_exp_f32 v24, v24
  v_cvt_pk_bf16_f32 v67, v22, v23
  v_exp_f32 v25, v25
  v_exp_f32 v26, v26
  v_mfma_f32_32x32x16_bf16 v[48:63], v[80:83], v[64:67], v[48:63]
  v_exp_f32 v27, v27
  v_cvt_pk_bf16_f32 v68, v24, v25
  v_exp_f32 v28, v28
  v_exp_f32 v29, v29
  v_cvt_pk_bf16_f32 v69, v26, v27
  v_exp_f32 v30, v30
  v_exp_f32 v31, v31
  v_cvt_pk_bf16_f32 v70, v28, v29
  v_cvt_pk_bf16_f32 v71, v30, v31
  s_waitcnt lgkmcnt(0)
  v_mfma_f32_32x32x16_bf16 v[16:31], v[72:75], v[4:7], 0
  ds_read_b128 v[76:79], v9 offset:15360
  v_exp_f32 v32, v32
  v_exp_f32 v33, v33
  v_exp_f32 v34, v34
  v_exp_f32 v35, v35
  v_mfma_f32_32x32x16_bf16 v[48:63], v[84:87], v[68:71], v[48:63]
  ds_read_b128 v[80:83], v8 offset:2048
  ds_read_b128 v[84:87], v8 offset:2560
  v_cvt_pk_bf16_f32 v64, v32, v33
  v_exp_f32 v36, v36
  v_exp_f32 v37, v37
  v_cvt_pk_bf16_f32 v65, v34, v35
  v_exp_f32 v38, v38
  v_exp_f32 v39, v39
  v_cvt_pk_bf16_f32 v66, v36, v37
  v_exp_f32 v40, v40
  v_cvt_pk_bf16_f32 v67, v38, v39
  v_exp_f32 v41, v41
  v_exp_f32 v42, v42
  v_mfma_f32_32x32x16_bf16 v[48:63], v[88:91], v[64:67], v[48:63]
  v_exp_f32 v43, v43
  v_cvt_pk_bf16_f32 v68, v40, v41
  v_exp_f32 v44, v44
  v_exp_f32 v45, v45
  v_cvt_pk_bf16_f32 v69, v42, v43
  v_exp_f32 v46, v46
  v_exp_f32 v47, v47
  v_cvt_pk_bf16_f32 v70, v44, v45
  v_cvt_pk_bf16_f32 v71, v46, v47
  s_waitcnt vmcnt(2) lgkmcnt(0)
  s_barrier
  s_mov_b32 m0, s40
  s_add_u32 s41, s40, 0x10000
  buffer_load_dwordx4 v9, s[12:15], s40 offen lds
  s_mov_b32 m0, s41
  s_add_u32 s40, s40, 8192
  buffer_load_dwordx4 v9, s[12:15], s41 offen lds
  v_mfma_f32_32x32x16_bf16 v[32:47], v[76:79], v[4:7], 0
  ds_read_b128 v[72:75], v9 offset:16384
  v_exp_f32 v16, v16
  v_exp_f32 v17, v17
  v_exp_f32 v18, v18
  v_exp_f32 v19, v19
  v_mfma_f32_32x32x16_bf16 v[48:63], v[92:95], v[68:71], v[48:63]
  ds_read_b128 v[88:91], v8 offset:3072
  ds_read_b128 v[92:95], v8 offset:3584
  v_cvt_pk_bf16_f32 v64, v16, v17
  v_exp_f32 v20, v20
  v_exp_f32 v21, v21
  v_cvt_pk_bf16_f32 v65, v18, v19
  v_exp_f32 v22, v22
  v_exp_f32 v23, v23
  v_cvt_pk_bf16_f32 v66, v20, v21
  v_exp_f32 v24, v24
  v_cvt_pk_bf16_f32 v67, v22, v23
  v_exp_f32 v25, v25
  v_exp_f32 v26, v26
  v_mfma_f32_32x32x16_bf16 v[48:63], v[80:83], v[64:67], v[48:63]
  v_exp_f32 v27, v27
  v_cvt_pk_bf16_f32 v68, v24, v25
  v_exp_f32 v28, v28
  v_exp_f32 v29, v29
  v_cvt_pk_bf16_f32 v69, v26, v27
  v_exp_f32 v30, v30
  v_exp_f32 v31, v31
  v_cvt_pk_bf16_f32 v70, v28, v29
  v_cvt_pk_bf16_f32 v71, v30, v31
  s_waitcnt lgkmcnt(0)
  v_mfma_f32_32x32x16_bf16 v[16:31], v[72:75], v[4:7], 0
  ds_read_b128 v[76:79], v9 offset:17408
  v_exp_f32 v32, v32
  v_exp_f32 v33, v33
  v_exp_f32 v34, v34
  v_exp_f32 v35, v35
  v_mfma_f32_32x32x16_bf16 v[48:63], v[84:87], v[68:71], v[48:63]
  v_add_u32 v8, v8, v10
  ds_read_b128 v[80:83], v8 offset:0
  ds_read_b128 v[84:87], v8 offset:512
  v_cvt_pk_bf16_f32 v64, v32, v33
  v_exp_f32 v36, v36
  v_exp_f32 v37, v37
  v_cvt_pk_bf16_f32 v65, v34, v35
  v_exp_f32 v38, v38
  v_exp_f32 v39, v39
  v_cvt_pk_bf16_f32 v66, v36, v37
  v_exp_f32 v40, v40
  v_cvt_pk_bf16_f32 v67, v38, v39
  v_exp_f32 v41, v41
  v_exp_f32 v42, v42
  v_mfma_f32_32x32x16_bf16 v[48:63], v[88:91], v[64:67], v[48:63]
  v_exp_f32 v43, v43
  v_cvt_pk_bf16_f32 v68, v40, v41
  v_exp_f32 v44, v44
  v_exp_f32 v45, v45
  v_cvt_pk_bf16_f32 v69, v42, v43
  v_exp_f32 v46, v46
  v_exp_f32 v47, v47
  v_cvt_pk_bf16_f32 v70, v44, v45
  v_cvt_pk_bf16_f32 v71, v46, v47
  s_waitcnt lgkmcnt(0)
  v_mfma_f32_32x32x16_bf16 v[32:47], v[76:79], v[4:7], 0
  ds_read_b128 v[72:75], v9 offset:18432
  v_exp_f32 v16, v16
  v_exp_f32 v17, v17
  v_exp_f32 v18, v18
  v_exp_f32 v19, v19
  v_mfma_f32_32x32x16_bf16 v[48:63], v[92:95], v[68:71], v[48:63]
  ds_read_b128 v[88:91], v8 offset:1024
  ds_read_b128 v[92:95], v8 offset:1536
  v_cvt_pk_bf16_f32 v64, v16, v17
  v_exp_f32 v20, v20
  v_exp_f32 v21, v21
  v_cvt_pk_bf16_f32 v65, v18, v19
  v_exp_f32 v22, v22
  v_exp_f32 v23, v23
  v_cvt_pk_bf16_f32 v66, v20, v21
  v_exp_f32 v24, v24
  v_cvt_pk_bf16_f32 v67, v22, v23
  v_exp_f32 v25, v25
  v_exp_f32 v26, v26
  v_mfma_f32_32x32x16_bf16 v[48:63], v[80:83], v[64:67], v[48:63]
  v_exp_f32 v27, v27
  v_cvt_pk_bf16_f32 v68, v24, v25
  v_exp_f32 v28, v28
  v_exp_f32 v29, v29
  v_cvt_pk_bf16_f32 v69, v26, v27
  v_exp_f32 v30, v30
  v_exp_f32 v31, v31
  v_cvt_pk_bf16_f32 v70, v28, v29
  v_cvt_pk_bf16_f32 v71, v30, v31
  s_waitcnt lgkmcnt(0)
  v_mfma_f32_32x32x16_bf16 v[16:31], v[72:75], v[4:7], 0
  ds_read_b128 v[76:79], v9 offset:19456
  v_exp_f32 v32, v32
  v_exp_f32 v33, v33
  v_exp_f32 v34, v34
  v_exp_f32 v35, v35
  v_mfma_f32_32x32x16_bf16 v[48:63], v[84:87], v[68:71], v[48:63]
  ds_read_b128 v[80:83], v8 offset:2048
  ds_read_b128 v[84:87], v8 offset:2560
  v_cvt_pk_bf16_f32 v64, v32, v33
  v_exp_f32 v36, v36
  v_exp_f32 v37, v37
  v_cvt_pk_bf16_f32 v65, v34, v35
  v_exp_f32 v38, v38
  v_exp_f32 v39, v39
  v_cvt_pk_bf16_f32 v66, v36, v37
  v_exp_f32 v40, v40
  v_cvt_pk_bf16_f32 v67, v38, v39
  v_exp_f32 v41, v41
  v_exp_f32 v42, v42
  v_mfma_f32_32x32x16_bf16 v[48:63], v[88:91], v[64:67], v[48:63]
  v_exp_f32 v43, v43
  v_cvt_pk_bf16_f32 v68, v40, v41
  v_exp_f32 v44, v44
  v_exp_f32 v45, v45
  v_cvt_pk_bf16_f32 v69, v42, v43
  v_exp_f32 v46, v46
  v_exp_f32 v47, v47
  v_cvt_pk_bf16_f32 v70, v44, v45
  v_cvt_pk_bf16_f32 v71, v46, v47
  s_waitcnt lgkmcnt(0)
  v_mfma_f32_32x32x16_bf16 v[32:47], v[76:79], v[4:7], 0
  ds_read_b128 v[72:75], v9 offset:20480
  v_exp_f32 v16, v16
  v_exp_f32 v17, v17
  v_exp_f32 v18, v18
  v_exp_f32 v19, v19
  v_mfma_f32_32x32x16_bf16 v[48:63], v[92:95], v[68:71], v[48:63]
  ds_read_b128 v[88:91], v8 offset:3072
  ds_read_b128 v[92:95], v8 offset:3584
  v_cvt_pk_bf16_f32 v64, v16, v17
  v_exp_f32 v20, v20
  v_exp_f32 v21, v21
  v_cvt_pk_bf16_f32 v65, v18, v19
  v_exp_f32 v22, v22
  v_exp_f32 v23, v23
  v_cvt_pk_bf16_f32 v66, v20, v21
  v_exp_f32 v24, v24
  v_cvt_pk_bf16_f32 v67, v22, v23
  v_exp_f32 v25, v25
  v_exp_f32 v26, v26
  v_mfma_f32_32x32x16_bf16 v[48:63], v[80:83], v[64:67], v[48:63]
  v_exp_f32 v27, v27
  v_cvt_pk_bf16_f32 v68, v24, v25
  v_exp_f32 v28, v28
  v_exp_f32 v29, v29
  v_cvt_pk_bf16_f32 v69, v26, v27
  v_exp_f32 v30, v30
  v_exp_f32 v31, v31
  v_cvt_pk_bf16_f32 v70, v28, v29
  v_cvt_pk_bf16_f32 v71, v30, v31
  s_waitcnt lgkmcnt(0)
  v_mfma_f32_32x32x16_bf16 v[16:31], v[72:75], v[4:7], 0
  ds_read_b128 v[76:79], v9 offset:21504
  v_exp_f32 v32, v32
  v_exp_f32 v33, v33
  v_exp_f32 v34, v34
  v_exp_f32 v35, v35
  v_mfma_f32_32x32x16_bf16 v[48:63], v[84:87], v[68:71], v[48:63]
  v_add_u32 v8, v8, v10
  ds_read_b128 v[80:83], v8 offset:0
  ds_read_b128 v[84:87], v8 offset:512
  v_cvt_pk_bf16_f32 v64, v32, v33
  v_exp_f32 v36, v36
  v_exp_f32 v37, v37
  v_cvt_pk_bf16_f32 v65, v34, v35
  v_exp_f32 v38, v38
  v_exp_f32 v39, v39
  v_cvt_pk_bf16_f32 v66, v36, v37
  v_exp_f32 v40, v40
  v_cvt_pk_bf16_f32 v67, v38, v39
  v_exp_f32 v41, v41
  v_exp_f32 v42, v42
  v_mfma_f32_32x32x16_bf16 v[48:63], v[88:91], v[64:67], v[48:63]
  v_exp_f32 v43, v43
  v_cvt_pk_bf16_f32 v68, v40, v41
  v_exp_f32 v44, v44
  v_exp_f32 v45, v45
  v_cvt_pk_bf16_f32 v69, v42, v43
  v_exp_f32 v46, v46
  v_exp_f32 v47, v47
  v_cvt_pk_bf16_f32 v70, v44, v45
  v_cvt_pk_bf16_f32 v71, v46, v47
  s_waitcnt lgkmcnt(0)
  v_mfma_f32_32x32x16_bf16 v[32:47], v[76:79], v[4:7], 0
  ds_read_b128 v[72:75], v9 offset:22528
  v_exp_f32 v16, v16
  v_exp_f32 v17, v17
  v_exp_f32 v18, v18
  v_exp_f32 v19, v19
  v_mfma_f32_32x32x16_bf16 v[48:63], v[92:95], v[68:71], v[48:63]
  ds_read_b128 v[88:91], v8 offset:1024
  ds_read_b128 v[92:95], v8 offset:1536
  v_cvt_pk_bf16_f32 v64, v16, v17
  v_exp_f32 v20, v20
  v_exp_f32 v21, v21
  v_cvt_pk_bf16_f32 v65, v18, v19
  v_exp_f32 v22, v22
  v_exp_f32 v23, v23
  v_cvt_pk_bf16_f32 v66, v20, v21
  v_exp_f32 v24, v24
  v_cvt_pk_bf16_f32 v67, v22, v23
  v_exp_f32 v25, v25
  v_exp_f32 v26, v26
  v_mfma_f32_32x32x16_bf16 v[48:63], v[80:83], v[64:67], v[48:63]
  v_exp_f32 v27, v27
  v_cvt_pk_bf16_f32 v68, v24, v25
  v_exp_f32 v28, v28
  v_exp_f32 v29, v29
  v_cvt_pk_bf16_f32 v69, v26, v27
  v_exp_f32 v30, v30
  v_exp_f32 v31, v31
  v_cvt_pk_bf16_f32 v70, v28, v29
  v_cvt_pk_bf16_f32 v71, v30, v31
  s_waitcnt lgkmcnt(0)
  v_mfma_f32_32x32x16_bf16 v[16:31], v[72:75], v[4:7], 0
  ds_read_b128 v[76:79], v9 offset:23552
  v_exp_f32 v32, v32
  v_exp_f32 v33, v33
  v_exp_f32 v34, v34
  v_exp_f32 v35, v35
  v_mfma_f32_32x32x16_bf16 v[48:63], v[84:87], v[68:71], v[48:63]
  ds_read_b128 v[80:83], v8 offset:2048
  ds_read_b128 v[84:87], v8 offset:2560
  v_cvt_pk_bf16_f32 v64, v32, v33
  v_exp_f32 v36, v36
  v_exp_f32 v37, v37
  v_cvt_pk_bf16_f32 v65, v34, v35
  v_exp_f32 v38, v38
  v_exp_f32 v39, v39
  v_cvt_pk_bf16_f32 v66, v36, v37
  v_exp_f32 v40, v40
  v_cvt_pk_bf16_f32 v67, v38, v39
  v_exp_f32 v41, v41
  v_exp_f32 v42, v42
  v_mfma_f32_32x32x16_bf16 v[48:63], v[88:91], v[64:67], v[48:63]
  v_exp_f32 v43, v43
  v_cvt_pk_bf16_f32 v68, v40, v41
  v_exp_f32 v44, v44
  v_exp_f32 v45, v45
  v_cvt_pk_bf16_f32 v69, v42, v43
  v_exp_f32 v46, v46
  v_exp_f32 v47, v47
  v_cvt_pk_bf16_f32 v70, v44, v45
  v_cvt_pk_bf16_f32 v71, v46, v47
  s_waitcnt vmcnt(2) lgkmcnt(0)
  s_barrier
  s_mov_b32 m0, s40
  s_add_u32 s41, s40, 0x10000
  buffer_load_dwordx4 v9, s[12:15], s40 offen lds
  s_mov_b32 m0, s41
  s_add_u32 s40, s40, 8192
  buffer_load_dwordx4 v9, s[12:15], s41 offen lds
  v_mfma_f32_32x32x16_bf16 v[32:47], v[76:79], v[4:7], 0
  ds_read_b128 v[72:75], v9 offset:24576
  v_exp_f32 v16, v16
  v_exp_f32 v17, v17
  v_exp_f32 v18, v18
  v_exp_f32 v19, v19
  v_mfma_f32_32x32x16_bf16 v[48:63], v[92:95], v[68:71], v[48:63]
  ds_read_b128 v[88:91], v8 offset:3072
  ds_read_b128 v[92:95], v8 offset:3584
  v_cvt_pk_bf16_f32 v64, v16, v17
  v_exp_f32 v20, v20
  v_exp_f32 v21, v21
  v_cvt_pk_bf16_f32 v65, v18, v19
  v_exp_f32 v22, v22
  v_exp_f32 v23, v23
  v_cvt_pk_bf16_f32 v66, v20, v21
  v_exp_f32 v24, v24
  v_cvt_pk_bf16_f32 v67, v22, v23
  v_exp_f32 v25, v25
  v_exp_f32 v26, v26
  v_mfma_f32_32x32x16_bf16 v[48:63], v[80:83], v[64:67], v[48:63]
  v_exp_f32 v27, v27
  v_cvt_pk_bf16_f32 v68, v24, v25
  v_exp_f32 v28, v28
  v_exp_f32 v29, v29
  v_cvt_pk_bf16_f32 v69, v26, v27
  v_exp_f32 v30, v30
  v_exp_f32 v31, v31
  v_cvt_pk_bf16_f32 v70, v28, v29
  v_cvt_pk_bf16_f32 v71, v30, v31
  s_waitcnt lgkmcnt(0)
  v_mfma_f32_32x32x16_bf16 v[16:31], v[72:75], v[4:7], 0
  ds_read_b128 v[76:79], v9 offset:25600
  v_exp_f32 v32, v32
  v_exp_f32 v33, v33
  v_exp_f32 v34, v34
  v_exp_f32 v35, v35
  v_mfma_f32_32x32x16_bf16 v[48:63], v[84:87], v[68:71], v[48:63]
  v_add_u32 v8, v8, v10
  ds_read_b128 v[80:83], v8 offset:0
  ds_read_b128 v[84:87], v8 offset:512
  v_cvt_pk_bf16_f32 v64, v32, v33
  v_exp_f32 v36, v36
  v_exp_f32 v37, v37
  v_cvt_pk_bf16_f32 v65, v34, v35
  v_exp_f32 v38, v38
  v_exp_f32 v39, v39
  v_cvt_pk_bf16_f32 v66, v36, v37
  v_exp_f32 v40, v40
  v_cvt_pk_bf16_f32 v67, v38, v39
  v_exp_f32 v41, v41
  v_exp_f32 v42, v42
  v_mfma_f32_32x32x16_bf16 v[48:63], v[88:91], v[64:67], v[48:63]
  v_exp_f32 v43, v43
  v_cvt_pk_bf16_f32 v68, v40, v41
  v_exp_f32 v44, v44
  v_exp_f32 v45, v45
  v_cvt_pk_bf16_f32 v69, v42, v43
  v_exp_f32 v46, v46
  v_exp_f32 v47, v47
  v_cvt_pk_bf16_f32 v70, v44, v45
  v_cvt_pk_bf16_f32 v71, v46, v47
  s_waitcnt lgkmcnt(0)
  v_mfma_f32_32x32x16_bf16 v[32:47], v[76:79], v[4:7], 0
  ds_read_b128 v[72:75], v9 offset:26624
  v_exp_f32 v16, v16
  v_exp_f32 v17, v17
  v_exp_f32 v18, v18
  v_exp_f32 v19, v19
  v_mfma_f32_32x32x16_bf16 v[48:63], v[92:95], v[68:71], v[48:63]
  ds_read_b128 v[88:91], v8 offset:1024
  ds_read_b128 v[92:95], v8 offset:1536
  v_cvt_pk_bf16_f32 v64, v16, v17
  v_exp_f32 v20, v20
  v_exp_f32 v21, v21
  v_cvt_pk_bf16_f32 v65, v18, v19
  v_exp_f32 v22, v22
  v_exp_f32 v23, v23
  v_cvt_pk_bf16_f32 v66, v20, v21
  v_exp_f32 v24, v24
  v_cvt_pk_bf16_f32 v67, v22, v23
  v_exp_f32 v25, v25
  v_exp_f32 v26, v26
  v_mfma_f32_32x32x16_bf16 v[48:63], v[80:83], v[64:67], v[48:63]
  v_exp_f32 v27, v27
  v_cvt_pk_bf16_f32 v68, v24, v25
  v_exp_f32 v28, v28
  v_exp_f32 v29, v29
  v_cvt_pk_bf16_f32 v69, v26, v27
  v_exp_f32 v30, v30
  v_exp_f32 v31, v31
  v_cvt_pk_bf16_f32 v70, v28, v29
  v_cvt_pk_bf16_f32 v71, v30, v31
  s_waitcnt lgkmcnt(0)
  v_mfma_f32_32x32x16_bf16 v[16:31], v[72:75], v[4:7], 0
  ds_read_b128 v[76:79], v9 offset:27648
  v_exp_f32 v32, v32
  v_exp_f32 v33, v33
  v_exp_f32 v34, v34
  v_exp_f32 v35, v35
  v_mfma_f32_32x32x16_bf16 v[48:63], v[84:87], v[68:71], v[48:63]
  ds_read_b128 v[80:83], v8 offset:2048
  ds_read_b128 v[84:87], v8 offset:2560
  v_cvt_pk_bf16_f32 v64, v32, v33
  v_exp_f32 v36, v36
  v_exp_f32 v37, v37
  v_cvt_pk_bf16_f32 v65, v34, v35
  v_exp_f32 v38, v38
  v_exp_f32 v39, v39
  v_cvt_pk_bf16_f32 v66, v36, v37
  v_exp_f32 v40, v40
  v_cvt_pk_bf16_f32 v67, v38, v39
  v_exp_f32 v41, v41
  v_exp_f32 v42, v42
  v_mfma_f32_32x32x16_bf16 v[48:63], v[88:91], v[64:67], v[48:63]
  v_exp_f32 v43, v43
  v_cvt_pk_bf16_f32 v68, v40, v41
  v_exp_f32 v44, v44
  v_exp_f32 v45, v45
  v_cvt_pk_bf16_f32 v69, v42, v43
  v_exp_f32 v46, v46
  v_exp_f32 v47, v47
  v_cvt_pk_bf16_f32 v70, v44, v45
  v_cvt_pk_bf16_f32 v71, v46, v47
  s_waitcnt lgkmcnt(0)
  v_mfma_f32_32x32x16_bf16 v[32:47], v[76:79], v[4:7], 0
  ds_read_b128 v[72:75], v9 offset:28672
  v_exp_f32 v16, v16
  v_exp_f32 v17, v17
  v_exp_f32 v18, v18
  v_exp_f32 v19, v19
  v_mfma_f32_32x32x16_bf16 v[48:63], v[92:95], v[68:71], v[48:63]
  ds_read_b128 v[88:91], v8 offset:3072
  ds_read_b128 v[92:95], v8 offset:3584
  v_cvt_pk_bf16_f32 v64, v16, v17
  v_exp_f32 v20, v20
  v_exp_f32 v21, v21
  v_cvt_pk_bf16_f32 v65, v18, v19
  v_exp_f32 v22, v22
  v_exp_f32 v23, v23
  v_cvt_pk_bf16_f32 v66, v20, v21
  v_exp_f32 v24, v24
  v_cvt_pk_bf16_f32 v67, v22, v23
  v_exp_f32 v25, v25
  v_exp_f32 v26, v26
  v_mfma_f32_32x32x16_bf16 v[48:63], v[80:83], v[64:67], v[48:63]
  v_exp_f32 v27, v27
  v_cvt_pk_bf16_f32 v68, v24, v25
  v_exp_f32 v28, v28
  v_exp_f32 v29, v29
  v_cvt_pk_bf16_f32 v69, v26, v27
  v_exp_f32 v30, v30
  v_exp_f32 v31, v31
  v_cvt_pk_bf16_f32 v70, v28, v29
  v_cvt_pk_bf16_f32 v71, v30, v31
  s_waitcnt lgkmcnt(0)
  v_mfma_f32_32x32x16_bf16 v[16:31], v[72:75], v[4:7], 0
  ds_read_b128 v[76:79], v9 offset:29696
  v_exp_f32 v32, v32
  v_exp_f32 v33, v33
  v_exp_f32 v34, v34
  v_exp_f32 v35, v35
  v_mfma_f32_32x32x16_bf16 v[48:63], v[84:87], v[68:71], v[48:63]
  v_add_u32 v8, v8, v10
  ds_read_b128 v[80:83], v8 offset:0
  ds_read_b128 v[84:87], v8 offset:512
  v_cvt_pk_bf16_f32 v64, v32, v33
  v_exp_f32 v36, v36
  v_exp_f32 v37, v37
  v_cvt_pk_bf16_f32 v65, v34, v35
  v_exp_f32 v38, v38
  v_exp_f32 v39, v39
  v_cvt_pk_bf16_f32 v66, v36, v37
  v_exp_f32 v40, v40
  v_cvt_pk_bf16_f32 v67, v38, v39
  v_exp_f32 v41, v41
  v_exp_f32 v42, v42
  v_mfma_f32_32x32x16_bf16 v[48:63], v[88:91], v[64:67], v[48:63]
  v_exp_f32 v43, v43
  v_cvt_pk_bf16_f32 v68, v40, v41
  v_exp_f32 v44, v44
  v_exp_f32 v45, v45
  v_cvt_pk_bf16_f32 v69, v42, v43
  v_exp_f32 v46, v46
  v_exp_f32 v47, v47
  v_cvt_pk_bf16_f32 v70, v44, v45
  v_cvt_pk_bf16_f32 v71, v46, v47
  s_waitcnt lgkmcnt(0)
  v_mfma_f32_32x32x16_bf16 v[32:47], v[76:79], v[4:7], 0
  ds_read_b128 v[72:75], v9 offset:30720
  v_exp_f32 v16, v16
  v_exp_f32 v17, v17
  v_exp_f32 v18, v18
  v_exp_f32 v19, v19
  v_mfma_f32_32x32x16_bf16 v[48:63], v[92:95], v[68:71], v[48:63]
  ds_read_b128 v[88:91], v8 offset:1024
  ds_read_b128 v[92:95], v8 offset:1536
  v_cvt_pk_bf16_f32 v64, v16, v17
  v_exp_f32 v20, v20
  v_exp_f32 v21, v21
  v_cvt_pk_bf16_f32 v65, v18, v19
  v_exp_f32 v22, v22
  v_exp_f32 v23, v23
  v_cvt_pk_bf16_f32 v66, v20, v21
  v_exp_f32 v24, v24
  v_cvt_pk_bf16_f32 v67, v22, v23
  v_exp_f32 v25, v25
  v_exp_f32 v26, v26
  v_mfma_f32_32x32x16_bf16 v[48:63], v[80:83], v[64:67], v[48:63]
  v_exp_f32 v27, v27
  v_cvt_pk_bf16_f32 v68, v24, v25
  v_exp_f32 v28, v28
  v_exp_f32 v29, v29
  v_cvt_pk_bf16_f32 v69, v26, v27
  v_exp_f32 v30, v30
  v_exp_f32 v31, v31
  v_cvt_pk_bf16_f32 v70, v28, v29
  v_cvt_pk_bf16_f32 v71, v30, v31
  s_waitcnt lgkmcnt(0)
  v_mfma_f32_32x32x16_bf16 v[16:31], v[72:75], v[4:7], 0
  ds_read_b128 v[76:79], v9 offset:31744
  v_exp_f32 v32, v32
  v_exp_f32 v33, v33
  v_exp_f32 v34, v34
  v_exp_f32 v35, v35
  v_mfma_f32_32x32x16_bf16 v[48:63], v[84:87], v[68:71], v[48:63]
  ds_read_b128 v[80:83], v8 offset:2048
  ds_read_b128 v[84:87], v8 offset:2560
  v_cvt_pk_bf16_f32 v64, v32, v33
  v_exp_f32 v36, v36
  v_exp_f32 v37, v37
  v_cvt_pk_bf16_f32 v65, v34, v35
  v_exp_f32 v38, v38
  v_exp_f32 v39, v39
  v_cvt_pk_bf16_f32 v66, v36, v37
  v_exp_f32 v40, v40
  v_cvt_pk_bf16_f32 v67, v38, v39
  v_exp_f32 v41, v41
  v_exp_f32 v42, v42
  v_mfma_f32_32x32x16_bf16 v[48:63], v[88:91], v[64:67], v[48:63]
  v_exp_f32 v43, v43
  v_cvt_pk_bf16_f32 v68, v40, v41
  v_exp_f32 v44, v44
  v_exp_f32 v45, v45
  v_cvt_pk_bf16_f32 v69, v42, v43
  v_exp_f32 v46, v46
  v_exp_f32 v47, v47
  v_cvt_pk_bf16_f32 v70, v44, v45
  v_cvt_pk_bf16_f32 v71, v46, v47
  s_waitcnt vmcnt(2) lgkmcnt(0)
  s_barrier
  s_mov_b32 m0, s40
  s_add_u32 s41, s40, 0x10000
  buffer_load_dwordx4 v9, s[12:15], s40 offen lds
  s_mov_b32 m0, s41
  s_add_u32 s40, s40, 8192
  buffer_load_dwordx4 v9, s[12:15], s41 offen lds
  v_mfma_f32_32x32x16_bf16 v[32:47], v[76:79], v[4:7], 0
  ds_read_b128 v[72:75], v9 offset:32768
  v_exp_f32 v16, v16
  v_exp_f32 v17, v17
  v_exp_f32 v18, v18
  v_exp_f32 v19, v19
  v_mfma_f32_32x32x16_bf16 v[48:63], v[92:95], v[68:71], v[48:63]
  ds_read_b128 v[88:91], v8 offset:3072
  ds_read_b128 v[92:95], v8 offset:3584
  v_cvt_pk_bf16_f32 v64, v16, v17
  v_exp_f32 v20, v20
  v_exp_f32 v21, v21
  v_cvt_pk_bf16_f32 v65, v18, v19
  v_exp_f32 v22, v22
  v_exp_f32 v23, v23
  v_cvt_pk_bf16_f32 v66, v20, v21
  v_exp_f32 v24, v24
  v_cvt_pk_bf16_f32 v67, v22, v23
  v_exp_f32 v25, v25
  v_exp_f32 v26, v26
  v_mfma_f32_32x32x16_bf16 v[48:63], v[80:83], v[64:67], v[48:63]
  v_exp_f32 v27, v27
  v_cvt_pk_bf16_f32 v68, v24, v25
  v_exp_f32 v28, v28
  v_exp_f32 v29, v29
  v_cvt_pk_bf16_f32 v69, v26, v27
  v_exp_f32 v30, v30
  v_exp_f32 v31, v31
  v_cvt_pk_bf16_f32 v70, v28, v29
  v_cvt_pk_bf16_f32 v71, v30, v31
  s_waitcnt lgkmcnt(0)
  v_mfma_f32_32x32x16_bf16 v[16:31], v[72:75], v[4:7], 0
  ds_read_b128 v[76:79], v9 offset:33792
  v_exp_f32 v32, v32
  v_exp_f32 v33, v33
  v_exp_f32 v34, v34
  v_exp_f32 v35, v35
  v_mfma_f32_32x32x16_bf16 v[48:63], v[84:87], v[68:71], v[48:63]
  v_add_u32 v8, v8, v10
  ds_read_b128 v[80:83], v8 offset:0
  ds_read_b128 v[84:87], v8 offset:512
  v_cvt_pk_bf16_f32 v64, v32, v33
  v_exp_f32 v36, v36
  v_exp_f32 v37, v37
  v_cvt_pk_bf16_f32 v65, v34, v35
  v_exp_f32 v38, v38
  v_exp_f32 v39, v39
  v_cvt_pk_bf16_f32 v66, v36, v37
  v_exp_f32 v40, v40
  v_cvt_pk_bf16_f32 v67, v38, v39
  v_exp_f32 v41, v41
  v_exp_f32 v42, v42
  v_mfma_f32_32x32x16_bf16 v[48:63], v[88:91], v[64:67], v[48:63]
  v_exp_f32 v43, v43
  v_cvt_pk_bf16_f32 v68, v40, v41
  v_exp_f32 v44, v44
  v_exp_f32 v45, v45
  v_cvt_pk_bf16_f32 v69, v42, v43
  v_exp_f32 v46, v46
  v_exp_f32 v47, v47
  v_cvt_pk_bf16_f32 v70, v44, v45
  v_cvt_pk_bf16_f32 v71, v46, v47
  s_waitcnt lgkmcnt(0)
  v_mfma_f32_32x32x16_bf16 v[32:47], v[76:79], v[4:7], 0
  ds_read_b128 v[72:75], v9 offset:34816
  v_exp_f32 v16, v16
  v_exp_f32 v17, v17
  v_exp_f32 v18, v18
  v_exp_f32 v19, v19
  v_mfma_f32_32x32x16_bf16 v[48:63], v[92:95], v[68:71], v[48:63]
  ds_read_b128 v[88:91], v8 offset:1024
  ds_read_b128 v[92:95], v8 offset:1536
  v_cvt_pk_bf16_f32 v64, v16, v17
  v_exp_f32 v20, v20
  v_exp_f32 v21, v21
  v_cvt_pk_bf16_f32 v65, v18, v19
  v_exp_f32 v22, v22
  v_exp_f32 v23, v23
  v_cvt_pk_bf16_f32 v66, v20, v21
  v_exp_f32 v24, v24
  v_cvt_pk_bf16_f32 v67, v22, v23
  v_exp_f32 v25, v25
  v_exp_f32 v26, v26
  v_mfma_f32_32x32x16_bf16 v[48:63], v[80:83], v[64:67], v[48:63]
  v_exp_f32 v27, v27
  v_cvt_pk_bf16_f32 v68, v24, v25
  v_exp_f32 v28, v28
  v_exp_f32 v29, v29
  v_cvt_pk_bf16_f32 v69, v26, v27
  v_exp_f32 v30, v30
  v_exp_f32 v31, v31
  v_cvt_pk_bf16_f32 v70, v28, v29
  v_cvt_pk_bf16_f32 v71, v30, v31
  s_waitcnt lgkmcnt(0)
  v_mfma_f32_32x32x16_bf16 v[16:31], v[72:75], v[4:7], 0
  ds_read_b128 v[76:79], v9 offset:35840
  v_exp_f32 v32, v32
  v_exp_f32 v33, v33
  v_exp_f32 v34, v34
  v_exp_f32 v35, v35
  v_mfma_f32_32x32x16_bf16 v[48:63], v[84:87], v[68:71], v[48:63]
  ds_read_b128 v[80:83], v8 offset:2048
  ds_read_b128 v[84:87], v8 offset:2560
  v_cvt_pk_bf16_f32 v64, v32, v33
  v_exp_f32 v36, v36
  v_exp_f32 v37, v37
  v_cvt_pk_bf16_f32 v65, v34, v35
  v_exp_f32 v38, v38
  v_exp_f32 v39, v39
  v_cvt_pk_bf16_f32 v66, v36, v37
  v_exp_f32 v40, v40
  v_cvt_pk_bf16_f32 v67, v38, v39
  v_exp_f32 v41, v41
  v_exp_f32 v42, v42
  v_mfma_f32_32x32x16_bf16 v[48:63], v[88:91], v[64:67], v[48:63]
  v_exp_f32 v43, v43
  v_cvt_pk_bf16_f32 v68, v40, v41
  v_exp_f32 v44, v44
  v_exp_f32 v45, v45
  v_cvt_pk_bf16_f32 v69, v42, v43
  v_exp_f32 v46, v46
  v_exp_f32 v47, v47
  v_cvt_pk_bf16_f32 v70, v44, v45
  v_cvt_pk_bf16_f32 v71, v46, v47
  s_waitcnt lgkmcnt(0)
  v_mfma_f32_32x32x16_bf16 v[32:47], v[76:79], v[4:7], 0
  ds_read_b128 v[72:75], v9 offset:36864
  v_exp_f32 v16, v16
  v_exp_f32 v17, v17
  v_exp_f32 v18, v18
  v_exp_f32 v19, v19
  v_mfma_f32_32x32x16_bf16 v[48:63], v[92:95], v[68:71], v[48:63]
  ds_read_b128 v[88:91], v8 offset:3072
  ds_read_b128 v[92:95], v8 offset:3584
  v_cvt_pk_bf16_f32 v64, v16, v17
  v_exp_f32 v20, v20
  v_exp_f32 v21, v21
  v_cvt_pk_bf16_f32 v65, v18, v19
  v_exp_f32 v22, v22
  v_exp_f32 v23, v23
  v_cvt_pk_bf16_f32 v66, v20, v21
  v_exp_f32 v24, v24
  v_cvt_pk_bf16_f32 v67, v22, v23
  v_exp_f32 v25, v25
  v_exp_f32 v26, v26
  v_mfma_f32_32x32x16_bf16 v[48:63], v[80:83], v[64:67], v[48:63]
  v_exp_f32 v27, v27
  v_cvt_pk_bf16_f32 v68, v24, v25
  v_exp_f32 v28, v28
  v_exp_f32 v29, v29
  v_cvt_pk_bf16_f32 v69, v26, v27
  v_exp_f32 v30, v30
  v_exp_f32 v31, v31
  v_cvt_pk_bf16_f32 v70, v28, v29
  v_cvt_pk_bf16_f32 v71, v30, v31
  s_waitcnt lgkmcnt(0)
  v_mfma_f32_32x32x16_bf16 v[16:31], v[72:75], v[4:7], 0
  ds_read_b128 v[76:79], v9 offset:37888
  v_exp_f32 v32, v32
  v_exp_f32 v33, v33
  v_exp_f32 v34, v34
  v_exp_f32 v35, v35
  v_mfma_f32_32x32x16_bf16 v[48:63], v[84:87], v[68:71], v[48:63]
  v_add_u32 v8, v8, v10
  ds_read_b128 v[80:83], v8 offset:0
  ds_read_b128 v[84:87], v8 offset:512
  v_cvt_pk_bf16_f32 v64, v32, v33
  v_exp_f32 v36, v36
  v_exp_f32 v37, v37
  v_cvt_pk_bf16_f32 v65, v34, v35
  v_exp_f32 v38, v38
  v_exp_f32 v39, v39
  v_cvt_pk_bf16_f32 v66, v36, v37
  v_exp_f32 v40, v40
  v_cvt_pk_bf16_f32 v67, v38, v39
  v_exp_f32 v41, v41
  v_exp_f32 v42, v42
  v_mfma_f32_32x32x16_bf16 v[48:63], v[88:91], v[64:67], v[48:63]
  v_exp_f32 v43, v43
  v_cvt_pk_bf16_f32 v68, v40, v41
  v_exp_f32 v44, v44
  v_exp_f32 v45, v45
  v_cvt_pk_bf16_f32 v69, v42, v43
  v_exp_f32 v46, v46
  v_exp_f32 v47, v47
  v_cvt_pk_bf16_f32 v70, v44, v45
  v_cvt_pk_bf16_f32 v71, v46, v47
  s_waitcnt lgkmcnt(0)
  v_mfma_f32_32x32x16_bf16 v[32:47], v[76:79], v[4:7], 0
  ds_read_b128 v[72:75], v9 offset:38912
  v_exp_f32 v16, v16
  v_exp_f32 v17, v17
  v_exp_f32 v18, v18
  v_exp_f32 v19, v19
  v_mfma_f32_32x32x16_bf16 v[48:63], v[92:95], v[68:71], v[48:63]
  ds_read_b128 v[88:91], v8 offset:1024
  ds_read_b128 v[92:95], v8 offset:1536
  v_cvt_pk_bf16_f32 v64, v16, v17
  v_exp_f32 v20, v20
  v_exp_f32 v21, v21
  v_cvt_pk_bf16_f32 v65, v18, v19
  v_exp_f32 v22, v22
  v_exp_f32 v23, v23
  v_cvt_pk_bf16_f32 v66, v20, v21
  v_exp_f32 v24, v24
  v_cvt_pk_bf16_f32 v67, v22, v23
  v_exp_f32 v25, v25
  v_exp_f32 v26, v26
  v_mfma_f32_32x32x16_bf16 v[48:63], v[80:83], v[64:67], v[48:63]
  v_exp_f32 v27, v27
  v_cvt_pk_bf16_f32 v68, v24, v25
  v_exp_f32 v28, v28
  v_exp_f32 v29, v29
  v_cvt_pk_bf16_f32 v69, v26, v27
  v_exp_f32 v30, v30
  v_exp_f32 v31, v31
  v_cvt_pk_bf16_f32 v70, v28, v29
  v_cvt_pk_bf16_f32 v71, v30, v31
  s_waitcnt lgkmcnt(0)
  v_mfma_f32_32x32x16_bf16 v[16:31], v[72:75], v[4:7], 0
  ds_read_b128 v[76:79], v9 offset:39936
  v_exp_f32 v32, v32
  v_exp_f32 v33, v33
  v_exp_f32 v34, v34
  v_exp_f32 v35, v35
  v_mfma_f32_32x32x16_bf16 v[48:63], v[84:87], v[68:71], v[48:63]
  ds_read_b128 v[80:83], v8 offset:2048
  ds_read_b128 v[84:87], v8 offset:2560
  v_cvt_pk_bf16_f32 v64, v32, v33
  v_exp_f32 v36, v36
  v_exp_f32 v37, v37
  v_cvt_pk_bf16_f32 v65, v34, v35
  v_exp_f32 v38, v38
  v_exp_f32 v39, v39
  v_cvt_pk_bf16_f32 v66, v36, v37
  v_exp_f32 v40, v40
  v_cvt_pk_bf16_f32 v67, v38, v39
  v_exp_f32 v41, v41
  v_exp_f32 v42, v42
  v_mfma_f32_32x32x16_bf16 v[48:63], v[88:91], v[64:67], v[48:63]
  v_exp_f32 v43, v43
  v_cvt_pk_bf16_f32 v68, v40, v41
  v_exp_f32 v44, v44
  v_exp_f32 v45, v45
  v_cvt_pk_bf16_f32 v69, v42, v43
  v_exp_f32 v46, v46
  v_exp_f32 v47, v47
  v_cvt_pk_bf16_f32 v70, v44, v45
  v_cvt_pk_bf16_f32 v71, v46, v47
  s_waitcnt vmcnt(2) lgkmcnt(0)
  s_barrier
  s_mov_b32 m0, s40
  s_add_u32 s41, s40, 0x10000
  buffer_load_dwordx4 v9, s[12:15], s40 offen lds
  s_mov_b32 m0, s41
  s_add_u32 s40, s40, 8192
  buffer_load_dwordx4 v9, s[12:15], s41 offen lds
  v_mfma_f32_32x32x16_bf16 v[32:47], v[76:79], v[4:7], 0
  ds_read_b128 v[72:75], v9 offset:40960
  v_exp_f32 v16, v16
  v_exp_f32 v17, v17
  v_exp_f32 v18, v18
  v_exp_f32 v19, v19
  v_mfma_f32_32x32x16_bf16 v[48:63], v[92:95], v[68:71], v[48:63]
  ds_read_b128 v[88:91], v8 offset:3072
  ds_read_b128 v[92:95], v8 offset:3584
  v_cvt_pk_bf16_f32 v64, v16, v17
  v_exp_f32 v20, v20
  v_exp_f32 v21, v21
  v_cvt_pk_bf16_f32 v65, v18, v19
  v_exp_f32 v22, v22
  v_exp_f32 v23, v23
  v_cvt_pk_bf16_f32 v66, v20, v21
  v_exp_f32 v24, v24
  v_cvt_pk_bf16_f32 v67, v22, v23
  v_exp_f32 v25, v25
  v_exp_f32 v26, v26
  v_mfma_f32_32x32x16_bf16 v[48:63], v[80:83], v[64:67], v[48:63]
  v_exp_f32 v27, v27
  v_cvt_pk_bf16_f32 v68, v24, v25
  v_exp_f32 v28, v28
  v_exp_f32 v29, v29
  v_cvt_pk_bf16_f32 v69, v26, v27
  v_exp_f32 v30, v30
  v_exp_f32 v31, v31
  v_cvt_pk_bf16_f32 v70, v28, v29
  v_cvt_pk_bf16_f32 v71, v30, v31
  s_waitcnt lgkmcnt(0)
  v_mfma_f32_32x32x16_bf16 v[16:31], v[72:75], v[4:7], 0
  ds_read_b128 v[76:79], v9 offset:41984
  v_exp_f32 v32, v32
  v_exp_f32 v33, v33
  v_exp_f32 v34, v34
  v_exp_f32 v35, v35
  v_mfma_f32_32x32x16_bf16 v[48:63], v[84:87], v[68:71], v[48:63]
  v_add_u32 v8, v8, v10
  ds_read_b128 v[80:83], v8 offset:0
  ds_read_b128 v[84:87], v8 offset:512
  v_cvt_pk_bf16_f32 v64, v32, v33
  v_exp_f32 v36, v36
  v_exp_f32 v37, v37
  v_cvt_pk_bf16_f32 v65, v34, v35
  v_exp_f32 v38, v38
  v_exp_f32 v39, v39
  v_cvt_pk_bf16_f32 v66, v36, v37
  v_exp_f32 v40, v40
  v_cvt_pk_bf16_f32 v67, v38, v39
  v_exp_f32 v41, v41
  v_exp_f32 v42, v42
  v_mfma_f32_32x32x16_bf16 v[48:63], v[88:91], v[64:67], v[48:63]
  v_exp_f32 v43, v43
  v_cvt_pk_bf16_f32 v68, v40, v41
  v_exp_f32 v44, v44
  v_exp_f32 v45, v45
  v_cvt_pk_bf16_f32 v69, v42, v43
  v_exp_f32 v46, v46
  v_exp_f32 v47, v47
  v_cvt_pk_bf16_f32 v70, v44, v45
  v_cvt_pk_bf16_f32 v71, v46, v47
  s_waitcnt lgkmcnt(0)
  v_mfma_f32_32x32x16_bf16 v[32:47], v[76:79], v[4:7], 0
  ds_read_b128 v[72:75], v9 offset:43008
  v_exp_f32 v16, v16
  v_exp_f32 v17, v17
  v_exp_f32 v18, v18
  v_exp_f32 v19, v19
  v_mfma_f32_32x32x16_bf16 v[48:63], v[92:95], v[68:71], v[48:63]
  ds_read_b128 v[88:91], v8 offset:1024
  ds_read_b128 v[92:95], v8 offset:1536
  v_cvt_pk_bf16_f32 v64, v16, v17
  v_exp_f32 v20, v20
  v_exp_f32 v21, v21
  v_cvt_pk_bf16_f32 v65, v18, v19
  v_exp_f32 v22, v22
  v_exp_f32 v23, v23
  v_cvt_pk_bf16_f32 v66, v20, v21
  v_exp_f32 v24, v24
  v_cvt_pk_bf16_f32 v67, v22, v23
  v_exp_f32 v25, v25
  v_exp_f32 v26, v26
  v_mfma_f32_32x32x16_bf16 v[48:63], v[80:83], v[64:67], v[48:63]
  v_exp_f32 v27, v27
  v_cvt_pk_bf16_f32 v68, v24, v25
  v_exp_f32 v28, v28
  v_exp_f32 v29, v29
  v_cvt_pk_bf16_f32 v69, v26, v27
  v_exp_f32 v30, v30
  v_exp_f32 v31, v31
  v_cvt_pk_bf16_f32 v70, v28, v29
  v_cvt_pk_bf16_f32 v71, v30, v31
  s_waitcnt lgkmcnt(0)
  v_mfma_f32_32x32x16_bf16 v[16:31], v[72:75], v[4:7], 0
  ds_read_b128 v[76:79], v9 offset:44032
  v_exp_f32 v32, v32
  v_exp_f32 v33, v33
  v_exp_f32 v34, v34
  v_exp_f32 v35, v35
  v_mfma_f32_32x32x16_bf16 v[48:63], v[84:87], v[68:71], v[48:63]
  ds_read_b128 v[80:83], v8 offset:2048
  ds_read_b128 v[84:87], v8 offset:2560
  v_cvt_pk_bf16_f32 v64, v32, v33
  v_exp_f32 v36, v36
  v_exp_f32 v37, v37
  v_cvt_pk_bf16_f32 v65, v34, v35
  v_exp_f32 v38, v38
  v_exp_f32 v39, v39
  v_cvt_pk_bf16_f32 v66, v36, v37
  v_exp_f32 v40, v40
  v_cvt_pk_bf16_f32 v67, v38, v39
  v_exp_f32 v41, v41
  v_exp_f32 v42, v42
  v_mfma_f32_32x32x16_bf16 v[48:63], v[88:91], v[64:67], v[48:63]
  v_exp_f32 v43, v43
  v_cvt_pk_bf16_f32 v68, v40, v41
  v_exp_f32 v44, v44
  v_exp_f32 v45, v45
  v_cvt_pk_bf16_f32 v69, v42, v43
  v_exp_f32 v46, v46
  v_exp_f32 v47, v47
  v_cvt_pk_bf16_f32 v70, v44, v45
  v_cvt_pk_bf16_f32 v71, v46, v47
  s_waitcnt lgkmcnt(0)
  v_mfma_f32_32x32x16_bf16 v[32:47], v[76:79], v[4:7], 0
  ds_read_b128 v[72:75], v9 offset:45056
  v_exp_f32 v16, v16
  v_exp_f32 v17, v17
  v_exp_f32 v18, v18
  v_exp_f32 v19, v19
  v_mfma_f32_32x32x16_bf16 v[48:63], v[92:95], v[68:71], v[48:63]
  ds_read_b128 v[88:91], v8 offset:3072
  ds_read_b128 v[92:95], v8 offset:3584
  v_cvt_pk_bf16_f32 v64, v16, v17
  v_exp_f32 v20, v20
  v_exp_f32 v21, v21
  v_cvt_pk_bf16_f32 v65, v18, v19
  v_exp_f32 v22, v22
  v_exp_f32 v23, v23
  v_cvt_pk_bf16_f32 v66, v20, v21
  v_exp_f32 v24, v24
  v_cvt_pk_bf16_f32 v67, v22, v23
  v_exp_f32 v25, v25
  v_exp_f32 v26, v26
  v_mfma_f32_32x32x16_bf16 v[48:63], v[80:83], v[64:67], v[48:63]
  v_exp_f32 v27, v27
  v_cvt_pk_bf16_f32 v68, v24, v25
  v_exp_f32 v28, v28
  v_exp_f32 v29, v29
  v_cvt_pk_bf16_f32 v69, v26, v27
  v_exp_f32 v30, v30
  v_exp_f32 v31, v31
  v_cvt_pk_bf16_f32 v70, v28, v29
  v_cvt_pk_bf16_f32 v71, v30, v31
  s_waitcnt lgkmcnt(0)
  v_mfma_f32_32x32x16_bf16 v[16:31], v[72:75], v[4:7], 0
  ds_read_b128 v[76:79], v9 offset:46080
  v_exp_f32 v32, v32
  v_exp_f32 v33, v33
  v_exp_f32 v34, v34
  v_exp_f32 v35, v35
  v_mfma_f32_32x32x16_bf16 v[48:63], v[84:87], v[68:71], v[48:63]
  v_add_u32 v8, v8, v10
  ds_read_b128 v[80:83], v8 offset:0
  ds_read_b128 v[84:87], v8 offset:512
  v_cvt_pk_bf16_f32 v64, v32, v33
  v_exp_f32 v36, v36
  v_exp_f32 v37, v37
  v_cvt_pk_bf16_f32 v65, v34, v35
  v_exp_f32 v38, v38
  v_exp_f32 v39, v39
  v_cvt_pk_bf16_f32 v66, v36, v37
  v_exp_f32 v40, v40
  v_cvt_pk_bf16_f32 v67, v38, v39
  v_exp_f32 v41, v41
  v_exp_f32 v42, v42
  v_mfma_f32_32x32x16_bf16 v[48:63], v[88:91], v[64:67], v[48:63]
  v_exp_f32 v43, v43
  v_cvt_pk_bf16_f32 v68, v40, v41
  v_exp_f32 v44, v44
  v_exp_f32 v45, v45
  v_cvt_pk_bf16_f32 v69, v42, v43
  v_exp_f32 v46, v46
  v_exp_f32 v47, v47
  v_cvt_pk_bf16_f32 v70, v44, v45
  v_cvt_pk_bf16_f32 v71, v46, v47
  s_waitcnt lgkmcnt(0)
  v_mfma_f32_32x32x16_bf16 v[32:47], v[76:79], v[4:7], 0
  ds_read_b128 v[72:75], v9 offset:47104
  v_exp_f32 v16, v16
  v_exp_f32 v17, v17
  v_exp_f32 v18, v18
  v_exp_f32 v19, v19
  v_mfma_f32_32x32x16_bf16 v[48:63], v[92:95], v[68:71], v[48:63]
  ds_read_b128 v[88:91], v8 offset:1024
  ds_read_b128 v[92:95], v8 offset:1536
  v_cvt_pk_bf16_f32 v64, v16, v17
  v_exp_f32 v20, v20
  v_exp_f32 v21, v21
  v_cvt_pk_bf16_f32 v65, v18, v19
  v_exp_f32 v22, v22
  v_exp_f32 v23, v23
  v_cvt_pk_bf16_f32 v66, v20, v21
  v_exp_f32 v24, v24
  v_cvt_pk_bf16_f32 v67, v22, v23
  v_exp_f32 v25, v25
  v_exp_f32 v26, v26
  v_mfma_f32_32x32x16_bf16 v[48:63], v[80:83], v[64:67], v[48:63]
  v_exp_f32 v27, v27
  v_cvt_pk_bf16_f32 v68, v24, v25
  v_exp_f32 v28, v28
  v_exp_f32 v29, v29
  v_cvt_pk_bf16_f32 v69, v26, v27
  v_exp_f32 v30, v30
  v_exp_f32 v31, v31
  v_cvt_pk_bf16_f32 v70, v28, v29
  v_cvt_pk_bf16_f32 v71, v30, v31
  s_waitcnt lgkmcnt(0)
  v_mfma_f32_32x32x16_bf16 v[16:31], v[72:75], v[4:7], 0
  ds_read_b128 v[76:79], v9 offset:48128
  v_exp_f32 v32, v32
  v_exp_f32 v33, v33
  v_exp_f32 v34, v34
  v_exp_f32 v35, v35
  v_mfma_f32_32x32x16_bf16 v[48:63], v[84:87], v[68:71], v[48:63]
  ds_read_b128 v[80:83], v8 offset:2048
  ds_read_b128 v[84:87], v8 offset:2560
  v_cvt_pk_bf16_f32 v64, v32, v33
  v_exp_f32 v36, v36
  v_exp_f32 v37, v37
  v_cvt_pk_bf16_f32 v65, v34, v35
  v_exp_f32 v38, v38
  v_exp_f32 v39, v39
  v_cvt_pk_bf16_f32 v66, v36, v37
  v_exp_f32 v40, v40
  v_cvt_pk_bf16_f32 v67, v38, v39
  v_exp_f32 v41, v41
  v_exp_f32 v42, v42
  v_mfma_f32_32x32x16_bf16 v[48:63], v[88:91], v[64:67], v[48:63]
  v_exp_f32 v43, v43
  v_cvt_pk_bf16_f32 v68, v40, v41
  v_exp_f32 v44, v44
  v_exp_f32 v45, v45
  v_cvt_pk_bf16_f32 v69, v42, v43
  v_exp_f32 v46, v46
  v_exp_f32 v47, v47
  v_cvt_pk_bf16_f32 v70, v44, v45
  v_cvt_pk_bf16_f32 v71, v46, v47
  s_waitcnt vmcnt(2) lgkmcnt(0)
  s_barrier
  v_mfma_f32_32x32x16_bf16 v[32:47], v[76:79], v[4:7], 0
  ds_read_b128 v[72:75], v9 offset:49152
  v_exp_f32 v16, v16
  v_exp_f32 v17, v17
  v_exp_f32 v18, v18
  v_exp_f32 v19, v19
  v_mfma_f32_32x32x16_bf16 v[48:63], v[92:95], v[68:71], v[48:63]
  ds_read_b128 v[88:91], v8 offset:3072
  ds_read_b128 v[92:95], v8 offset:3584
  v_cvt_pk_bf16_f32 v64, v16, v17
  v_exp_f32 v20, v20
  v_exp_f32 v21, v21
  v_cvt_pk_bf16_f32 v65, v18, v19
  v_exp_f32 v22, v22
  v_exp_f32 v23, v23
  v_cvt_pk_bf16_f32 v66, v20, v21
  v_exp_f32 v24, v24
  v_cvt_pk_bf16_f32 v67, v22, v23
  v_exp_f32 v25, v25
  v_exp_f32 v26, v26
  v_mfma_f32_32x32x16_bf16 v[48:63], v[80:83], v[64:67], v[48:63]
  v_exp_f32 v27, v27
  v_cvt_pk_bf16_f32 v68, v24, v25
  v_exp_f32 v28, v28
  v_exp_f32 v29, v29
  v_cvt_pk_bf16_f32 v69, v26, v27
  v_exp_f32 v30, v30
  v_exp_f32 v31, v31
  v_cvt_pk_bf16_f32 v70, v28, v29
  v_cvt_pk_bf16_f32 v71, v30, v31
  s_waitcnt lgkmcnt(0)
  v_mfma_f32_32x32x16_bf16 v[16:31], v[72:75], v[4:7], 0
  ds_read_b128 v[76:79], v9 offset:50176
  v_exp_f32 v32, v32
  v_exp_f32 v33, v33
  v_exp_f32 v34, v34
  v_exp_f32 v35, v35
  v_mfma_f32_32x32x16_bf16 v[48:63], v[84:87], v[68:71], v[48:63]
  v_add_u32 v8, v8, v10
  ds_read_b128 v[80:83], v8 offset:0
  ds_read_b128 v[84:87], v8 offset:512
  v_cvt_pk_bf16_f32 v64, v32, v33
  v_exp_f32 v36, v36
  v_exp_f32 v37, v37
  v_cvt_pk_bf16_f32 v65, v34, v35
  v_exp_f32 v38, v38
  v_exp_f32 v39, v39
  v_cvt_pk_bf16_f32 v66, v36, v37
  v_exp_f32 v40, v40
  v_cvt_pk_bf16_f32 v67, v38, v39
  v_exp_f32 v41, v41
  v_exp_f32 v42, v42
  v_mfma_f32_32x32x16_bf16 v[48:63], v[88:91], v[64:67], v[48:63]
  v_exp_f32 v43, v43
  v_cvt_pk_bf16_f32 v68, v40, v41
  v_exp_f32 v44, v44
  v_exp_f32 v45, v45
  v_cvt_pk_bf16_f32 v69, v42, v43
  v_exp_f32 v46, v46
  v_exp_f32 v47, v47
  v_cvt_pk_bf16_f32 v70, v44, v45
  v_cvt_pk_bf16_f32 v71, v46, v47
  s_waitcnt lgkmcnt(0)
  v_mfma_f32_32x32x16_bf16 v[32:47], v[76:79], v[4:7], 0
  ds_read_b128 v[72:75], v9 offset:51200
  v_exp_f32 v16, v16
  v_exp_f32 v17, v17
  v_exp_f32 v18, v18
  v_exp_f32 v19, v19
  v_mfma_f32_32x32x16_bf16 v[48:63], v[92:95], v[68:71], v[48:63]
  ds_read_b128 v[88:91], v8 offset:1024
  ds_read_b128 v[92:95], v8 offset:1536
  v_cvt_pk_bf16_f32 v64, v16, v17
  v_exp_f32 v20, v20
  v_exp_f32 v21, v21
  v_cvt_pk_bf16_f32 v65, v18, v19
  v_exp_f32 v22, v22
  v_exp_f32 v23, v23
  v_cvt_pk_bf16_f32 v66, v20, v21
  v_exp_f32 v24, v24
  v_cvt_pk_bf16_f32 v67, v22, v23
  v_exp_f32 v25, v25
  v_exp_f32 v26, v26
  v_mfma_f32_32x32x16_bf16 v[48:63], v[80:83], v[64:67], v[48:63]
  v_exp_f32 v27, v27
  v_cvt_pk_bf16_f32 v68, v24, v25
  v_exp_f32 v28, v28
  v_exp_f32 v29, v29
  v_cvt_pk_bf16_f32 v69, v26, v27
  v_exp_f32 v30, v30
  v_exp_f32 v31, v31
  v_cvt_pk_bf16_f32 v70, v28, v29
  v_cvt_pk_bf16_f32 v71, v30, v31
  s_waitcnt lgkmcnt(0)
  v_mfma_f32_32x32x16_bf16 v[16:31], v[72:75], v[4:7], 0
  ds_read_b128 v[76:79], v9 offset:52224
  v_exp_f32 v32, v32
  v_exp_f32 v33, v33
  v_exp_f32 v34, v34
  v_exp_f32 v35, v35
  v_mfma_f32_32x32x16_bf16 v[48:63], v[84:87], v[68:71], v[48:63]
  ds_read_b128 v[80:83], v8 offset:2048
  ds_read_b128 v[84:87], v8 offset:2560
  v_cvt_pk_bf16_f32 v64, v32, v33
  v_exp_f32 v36, v36
  v_exp_f32 v37, v37
  v_cvt_pk_bf16_f32 v65, v34, v35
  v_exp_f32 v38, v38
  v_exp_f32 v39, v39
  v_cvt_pk_bf16_f32 v66, v36, v37
  v_exp_f32 v40, v40
  v_cvt_pk_bf16_f32 v67, v38, v39
  v_exp_f32 v41, v41
  v_exp_f32 v42, v42
  v_mfma_f32_32x32x16_bf16 v[48:63], v[88:91], v[64:67], v[48:63]
  v_exp_f32 v43, v43
  v_cvt_pk_bf16_f32 v68, v40, v41
  v_exp_f32 v44, v44
  v_exp_f32 v45, v45
  v_cvt_pk_bf16_f32 v69, v42, v43
  v_exp_f32 v46, v46
  v_exp_f32 v47, v47
  v_cvt_pk_bf16_f32 v70, v44, v45
  v_cvt_pk_bf16_f32 v71, v46, v47
  s_waitcnt lgkmcnt(0)
  v_mfma_f32_32x32x16_bf16 v[32:47], v[76:79], v[4:7], 0
  ds_read_b128 v[72:75], v9 offset:53248
  v_exp_f32 v16, v16
  v_exp_f32 v17, v17
  v_exp_f32 v18, v18
  v_exp_f32 v19, v19
  v_mfma_f32_32x32x16_bf16 v[48:63], v[92:95], v[68:71], v[48:63]
  ds_read_b128 v[88:91], v8 offset:3072
  ds_read_b128 v[92:95], v8 offset:3584
  v_cvt_pk_bf16_f32 v64, v16, v17
  v_exp_f32 v20, v20
  v_exp_f32 v21, v21
  v_cvt_pk_bf16_f32 v65, v18, v19
  v_exp_f32 v22, v22
  v_exp_f32 v23, v23
  v_cvt_pk_bf16_f32 v66, v20, v21
  v_exp_f32 v24, v24
  v_cvt_pk_bf16_f32 v67, v22, v23
  v_exp_f32 v25, v25
  v_exp_f32 v26, v26
  v_mfma_f32_32x32x16_bf16 v[48:63], v[80:83], v[64:67], v[48:63]
  v_exp_f32 v27, v27
  v_cvt_pk_bf16_f32 v68, v24, v25
  v_exp_f32 v28, v28
  v_exp_f32 v29, v29
  v_cvt_pk_bf16_f32 v69, v26, v27
  v_exp_f32 v30, v30
  v_exp_f32 v31, v31
  v_cvt_pk_bf16_f32 v70, v28, v29
  v_cvt_pk_bf16_f32 v71, v30, v31
  s_waitcnt lgkmcnt(0)
  v_mfma_f32_32x32x16_bf16 v[16:31], v[72:75], v[4:7], 0
  ds_read_b128 v[76:79], v9 offset:54272
  v_exp_f32 v32, v32
  v_exp_f32 v33, v33
  v_exp_f32 v34, v34
  v_exp_f32 v35, v35
  v_mfma_f32_32x32x16_bf16 v[48:63], v[84:87], v[68:71], v[48:63]
  v_add_u32 v8, v8, v10
  ds_read_b128 v[80:83], v8 offset:0
  ds_read_b128 v[84:87], v8 offset:512
  v_cvt_pk_bf16_f32 v64, v32, v33
  v_exp_f32 v36, v36
  v_exp_f32 v37, v37
  v_cvt_pk_bf16_f32 v65, v34, v35
  v_exp_f32 v38, v38
  v_exp_f32 v39, v39
  v_cvt_pk_bf16_f32 v66, v36, v37
  v_exp_f32 v40, v40
  v_cvt_pk_bf16_f32 v67, v38, v39
  v_exp_f32 v41, v41
  v_exp_f32 v42, v42
  v_mfma_f32_32x32x16_bf16 v[48:63], v[88:91], v[64:67], v[48:63]
  v_exp_f32 v43, v43
  v_cvt_pk_bf16_f32 v68, v40, v41
  v_exp_f32 v44, v44
  v_exp_f32 v45, v45
  v_cvt_pk_bf16_f32 v69, v42, v43
  v_exp_f32 v46, v46
  v_exp_f32 v47, v47
  v_cvt_pk_bf16_f32 v70, v44, v45
  v_cvt_pk_bf16_f32 v71, v46, v47
  s_waitcnt lgkmcnt(0)
  v_mfma_f32_32x32x16_bf16 v[32:47], v[76:79], v[4:7], 0
  ds_read_b128 v[72:75], v9 offset:55296
  v_exp_f32 v16, v16
  v_exp_f32 v17, v17
  v_exp_f32 v18, v18
  v_exp_f32 v19, v19
  v_mfma_f32_32x32x16_bf16 v[48:63], v[92:95], v[68:71], v[48:63]
  ds_read_b128 v[88:91], v8 offset:1024
  ds_read_b128 v[92:95], v8 offset:1536
  v_cvt_pk_bf16_f32 v64, v16, v17
  v_exp_f32 v20, v20
  v_exp_f32 v21, v21
  v_cvt_pk_bf16_f32 v65, v18, v19
  v_exp_f32 v22, v22
  v_exp_f32 v23, v23
  v_cvt_pk_bf16_f32 v66, v20, v21
  v_exp_f32 v24, v24
  v_cvt_pk_bf16_f32 v67, v22, v23
  v_exp_f32 v25, v25
  v_exp_f32 v26, v26
  v_mfma_f32_32x32x16_bf16 v[48:63], v[80:83], v[64:67], v[48:63]
  v_exp_f32 v27, v27
  v_cvt_pk_bf16_f32 v68, v24, v25
  v_exp_f32 v28, v28
  v_exp_f32 v29, v29
  v_cvt_pk_bf16_f32 v69, v26, v27
  v_exp_f32 v30, v30
  v_exp_f32 v31, v31
  v_cvt_pk_bf16_f32 v70, v28, v29
  v_cvt_pk_bf16_f32 v71, v30, v31
  s_waitcnt lgkmcnt(0)
  v_mfma_f32_32x32x16_bf16 v[16:31], v[72:75], v[4:7], 0
  ds_read_b128 v[76:79], v9 offset:56320
  v_exp_f32 v32, v32
  v_exp_f32 v33, v33
  v_exp_f32 v34, v34
  v_exp_f32 v35, v35
  v_mfma_f32_32x32x16_bf16 v[48:63], v[84:87], v[68:71], v[48:63]
  ds_read_b128 v[80:83], v8 offset:2048
  ds_read_b128 v[84:87], v8 offset:2560
  v_cvt_pk_bf16_f32 v64, v32, v33
  v_exp_f32 v36, v36
  v_exp_f32 v37, v37
  v_cvt_pk_bf16_f32 v65, v34, v35
  v_exp_f32 v38, v38
  v_exp_f32 v39, v39
  v_cvt_pk_bf16_f32 v66, v36, v37
  v_exp_f32 v40, v40
  v_cvt_pk_bf16_f32 v67, v38, v39
  v_exp_f32 v41, v41
  v_exp_f32 v42, v42
  v_mfma_f32_32x32x16_bf16 v[48:63], v[88:91], v[64:67], v[48:63]
  v_exp_f32 v43, v43
  v_cvt_pk_bf16_f32 v68, v40, v41
  v_exp_f32 v44, v44
  v_exp_f32 v45, v45
  v_cvt_pk_bf16_f32 v69, v42, v43
  v_exp_f32 v46, v46
  v_exp_f32 v47, v47
  v_cvt_pk_bf16_f32 v70, v44, v45
  v_cvt_pk_bf16_f32 v71, v46, v47
  s_waitcnt vmcnt(0) lgkmcnt(0)
  s_barrier
  v_mfma_f32_32x32x16_bf16 v[32:47], v[76:79], v[4:7], 0
  ds_read_b128 v[72:75], v9 offset:57344
  v_exp_f32 v16, v16
  v_exp_f32 v17, v17
  v_exp_f32 v18, v18
  v_exp_f32 v19, v19
  v_mfma_f32_32x32x16_bf16 v[48:63], v[92:95], v[68:71], v[48:63]
  ds_read_b128 v[88:91], v8 offset:3072
  ds_read_b128 v[92:95], v8 offset:3584
  v_cvt_pk_bf16_f32 v64, v16, v17
  v_exp_f32 v20, v20
  v_exp_f32 v21, v21
  v_cvt_pk_bf16_f32 v65, v18, v19
  v_exp_f32 v22, v22
  v_exp_f32 v23, v23
  v_cvt_pk_bf16_f32 v66, v20, v21
  v_exp_f32 v24, v24
  v_cvt_pk_bf16_f32 v67, v22, v23
  v_exp_f32 v25, v25
  v_exp_f32 v26, v26
  v_mfma_f32_32x32x16_bf16 v[48:63], v[80:83], v[64:67], v[48:63]
  v_exp_f32 v27, v27
  v_cvt_pk_bf16_f32 v68, v24, v25
  v_exp_f32 v28, v28
  v_exp_f32 v29, v29
  v_cvt_pk_bf16_f32 v69, v26, v27
  v_exp_f32 v30, v30
  v_exp_f32 v31, v31
  v_cvt_pk_bf16_f32 v70, v28, v29
  v_cvt_pk_bf16_f32 v71, v30, v31
  s_waitcnt lgkmcnt(0)
  v_mfma_f32_32x32x16_bf16 v[16:31], v[72:75], v[4:7], 0
  ds_read_b128 v[76:79], v9 offset:58368
  v_exp_f32 v32, v32
  v_exp_f32 v33, v33
  v_exp_f32 v34, v34
  v_exp_f32 v35, v35
  v_mfma_f32_32x32x16_bf16 v[48:63], v[84:87], v[68:71], v[48:63]
  v_add_u32 v8, v8, v10
  ds_read_b128 v[80:83], v8 offset:0
  ds_read_b128 v[84:87], v8 offset:512
  v_cvt_pk_bf16_f32 v64, v32, v33
  v_exp_f32 v36, v36
  v_exp_f32 v37, v37
  v_cvt_pk_bf16_f32 v65, v34, v35
  v_exp_f32 v38, v38
  v_exp_f32 v39, v39
  v_cvt_pk_bf16_f32 v66, v36, v37
  v_exp_f32 v40, v40
  v_cvt_pk_bf16_f32 v67, v38, v39
  v_exp_f32 v41, v41
  v_exp_f32 v42, v42
  v_mfma_f32_32x32x16_bf16 v[48:63], v[88:91], v[64:67], v[48:63]
  v_exp_f32 v43, v43
  v_cvt_pk_bf16_f32 v68, v40, v41
  v_exp_f32 v44, v44
  v_exp_f32 v45, v45
  v_cvt_pk_bf16_f32 v69, v42, v43
  v_exp_f32 v46, v46
  v_exp_f32 v47, v47
  v_cvt_pk_bf16_f32 v70, v44, v45
  v_cvt_pk_bf16_f32 v71, v46, v47
  s_waitcnt lgkmcnt(0)
  v_mfma_f32_32x32x16_bf16 v[32:47], v[76:79], v[4:7], 0
  ds_read_b128 v[72:75], v9 offset:59392
  v_exp_f32 v16, v16
  v_exp_f32 v17, v17
  v_exp_f32 v18, v18
  v_exp_f32 v19, v19
  v_mfma_f32_32x32x16_bf16 v[48:63], v[92:95], v[68:71], v[48:63]
  ds_read_b128 v[88:91], v8 offset:1024
  ds_read_b128 v[92:95], v8 offset:1536
  v_cvt_pk_bf16_f32 v64, v16, v17
  v_exp_f32 v20, v20
  v_exp_f32 v21, v21
  v_cvt_pk_bf16_f32 v65, v18, v19
  v_exp_f32 v22, v22
  v_exp_f32 v23, v23
  v_cvt_pk_bf16_f32 v66, v20, v21
  v_exp_f32 v24, v24
  v_cvt_pk_bf16_f32 v67, v22, v23
  v_exp_f32 v25, v25
  v_exp_f32 v26, v26
  v_mfma_f32_32x32x16_bf16 v[48:63], v[80:83], v[64:67], v[48:63]
  v_exp_f32 v27, v27
  v_cvt_pk_bf16_f32 v68, v24, v25
  v_exp_f32 v28, v28
  v_exp_f32 v29, v29
  v_cvt_pk_bf16_f32 v69, v26, v27
  v_exp_f32 v30, v30
  v_exp_f32 v31, v31
  v_cvt_pk_bf16_f32 v70, v28, v29
  v_cvt_pk_bf16_f32 v71, v30, v31
  s_waitcnt lgkmcnt(0)
  v_mfma_f32_32x32x16_bf16 v[16:31], v[72:75], v[4:7], 0
  ds_read_b128 v[76:79], v9 offset:60416
  v_exp_f32 v32, v32
  v_exp_f32 v33, v33
  v_exp_f32 v34, v34
  v_exp_f32 v35, v35
  v_mfma_f32_32x32x16_bf16 v[48:63], v[84:87], v[68:71], v[48:63]
  ds_read_b128 v[80:83], v8 offset:2048
  ds_read_b128 v[84:87], v8 offset:2560
  v_cvt_pk_bf16_f32 v64, v32, v33
  v_exp_f32 v36, v36
  v_exp_f32 v37, v37
  v_cvt_pk_bf16_f32 v65, v34, v35
  v_exp_f32 v38, v38
  v_exp_f32 v39, v39
  v_cvt_pk_bf16_f32 v66, v36, v37
  v_exp_f32 v40, v40
  v_cvt_pk_bf16_f32 v67, v38, v39
  v_exp_f32 v41, v41
  v_exp_f32 v42, v42
  v_mfma_f32_32x32x16_bf16 v[48:63], v[88:91], v[64:67], v[48:63]
  v_exp_f32 v43, v43
  v_cvt_pk_bf16_f32 v68, v40, v41
  v_exp_f32 v44, v44
  v_exp_f32 v45, v45
  v_cvt_pk_bf16_f32 v69, v42, v43
  v_exp_f32 v46, v46
  v_exp_f32 v47, v47
  v_cvt_pk_bf16_f32 v70, v44, v45
  v_cvt_pk_bf16_f32 v71, v46, v47
  s_waitcnt lgkmcnt(0)
  v_mfma_f32_32x32x16_bf16 v[32:47], v[76:79], v[4:7], 0
  ds_read_b128 v[72:75], v9 offset:61440
  v_exp_f32 v16, v16
  v_exp_f32 v17, v17
  v_exp_f32 v18, v18
  v_exp_f32 v19, v19
  v_mfma_f32_32x32x16_bf16 v[48:63], v[92:95], v[68:71], v[48:63]
  ds_read_b128 v[88:91], v8 offset:3072
  ds_read_b128 v[92:95], v8 offset:3584
  v_cvt_pk_bf16_f32 v64, v16, v17
  v_exp_f32 v20, v20
  v_exp_f32 v21, v21
  v_cvt_pk_bf16_f32 v65, v18, v19
  v_exp_f32 v22, v22
  v_exp_f32 v23, v23
  v_cvt_pk_bf16_f32 v66, v20, v21
  v_exp_f32 v24, v24
  v_cvt_pk_bf16_f32 v67, v22, v23
  v_exp_f32 v25, v25
  v_exp_f32 v26, v26
  v_mfma_f32_32x32x16_bf16 v[48:63], v[80:83], v[64:67], v[48:63]
  v_exp_f32 v27, v27
  v_cvt_pk_bf16_f32 v68, v24, v25
  v_exp_f32 v28, v28
  v_exp_f32 v29, v29
  v_cvt_pk_bf16_f32 v69, v26, v27
  v_exp_f32 v30, v30
  v_exp_f32 v31, v31
  v_cvt_pk_bf16_f32 v70, v28, v29
  v_cvt_pk_bf16_f32 v71, v30, v31
  s_waitcnt lgkmcnt(0)
  v_mfma_f32_32x32x16_bf16 v[16:31], v[72:75], v[4:7], 0
  ds_read_b128 v[76:79], v9 offset:62464
  v_exp_f32 v32, v32
  v_exp_f32 v33, v33
  v_exp_f32 v34, v34
  v_exp_f32 v35, v35
  v_mfma_f32_32x32x16_bf16 v[48:63], v[84:87], v[68:71], v[48:63]
  v_add_u32 v8, v8, v10
  ds_read_b128 v[80:83], v8 offset:0
  ds_read_b128 v[84:87], v8 offset:512
  v_cvt_pk_bf16_f32 v64, v32, v33
  v_exp_f32 v36, v36
  v_exp_f32 v37, v37
  v_cvt_pk_bf16_f32 v65, v34, v35
  v_exp_f32 v38, v38
  v_exp_f32 v39, v39
  v_cvt_pk_bf16_f32 v66, v36, v37
  v_exp_f32 v40, v40
  v_cvt_pk_bf16_f32 v67, v38, v39
  v_exp_f32 v41, v41
  v_exp_f32 v42, v42
  v_mfma_f32_32x32x16_bf16 v[48:63], v[88:91], v[64:67], v[48:63]
  v_exp_f32 v43, v43
  v_cvt_pk_bf16_f32 v68, v40, v41
  v_exp_f32 v44, v44
  v_exp_f32 v45, v45
  v_cvt_pk_bf16_f32 v69, v42, v43
  v_exp_f32 v46, v46
  v_exp_f32 v47, v47
  v_cvt_pk_bf16_f32 v70, v44, v45
  v_cvt_pk_bf16_f32 v71, v46, v47
  s_waitcnt lgkmcnt(0)
  v_mfma_f32_32x32x16_bf16 v[32:47], v[76:79], v[4:7], 0
  ds_read_b128 v[72:75], v9 offset:63488
  v_exp_f32 v16, v16
  v_exp_f32 v17, v17
  v_exp_f32 v18, v18
  v_exp_f32 v19, v19
  v_mfma_f32_32x32x16_bf16 v[48:63], v[92:95], v[68:71], v[48:63]
  ds_read_b128 v[88:91], v8 offset:1024
  ds_read_b128 v[92:95], v8 offset:1536
  v_cvt_pk_bf16_f32 v64, v16, v17
  v_exp_f32 v20, v20
  v_exp_f32 v21, v21
  v_cvt_pk_bf16_f32 v65, v18, v19
  v_exp_f32 v22, v22
  v_exp_f32 v23, v23
  v_cvt_pk_bf16_f32 v66, v20, v21
  v_exp_f32 v24, v24
  v_cvt_pk_bf16_f32 v67, v22, v23
  v_exp_f32 v25, v25
  v_exp_f32 v26, v26
  v_mfma_f32_32x32x16_bf16 v[48:63], v[80:83], v[64:67], v[48:63]
  v_exp_f32 v27, v27
  v_cvt_pk_bf16_f32 v68, v24, v25
  v_exp_f32 v28, v28
  v_exp_f32 v29, v29
  v_cvt_pk_bf16_f32 v69, v26, v27
  v_exp_f32 v30, v30
  v_exp_f32 v31, v31
  v_cvt_pk_bf16_f32 v70, v28, v29
  v_cvt_pk_bf16_f32 v71, v30, v31
  s_waitcnt lgkmcnt(0)
  v_mfma_f32_32x32x16_bf16 v[16:31], v[72:75], v[4:7], 0
  ds_read_b128 v[76:79], v9 offset:64512
  v_exp_f32 v32, v32
  v_exp_f32 v33, v33
  v_exp_f32 v34, v34
  v_exp_f32 v35, v35
  v_mfma_f32_32x32x16_bf16 v[48:63], v[84:87], v[68:71], v[48:63]
  ds_read_b128 v[80:83], v8 offset:2048
  ds_read_b128 v[84:87], v8 offset:2560
  v_cvt_pk_bf16_f32 v64, v32, v33
  v_exp_f32 v36, v36
  v_exp_f32 v37, v37
  v_cvt_pk_bf16_f32 v65, v34, v35
  v_exp_f32 v38, v38
  v_exp_f32 v39, v39
  v_cvt_pk_bf16_f32 v66, v36, v37
  v_exp_f32 v40, v40
  v_cvt_pk_bf16_f32 v67, v38, v39
  v_exp_f32 v41, v41
  v_exp_f32 v42, v42
  v_mfma_f32_32x32x16_bf16 v[48:63], v[88:91], v[64:67], v[48:63]
  v_exp_f32 v43, v43
  v_cvt_pk_bf16_f32 v68, v40, v41
  v_exp_f32 v44, v44
  v_exp_f32 v45, v45
  v_cvt_pk_bf16_f32 v69, v42, v43
  v_exp_f32 v46, v46
  v_exp_f32 v47, v47
  v_cvt_pk_bf16_f32 v70, v44, v45
  v_cvt_pk_bf16_f32 v71, v46, v47
  s_waitcnt lgkmcnt(0)
  v_mfma_f32_32x32x16_bf16 v[32:47], v[76:79], v[4:7], 0
  v_exp_f32 v16, v16
  v_exp_f32 v17, v17
  v_exp_f32 v18, v18
  v_exp_f32 v19, v19
  v_mfma_f32_32x32x16_bf16 v[48:63], v[92:95], v[68:71], v[48:63]
  ds_read_b128 v[88:91], v8 offset:3072
  ds_read_b128 v[92:95], v8 offset:3584
  v_cvt_pk_bf16_f32 v64, v16, v17
  v_exp_f32 v20, v20
  v_exp_f32 v21, v21
  v_cvt_pk_bf16_f32 v65, v18, v19
  v_exp_f32 v22, v22
  v_exp_f32 v23, v23
  v_cvt_pk_bf16_f32 v66, v20, v21
  v_exp_f32 v24, v24
  v_cvt_pk_bf16_f32 v67, v22, v23
  v_exp_f32 v25, v25
  v_exp_f32 v26, v26
  v_mfma_f32_32x32x16_bf16 v[48:63], v[80:83], v[64:67], v[48:63]
  v_exp_f32 v27, v27
  v_cvt_pk_bf16_f32 v68, v24, v25
  v_exp_f32 v28, v28
  v_exp_f32 v29, v29
  v_cvt_pk_bf16_f32 v69, v26, v27
  v_exp_f32 v30, v30
  v_exp_f32 v31, v31
  v_cvt_pk_bf16_f32 v70, v28, v29
  v_cvt_pk_bf16_f32 v71, v30, v31
  s_waitcnt lgkmcnt(0)
  v_exp_f32 v32, v32
  v_exp_f32 v33, v33
  v_exp_f32 v34, v34
  v_exp_f32 v35, v35
  v_mfma_f32_32x32x16_bf16 v[48:63], v[84:87], v[68:71], v[48:63]
  v_cvt_pk_bf16_f32 v64, v32, v33
  v_exp_f32 v36, v36
  v_exp_f32 v37, v37
  v_cvt_pk_bf16_f32 v65, v34, v35
  v_exp_f32 v38, v38
  v_exp_f32 v39, v39
  v_cvt_pk_bf16_f32 v66, v36, v37
  v_exp_f32 v40, v40
  v_cvt_pk_bf16_f32 v67, v38, v39
  v_exp_f32 v41, v41
  v_exp_f32 v42, v42
  v_mfma_f32_32x32x16_bf16 v[48:63], v[88:91], v[64:67], v[48:63]
  v_exp_f32 v43, v43
  v_cvt_pk_bf16_f32 v68, v40, v41
  v_exp_f32 v44, v44
  v_exp_f32 v45, v45
  v_cvt_pk_bf16_f32 v69, v42, v43
  v_exp_f32 v46, v46
  v_exp_f32 v47, v47
  v_cvt_pk_bf16_f32 v70, v44, v45
  v_cvt_pk_bf16_f32 v71, v46, v47
  s_nop 1
  v_mfma_f32_32x32x16_bf16 v[48:63], v[92:95], v[68:71], v[48:63]
  s_mov_b32 s42, 0x2b800000
  s_mov_b32 s43, 0x53800000
  s_nop 7
  s_nop 3
  v_cmp_le_f32 vcc, s42, v56
  v_cmp_ge_f32 s[44:45], s43, v56
  s_and_b64 vcc, vcc, s[44:45]
  s_cmp_eq_u64 vcc, -1
  s_cbranch_scc0 K2_fb
K2_fin:
  v_rcp_f32 v12, v56
  s_nop 0
  v_mul_f32 v48, v12, v48
  v_mul_f32 v49, v12, v49
  v_mul_f32 v50, v12, v50
  v_mul_f32 v51, v12, v51
  v_mul_f32 v52, v12, v52
  v_mul_f32 v53, v12, v53
  v_mul_f32 v54, v12, v54
  v_mul_f32 v55, v12, v55
  v_cvt_pk_bf16_f32 v64, v48, v49
  v_cvt_pk_bf16_f32 v65, v50, v51
  v_cvt_pk_bf16_f32 v66, v52, v53
  v_cvt_pk_bf16_f32 v67, v54, v55
  v_and_b32 v12, 7, v1
  v_xor_b32 v13, s3, v12
  v_lshlrev_b32 v13, 4, v13
  v_lshl_or_b32 v13, v1, 7, v13
  v_add_u32 v13, 135168, v13
  ds_write_b128 v13, v[64:67]
  v_lshrrev_b32 v14, 3, v1
  v_xor_b32 v13, v14, v12
  v_lshlrev_b32 v13, 4, v13
  v_lshl_or_b32 v13, v14, 7, v13
  s_lshl_b32 s7, s3, 10
  s_add_u32 s7, s7, 135168
  v_add_u32 v13, s7, v13
  v_lshlrev_b32 v12, 4, v12
  v_lshl_or_b32 v12, v14, 10, v12
  s_lshr_b32 s6, s2, 2
  s_lshl_b32 s6, s6, 15
  s_and_b32 s7, s2, 3
  s_lshl_b32 s7, s7, 7
  s_add_u32 s6, s6, s7
  s_and_b32 s7, s3, 3
  s_lshl_b32 s7, s7, 13
  s_add_u32 s6, s6, s7
  s_lshr_b32 s7, s3, 2
  s_lshl_b32 s7, s7, 9
  s_add_u32 s6, s6, s7
  s_waitcnt lgkmcnt(0)
  s_barrier
  ds_read_b128 v[64:67], v13
  s_waitcnt lgkmcnt(0)
  buffer_store_dwordx4 v[64:67], v12, s[16:19], s6 offen sc0 sc1
  s_endpgm
K2_fb:
  v_mov_b32 v12, 0xff800000
  v_mov_b32 v13, v9
  s_mov_b32 s46, 64
K2_fb1:
  ds_read_b128 v[72:75], v13
  v_add_u32 v13, 0x400, v13
  s_waitcnt lgkmcnt(0)
  v_mfma_f32_32x32x16_bf16 v[16:31], v[72:75], v[4:7], 0
  s_nop 7
  s_nop 7
  v_max3_f32 v12, v12, v16, v17
  v_max3_f32 v12, v12, v18, v19
  v_max3_f32 v12, v12, v20, v21
  v_max3_f32 v12, v12, v22, v23
  v_max3_f32 v12, v12, v24, v25
  v_max3_f32 v12, v12, v26, v27
  v_max3_f32 v12, v12, v28, v29
  v_max3_f32 v12, v12, v30, v31
  s_sub_u32 s46, s46, 1
  s_cmp_lg_u32 s46, 0
  s_cbranch_scc1 K2_fb1
  v_xor_b32 v13, 32, v1
  v_lshlrev_b32 v13, 2, v13
  ds_bpermute_b32 v13, v13, v12
  s_waitcnt lgkmcnt(0)
  v_max_f32 v12, v12, v13
  v_sub_f32 v32, 0, v12
  v_mov_b32 v48, 0
  v_sub_f32 v33, 0, v12
  v_mov_b32 v49, 0
  v_sub_f32 v34, 0, v12
  v_mov_b32 v50, 0
  v_sub_f32 v35, 0, v12
  v_mov_b32 v51, 0
  v_sub_f32 v36, 0, v12
  v_mov_b32 v52, 0
  v_sub_f32 v37, 0, v12
  v_mov_b32 v53, 0
  v_sub_f32 v38, 0, v12
  v_mov_b32 v54, 0
  v_sub_f32 v39, 0, v12
  v_mov_b32 v55, 0
  v_sub_f32 v40, 0, v12
  v_mov_b32 v56, 0
  v_sub_f32 v41, 0, v12
  v_mov_b32 v57, 0
  v_sub_f32 v42, 0, v12
  v_mov_b32 v58, 0
  v_sub_f32 v43, 0, v12
  v_mov_b32 v59, 0
  v_sub_f32 v44, 0, v12
  v_mov_b32 v60, 0
  v_sub_f32 v45, 0, v12
  v_mov_b32 v61, 0
  v_sub_f32 v46, 0, v12
  v_mov_b32 v62, 0
  v_sub_f32 v47, 0, v12
  v_mov_b32 v63, 0
  v_mov_b32 v13, v9
  v_cndmask_b32 v8, v15, v14, s[48:49]
  v_lshrrev_b32 v10, 2, v10
  s_mov_b32 s46, 64
K2_fb2:
  ds_read_b128 v[72:75], v13
  ds_read_b128 v[80:83], v8
  ds_read_b128 v[84:87], v8 offset:512
  v_add_u32 v13, 0x400, v13
  v_add_u32 v8, v8, v10
  s_waitcnt lgkmcnt(0)
  v_mfma_f32_32x32x16_bf16 v[16:31], v[72:75], v[4:7], v[32:47]
  s_nop 7
  s_nop 7
  v_exp_f32 v16, v16
  v_exp_f32 v17, v17
  v_exp_f32 v18, v18
  v_exp_f32 v19, v19
  v_exp_f32 v20, v20
  v_exp_f32 v21, v21
  v_exp_f32 v22, v22
  v_exp_f32 v23, v23
  v_exp_f32 v24, v24
  v_exp_f32 v25, v25
  v_exp_f32 v26, v26
  v_exp_f32 v27, v27
  v_exp_f32 v28, v28
  v_exp_f32 v29, v29
  v_exp_f32 v30, v30
  v_exp_f32 v31, v31
  s_nop 0
  v_cvt_pk_bf16_f32 v64, v16, v17
  v_cvt_pk_bf16_f32 v65, v18, v19
  v_cvt_pk_bf16_f32 v66, v20, v21
  v_cvt_pk_bf16_f32 v67, v22, v23
  v_cvt_pk_bf16_f32 v68, v24, v25
  v_cvt_pk_bf16_f32 v69, v26, v27
  v_cvt_pk_bf16_f32 v70, v28, v29
  v_cvt_pk_bf16_f32 v71, v30, v31
  s_nop 1
  v_mfma_f32_32x32x16_bf16 v[48:63], v[80:83], v[64:67], v[48:63]
  v_mfma_f32_32x32x16_bf16 v[48:63], v[84:87], v[68:71], v[48:63]
  s_sub_u32 s46, s46, 1
  s_cmp_lg_u32 s46, 0
  s_cbranch_scc1 K2_fb2
  s_nop 7
  s_nop 7
  s_branch K2_fin
K2_fft:
  s_add_u32 s8, s78, 3145728
  s_addc_u32 s9, s79, 0
  s_mov_b32 s10, 2097152
  s_mov_b32 s11, 0x00020000
  s_add_u32 s12, s78, 3145728
  s_addc_u32 s13, s79, 0
  s_mov_b32 s14, 2097152
  s_mov_b32 s15, 0x00020000
  s_add_u32 s16, s78, 7340032
  s_addc_u32 s17, s79, 0
  s_mov_b32 s18, 2097152
  s_mov_b32 s19, 0x00020000
  s_add_u32 s20, s78, 7340032
  s_addc_u32 s21, s79, 0
  s_mov_b32 s22, 2097152
  s_mov_b32 s23, 0x00020000
  s_add_u32 s24, s78, 10485760
  s_addc_u32 s25, s79, 0
  s_mov_b32 s26, 106496
  s_mov_b32 s27, 0x00020000
  s_add_u32 s28, s78, 13631488
  s_addc_u32 s29, s79, 0
  s_mov_b32 s30, 2105344
  s_mov_b32 s31, 0x00020000
  s_add_u32 s36, s78, 9437184
  s_addc_u32 s37, s79, 0
  s_mov_b32 s38, 524288
  s_mov_b32 s39, 0x00020000
  s_sub_u32 s3, s3, 8
  s_and_b32 s4, s3, 1
  s_lshr_b32 s5, s3, 1
  s_and_b32 s6, s2, 7
  s_lshl_b32 s6, s6, 5
  s_lshr_b32 s7, s2, 3
  s_add_u32 s6, s6, s7
  s_lshl_b32 s40, s6, 13
  s_add_u32 s41, s40, 4096
  s_lshl_b32 s42, s6, 13
  s_lshl_b32 s7, s3, 11
  s_add_u32 s42, s42, s7
  s_cmp_eq_u32 s6, 0
  s_cselect_b32 s14, 0, s14
  s_cselect_b32 s22, 0, s22
  s_cselect_b32 s47, 1, 0
  v_and_b32 v4, 15, v1
  v_lshrrev_b32 v5, 4, v1
  s_lshl_b32 s7, s4, 11
  v_lshlrev_b32 v13, 4, v5
  v_lshl_add_u32 v6, v4, 7, v13
  v_add_u32 v6, s7, v6
  s_mul_i32 s43, s3, 26624
  v_lshlrev_b32 v14, 4, v1
  s_lshl_b32 s7, s5, 6
  v_add_u32 v12, s7, v6
  v_and_b32 v15, 12, v4
  v_and_b32 v11, 3, v4
  v_lshl_add_u32 v15, v15, 1, v11
  s_lshl_b32 s7, s5, 5
  v_add_u32 v15, s7, v15
  v_mul_u32_u24 v15, 80, v15
  s_lshl_b32 s7, s4, 3
  s_add_u32 s7, s7, 135168
  v_add3_u32 v7, v15, v13, s7
  s_lshl_b32 s7, s3, 4
  v_add_u32 v15, s7, v4
  v_mul_u32_u24 v8, 80, v15
  v_add_u32 v8, 135168, v8
  v_add_u32 v8, v8, v13
  v_mul_u32_u24 v15, 144, v4
  s_lshl_b32 s7, s3, 5
  s_add_u32 s7, s7, 145408
  v_lshl_add_u32 v9, v5, 3, s7
  v_add_u32 v9, v9, v15
  s_mul_i32 s7, s4, 2304
  s_add_u32 s7, s7, 145408
  v_add3_u32 v10, v15, v13, s7
  s_cmp_ge_u32 s3, 2
  s_cbranch_scc1 K2_nog
  s_lshl_b32 s7, s2, 1
  s_add_u32 s7, s7, s3
  s_lshl_b32 s44, s7, 10
  s_and_b32 s45, s7, 31
  s_lshr_b32 s7, s7, 5
  s_lshl_b32 s7, s7, 5
  s_lshl_b32 s45, s45, 3
  v_lshrrev_b32 v137, 1, v3
  v_xor_b32 v137, v137, v3
  v_and_b32 v137, 4, v137
  v_lshl_or_b32 v136, v137, 1, v137
  v_xor_b32 v136, v136, v3
  v_add_u32 v136, s7, v136
  v_cvt_f32_u32 v136, v136
  v_lshl_add_u32 v137, v2, 2, s45
  v_cmp_eq_u32 vcc, 0, v137
  v_cvt_f32_u32 v137, v137
  v_mul_f32 v138, 0x3b000000, v136
  v_mul_f32 v139, v138, v137
  v_fract_f32 v139, v139
  v_mul_f32 v140, 0.5, v136
  v_mov_b32 v141, 0x3b800000
  v_mov_b32 v142, 0x3b000000
  v_cndmask_b32 v142, v141, v142, vcc
  v_add_f32 v153, 0x3e800000, v139
  v_fract_f32 v140, v140
  v_cndmask_b32 v153, v153, v140, vcc
  v_cos_f32 v152, v139
  v_cos_f32 v153, v153
  v_add_f32 v139, v139, v138
  v_add_f32 v155, 0x3e800000, v139
  v_cos_f32 v154, v139
  v_cos_f32 v155, v155
  v_add_f32 v139, v139, v138
  v_add_f32 v157, 0x3e800000, v139
  v_cos_f32 v156, v139
  v_cos_f32 v157, v157
  v_add_f32 v139, v139, v138
  v_add_f32 v159, 0x3e800000, v139
  v_cos_f32 v158, v139
  v_cos_f32 v159, v159
  s_nop 0
  v_mul_f32 v152, v142, v152
  v_mul_f32 v153, v142, v153
  v_mul_f32 v154, v141, v154
  v_mul_f32 v155, v141, v155
  v_mul_f32 v156, v141, v156
  v_mul_f32 v157, v141, v157
  v_mul_f32 v158, v141, v158
  v_mul_f32 v159, v141, v159
  v_cvt_pk_bf16_f32 v160, v152, v153
  v_cvt_pk_bf16_f32 v161, v154, v155
  v_cvt_pk_bf16_f32 v162, v156, v157
  v_cvt_pk_bf16_f32 v163, v158, v159
  buffer_store_dwordx4 v[160:163], v14, s[36:39], s44 offen sc0 sc1
K2_nog:
  s_barrier
  buffer_load_dwordx4 v[120:123], v6, s[8:11], s40 offen offset:0
  buffer_load_dwordx4 v[124:127], v6, s[8:11], s40 offen offset:64
  buffer_load_dwordx4 v[128:131], v6, s[12:15], s41 offen offset:0
  buffer_load_dwordx4 v[132:135], v6, s[12:15], s41 offen offset:64
  s_add_u32 s44, s43, 0
  buffer_load_dwordx4 v[16:19], v14, s[24:27], s44 offen
  s_add_u32 s44, s43, 1024
  buffer_load_dwordx4 v[20:23], v14, s[24:27], s44 offen
  s_add_u32 s44, s43, 2048
  buffer_load_dwordx4 v[24:27], v14, s[24:27], s44 offen
  s_add_u32 s44, s43, 3072
  buffer_load_dwordx4 v[28:31], v14, s[24:27], s44 offen
  s_add_u32 s44, s43, 4096
  buffer_load_dwordx4 v[32:35], v14, s[24:27], s44 offen
  s_add_u32 s44, s43, 5120
  buffer_load_dwordx4 v[36:39], v14, s[24:27], s44 offen
  s_add_u32 s44, s43, 6144
  buffer_load_dwordx4 v[40:43], v14, s[24:27], s44 offen
  s_add_u32 s44, s43, 7168
  buffer_load_dwordx4 v[44:47], v14, s[24:27], s44 offen
  s_add_u32 s44, s43, 8192
  buffer_load_dwordx4 v[48:51], v14, s[24:27], s44 offen
  s_add_u32 s44, s43, 9216
  buffer_load_dwordx4 v[52:55], v14, s[24:27], s44 offen
  s_add_u32 s44, s43, 10240
  buffer_load_dwordx4 v[56:59], v14, s[24:27], s44 offen
  s_add_u32 s44, s43, 11264
  buffer_load_dwordx4 v[60:63], v14, s[24:27], s44 offen
  s_add_u32 s44, s43, 18432
  buffer_load_dwordx4 v[88:91], v14, s[24:27], s44 offen
  s_add_u32 s44, s43, 19456
  buffer_load_dwordx4 v[92:95], v14, s[24:27], s44 offen
  s_add_u32 s44, s43, 20480
  buffer_load_dwordx4 v[96:99], v14, s[24:27], s44 offen
  s_add_u32 s44, s43, 21504
  buffer_load_dwordx4 v[100:103], v14, s[24:27], s44 offen
  s_add_u32 s44, s43, 12288
  buffer_load_dwordx4 v[64:67], v14, s[24:27], s44 offen
  s_add_u32 s44, s43, 13312
  buffer_load_dwordx4 v[68:71], v14, s[24:27], s44 offen
  s_add_u32 s44, s43, 14336
  buffer_load_dwordx4 v[72:75], v14, s[24:27], s44 offen
  s_add_u32 s44, s43, 15360
  buffer_load_dwordx4 v[76:79], v14, s[24:27], s44 offen
  s_add_u32 s44, s43, 16384
  buffer_load_dwordx4 v[80:83], v14, s[24:27], s44 offen
  s_add_u32 s44, s43, 17408
  buffer_load_dwordx4 v[84:87], v14, s[24:27], s44 offen
  s_add_u32 s44, s43, 22528
  buffer_load_dwordx4 v[104:107], v14, s[24:27], s44 offen
  s_add_u32 s44, s43, 23552
  buffer_load_dwordx4 v[108:111], v14, s[24:27], s44 offen
  s_add_u32 s44, s43, 24576
  buffer_load_dwordx4 v[112:115], v14, s[24:27], s44 offen
  s_add_u32 s44, s43, 25600
  buffer_load_dwordx4 v[116:119], v14, s[24:27], s44 offen
  s_barrier
  s_waitcnt vmcnt(10)
K2_col:
  v_mfma_f32_16x16x32_bf16 v[136:139], v[120:123], v[16:19], 0
  v_mfma_f32_16x16x32_bf16 v[144:147], v[128:131], v[16:19], 0
  v_mfma_f32_16x16x32_bf16 v[140:143], v[120:123], v[40:43], 0
  v_mfma_f32_16x16x32_bf16 v[148:151], v[128:131], v[40:43], 0
  v_mfma_f32_16x16x32_bf16 v[136:139], v[128:131], v[20:23], v[136:139]
  v_mfma_f32_16x16x32_bf16 v[144:147], v[120:123], v[24:27], v[144:147]
  v_mfma_f32_16x16x32_bf16 v[140:143], v[128:131], v[44:47], v[140:143]
  v_mfma_f32_16x16x32_bf16 v[148:151], v[120:123], v[48:51], v[148:151]
  v_mfma_f32_16x16x32_bf16 v[136:139], v[124:127], v[28:31], v[136:139]
  v_mfma_f32_16x16x32_bf16 v[144:147], v[132:135], v[28:31], v[144:147]
  v_mfma_f32_16x16x32_bf16 v[140:143], v[124:127], v[52:55], v[140:143]
  v_mfma_f32_16x16x32_bf16 v[148:151], v[132:135], v[52:55], v[148:151]
  v_mfma_f32_16x16x32_bf16 v[136:139], v[132:135], v[32:35], v[136:139]
  v_mfma_f32_16x16x32_bf16 v[144:147], v[124:127], v[36:39], v[144:147]
  v_mfma_f32_16x16x32_bf16 v[140:143], v[132:135], v[56:59], v[140:143]
  v_mfma_f32_16x16x32_bf16 v[148:151], v[124:127], v[60:63], v[148:151]
  s_nop 7
  buffer_load_dwordx4 v[128:131], v14, s[28:31], s42 offen offset:0
  buffer_load_dwordx4 v[132:135], v14, s[28:31], s42 offen offset:1024
  v_pk_mul_f32 v[152:153], v[136:137], v[88:89]
  v_pk_mul_f32 v[160:161], v[144:145], v[88:89]
  v_pk_mul_f32 v[154:155], v[138:139], v[90:91]
  v_pk_mul_f32 v[162:163], v[146:147], v[90:91]
  v_pk_fma_f32 v[152:153], v[144:145], v[92:93], v[152:153]
  v_pk_fma_f32 v[160:161], v[136:137], v[92:93], v[160:161] neg_lo:[1,0,0] neg_hi:[1,0,0]
  v_pk_fma_f32 v[154:155], v[146:147], v[94:95], v[154:155]
  v_pk_fma_f32 v[162:163], v[138:139], v[94:95], v[162:163] neg_lo:[1,0,0] neg_hi:[1,0,0]
  v_pk_mul_f32 v[156:157], v[140:141], v[96:97]
  v_pk_mul_f32 v[164:165], v[148:149], v[96:97]
  v_pk_mul_f32 v[158:159], v[142:143], v[98:99]
  v_pk_mul_f32 v[166:167], v[150:151], v[98:99]
  v_pk_fma_f32 v[156:157], v[148:149], v[100:101], v[156:157]
  v_pk_fma_f32 v[164:165], v[140:141], v[100:101], v[164:165] neg_lo:[1,0,0] neg_hi:[1,0,0]
  v_pk_fma_f32 v[158:159], v[150:151], v[102:103], v[158:159]
  v_pk_fma_f32 v[166:167], v[142:143], v[102:103], v[166:167] neg_lo:[1,0,0] neg_hi:[1,0,0]
  v_cvt_pk_bf16_f32 v120, v152, v153
  v_cvt_pk_bf16_f32 v121, v154, v155
  v_cvt_pk_bf16_f32 v122, v156, v157
  v_cvt_pk_bf16_f32 v123, v158, v159
  v_cvt_pk_bf16_f32 v124, v160, v161
  v_cvt_pk_bf16_f32 v125, v162, v163
  v_cvt_pk_bf16_f32 v126, v164, v165
  v_cvt_pk_bf16_f32 v127, v166, v167
  ds_write_b64 v7, v[120:121] offset:0
  ds_write_b64 v7, v[122:123] offset:320
  ds_write_b64 v7, v[124:125] offset:5120
  ds_write_b64 v7, v[126:127] offset:5440
  s_waitcnt lgkmcnt(0)
  s_barrier
  ds_read_b128 v[120:123], v8
  ds_read_b128 v[124:127], v8 offset:5120
  s_waitcnt vmcnt(0) lgkmcnt(0)
  v_mfma_f32_16x16x32_bf16 v[136:139], v[64:67], v[120:123], 0
  v_mfma_f32_16x16x32_bf16 v[144:147], v[64:67], v[124:127], 0
  v_mfma_f32_16x16x32_bf16 v[140:143], v[76:79], v[120:123], 0
  v_mfma_f32_16x16x32_bf16 v[148:151], v[76:79], v[124:127], 0
  v_mfma_f32_16x16x32_bf16 v[136:139], v[68:71], v[124:127], v[136:139]
  v_mfma_f32_16x16x32_bf16 v[144:147], v[72:75], v[120:123], v[144:147]
  v_mfma_f32_16x16x32_bf16 v[140:143], v[80:83], v[124:127], v[140:143]
  v_mfma_f32_16x16x32_bf16 v[148:151], v[84:87], v[120:123], v[148:151]
  v_lshlrev_b32 v152, 16, v128
  v_and_b32 v128, 0xffff0000, v128
  v_lshlrev_b32 v153, 16, v129
  v_and_b32 v129, 0xffff0000, v129
  v_lshlrev_b32 v154, 16, v130
  v_and_b32 v130, 0xffff0000, v130
  v_lshlrev_b32 v155, 16, v131
  v_and_b32 v131, 0xffff0000, v131
  v_lshlrev_b32 v156, 16, v132
  v_and_b32 v132, 0xffff0000, v132
  v_lshlrev_b32 v157, 16, v133
  v_and_b32 v133, 0xffff0000, v133
  v_lshlrev_b32 v158, 16, v134
  v_and_b32 v134, 0xffff0000, v134
  v_lshlrev_b32 v159, 16, v135
  v_and_b32 v135, 0xffff0000, v135
  s_nop 1
  v_pk_mul_f32 v[160:161], v[144:145], v[128:129]
  v_pk_mul_f32 v[128:129], v[136:137], v[128:129]
  v_pk_mul_f32 v[162:163], v[146:147], v[130:131]
  v_pk_mul_f32 v[130:131], v[138:139], v[130:131]
  v_pk_fma_f32 v[136:137], v[136:137], v[152:153], v[160:161] neg_lo:[0,0,1] neg_hi:[0,0,1]
  v_pk_fma_f32 v[144:145], v[144:145], v[152:153], v[128:129]
  v_pk_fma_f32 v[138:139], v[138:139], v[154:155], v[162:163] neg_lo:[0,0,1] neg_hi:[0,0,1]
  v_pk_fma_f32 v[146:147], v[146:147], v[154:155], v[130:131]
  v_pk_mul_f32 v[164:165], v[148:149], v[132:133]
  v_pk_mul_f32 v[132:133], v[140:141], v[132:133]
  v_pk_mul_f32 v[166:167], v[150:151], v[134:135]
  v_pk_mul_f32 v[134:135], v[142:143], v[134:135]
  v_pk_fma_f32 v[140:141], v[140:141], v[156:157], v[164:165] neg_lo:[0,0,1] neg_hi:[0,0,1]
  v_pk_fma_f32 v[148:149], v[148:149], v[156:157], v[132:133]
  v_pk_fma_f32 v[142:143], v[142:143], v[158:159], v[166:167] neg_lo:[0,0,1] neg_hi:[0,0,1]
  v_pk_fma_f32 v[150:151], v[150:151], v[158:159], v[134:135]
  v_cvt_pk_bf16_f32 v120, v136, v137
  v_cvt_pk_bf16_f32 v121, v138, v139
  v_cvt_pk_bf16_f32 v122, v140, v141
  v_cvt_pk_bf16_f32 v123, v142, v143
  v_cvt_pk_bf16_f32 v124, v144, v145
  v_cvt_pk_bf16_f32 v125, v146, v147
  v_cvt_pk_bf16_f32 v126, v148, v149
  v_cvt_pk_bf16_f32 v127, v150, v151
  s_nop 1
  v_mfma_f32_16x16x32_bf16 v[136:139], v[120:123], v[64:67], 0
  v_mfma_f32_16x16x32_bf16 v[144:147], v[124:127], v[64:67], 0
  v_mfma_f32_16x16x32_bf16 v[140:143], v[120:123], v[76:79], 0
  v_mfma_f32_16x16x32_bf16 v[148:151], v[124:127], v[76:79], 0
  v_mfma_f32_16x16x32_bf16 v[136:139], v[124:127], v[72:75], v[136:139]
  v_mfma_f32_16x16x32_bf16 v[144:147], v[120:123], v[68:71], v[144:147]
  v_mfma_f32_16x16x32_bf16 v[140:143], v[124:127], v[84:87], v[140:143]
  v_mfma_f32_16x16x32_bf16 v[148:151], v[120:123], v[80:83], v[148:151]
  s_nop 7
  v_pk_mul_f32 v[152:153], v[136:137], v[104:105]
  v_pk_mul_f32 v[160:161], v[144:145], v[104:105]
  v_pk_mul_f32 v[154:155], v[138:139], v[106:107]
  v_pk_mul_f32 v[162:163], v[146:147], v[106:107]
  v_pk_fma_f32 v[152:153], v[144:145], v[108:109], v[152:153] neg_lo:[1,0,0] neg_hi:[1,0,0]
  v_pk_fma_f32 v[160:161], v[136:137], v[108:109], v[160:161]
  v_pk_fma_f32 v[154:155], v[146:147], v[110:111], v[154:155] neg_lo:[1,0,0] neg_hi:[1,0,0]
  v_pk_fma_f32 v[162:163], v[138:139], v[110:111], v[162:163]
  v_pk_mul_f32 v[156:157], v[140:141], v[112:113]
  v_pk_mul_f32 v[164:165], v[148:149], v[112:113]
  v_pk_mul_f32 v[158:159], v[142:143], v[114:115]
  v_pk_mul_f32 v[166:167], v[150:151], v[114:115]
  v_pk_fma_f32 v[156:157], v[148:149], v[116:117], v[156:157] neg_lo:[1,0,0] neg_hi:[1,0,0]
  v_pk_fma_f32 v[164:165], v[140:141], v[116:117], v[164:165]
  v_pk_fma_f32 v[158:159], v[150:151], v[118:119], v[158:159] neg_lo:[1,0,0] neg_hi:[1,0,0]
  v_pk_fma_f32 v[166:167], v[142:143], v[118:119], v[166:167]
  v_cvt_pk_bf16_f32 v120, v152, v153
  v_cvt_pk_bf16_f32 v121, v154, v155
  v_cvt_pk_bf16_f32 v122, v156, v157
  v_cvt_pk_bf16_f32 v123, v158, v159
  v_cvt_pk_bf16_f32 v124, v160, v161
  v_cvt_pk_bf16_f32 v125, v162, v163
  v_cvt_pk_bf16_f32 v126, v164, v165
  v_cvt_pk_bf16_f32 v127, v166, v167
  ds_write_b64 v9, v[120:121] offset:0
  ds_write_b64 v9, v[122:123] offset:2304
  ds_write_b64 v9, v[124:125] offset:4608
  ds_write_b64 v9, v[126:127] offset:6912
  s_waitcnt lgkmcnt(0)
  s_barrier
  ds_read_b128 v[120:123], v10 offset:0
  ds_read_b128 v[124:127], v10 offset:64
  ds_read_b128 v[128:131], v10 offset:4608
  ds_read_b128 v[132:135], v10 offset:4672
  s_waitcnt lgkmcnt(0)
  v_mfma_f32_16x16x32_bf16 v[136:139], v[16:19], v[120:123], 0
  v_mfma_f32_16x16x32_bf16 v[144:147], v[16:19], v[128:131], 0
  v_mfma_f32_16x16x32_bf16 v[140:143], v[40:43], v[120:123], 0
  v_mfma_f32_16x16x32_bf16 v[148:151], v[40:43], v[128:131], 0
  v_mfma_f32_16x16x32_bf16 v[136:139], v[24:27], v[128:131], v[136:139]
  v_mfma_f32_16x16x32_bf16 v[144:147], v[20:23], v[120:123], v[144:147]
  v_mfma_f32_16x16x32_bf16 v[140:143], v[48:51], v[128:131], v[140:143]
  v_mfma_f32_16x16x32_bf16 v[148:151], v[44:47], v[120:123], v[148:151]
  v_mfma_f32_16x16x32_bf16 v[136:139], v[28:31], v[124:127], v[136:139]
  v_mfma_f32_16x16x32_bf16 v[144:147], v[28:31], v[132:135], v[144:147]
  v_mfma_f32_16x16x32_bf16 v[140:143], v[52:55], v[124:127], v[140:143]
  v_mfma_f32_16x16x32_bf16 v[148:151], v[52:55], v[132:135], v[148:151]
  v_mfma_f32_16x16x32_bf16 v[136:139], v[36:39], v[132:135], v[136:139]
  v_mfma_f32_16x16x32_bf16 v[144:147], v[32:35], v[124:127], v[144:147]
  v_mfma_f32_16x16x32_bf16 v[140:143], v[60:63], v[132:135], v[140:143]
  v_mfma_f32_16x16x32_bf16 v[148:151], v[56:59], v[124:127], v[148:151]
  s_nop 7
  v_cvt_pk_bf16_f32 v152, v136, v137
  v_cvt_pk_bf16_f32 v153, v138, v139
  v_cvt_pk_bf16_f32 v154, v140, v141
  v_cvt_pk_bf16_f32 v155, v142, v143
  v_cvt_pk_bf16_f32 v156, v144, v145
  v_cvt_pk_bf16_f32 v157, v146, v147
  v_cvt_pk_bf16_f32 v158, v148, v149
  v_cvt_pk_bf16_f32 v159, v150, v151
  buffer_store_dwordx4 v[152:155], v12, s[16:19], s40 offen sc0 sc1
  buffer_store_dwordx4 v[156:159], v12, s[20:23], s41 offen sc0 sc1
  s_cmp_eq_u32 s47, 0
  s_cbranch_scc1 K2_exit
  s_mov_b32 s47, 0
  s_mov_b32 s40, 4096
  s_add_u32 s42, s42, 2097152
  buffer_load_dwordx4 v[120:123], v6, s[8:11], s40 offen offset:0
  buffer_load_dwordx4 v[124:127], v6, s[8:11], s40 offen offset:64
  buffer_load_dwordx4 v[128:131], v6, s[12:15], s41 offen offset:0
  buffer_load_dwordx4 v[132:135], v6, s[12:15], s41 offen offset:64
  s_waitcnt vmcnt(0)
  s_branch K2_col
K2_exit:
  s_endpgm
  .p2align 8
  .globl k3_kernel
  .type k3_kernel,@function
k3_kernel:
  s_cmp_ge_u32 s2, 256
  s_cbranch_scc1 K3_exit
  s_load_dwordx2 s[66:67], s[0:1], 32
  s_load_dwordx2 s[76:77], s[0:1], 64
  s_load_dwordx2 s[78:79], s[0:1], 80
  v_lshrrev_b32 v10, 6, v0
  v_and_b32 v1, 63, v0
  v_readfirstlane_b32 s3, v10
  v_lshrrev_b32 v2, 5, v1
  v_and_b32 v3, 31, v1
  s_bfe_u32 s6, s2, 0x20001
  s_lshr_b32 s7, s2, 3
  s_waitcnt lgkmcnt(0)
  s_mov_b32 s16, s76
  s_mov_b32 s17, s77
  s_mov_b32 s18, 4194304
  s_mov_b32 s19, 0x00020000
  s_bitcmp1_b32 s2, 0
  s_cbranch_scc1 K3_b
  s_and_b32 s4, s7, 3
  s_lshl_b32 s6, s6, 2
  s_add_u32 s4, s4, s6
  s_bfe_u32 s5, s7, 0x30002
  s_add_u32 s8, s78, 5242880
  s_addc_u32 s9, s79, 0
  s_mov_b32 s10, 2097152
  s_mov_b32 s11, 0x00020000
  s_mov_b32 s12, s66
  s_mov_b32 s13, s67
  s_mov_b32 s14, 524288
  s_mov_b32 s15, 0x00020000
  v_lshrrev_b32 v10, 2, v1
  v_and_b32 v10, 4, v10
  v_xor_b32 v10, v10, v1
  v_and_b32 v10, 7, v10
  v_lshlrev_b32 v10, 4, v10
  v_lshrrev_b32 v11, 3, v1
  v_lshl_or_b32 v5, v11, 10, v10
  v_and_b32 v10, 3, v1
  v_lshrrev_b32 v11, 1, v10
  v_and_b32 v10, 1, v10
  v_lshl_or_b32 v10, v10, 1, v11
  v_lshlrev_b32 v10, 3, v10
  v_bfe_u32 v11, v1, 2, 2
  v_lshl_or_b32 v8, v11, 5, v10
  v_lshl_or_b32 v8, v2, 10, v8
  v_add_u32 v8, 0x10000, v8
  v_lshl_or_b32 v10, v11, 7, v10
  v_lshl_or_b32 v10, v2, 10, v10
  v_bfe_u32 v11, v1, 4, 1
  v_lshl_or_b32 v10, v11, 5, v10
  v_bfe_u32 v11, v1, 3, 1
  v_lshl_or_b32 v6, v11, 6, v10
  v_xor_b32 v7, 64, v6
  v_lshlrev_b32 v4, 4, v1
  s_lshl_b32 s6, s4, 2
  s_add_u32 s6, s6, s3
  s_lshl_b32 s44, s6, 15
  s_lshl_b32 s45, s5, 7
  s_add_u32 s53, s4, s5
  s_and_b32 s53, s53, 3
  s_lshl_b32 s40, s3, 12
  s_mul_i32 s54, s3, 32768
  s_add_u32 s54, s54, s45
  s_add_u32 s55, s53, 0
  s_and_b32 s55, s55, 3
  s_mul_i32 s41, s55, 131072
  s_add_u32 s41, s41, s54
  s_lshl_b32 s57, s55, 13
  s_add_u32 s57, s57, s44
  s_mov_b32 m0, s40
  s_add_u32 s40, s40, 1024
  buffer_load_dwordx4 v5, s[12:15], s41 offen lds
  s_add_u32 s41, s41, 8192
  s_mov_b32 m0, s40
  s_add_u32 s40, s40, 1024
  buffer_load_dwordx4 v5, s[12:15], s41 offen lds
  s_add_u32 s41, s41, 8192
  s_mov_b32 m0, s40
  s_add_u32 s40, s40, 1024
  buffer_load_dwordx4 v5, s[12:15], s41 offen lds
  s_add_u32 s41, s41, 8192
  s_mov_b32 m0, s40
  s_add_u32 s40, s40, 13312
  buffer_load_dwordx4 v5, s[12:15], s41 offen lds
  buffer_load_dwordx4 v[128:131], v4, s[8:11], s57 offen offset:0
  buffer_load_dwordx4 v[132:135], v4, s[8:11], s57 offen offset:1024
  buffer_load_dwordx4 v[136:139], v4, s[8:11], s57 offen offset:2048
  buffer_load_dwordx4 v[140:143], v4, s[8:11], s57 offen offset:3072
  s_add_u32 s57, s57, 4096
  buffer_load_dwordx4 v[144:147], v4, s[8:11], s57 offen offset:0
  buffer_load_dwordx4 v[148:151], v4, s[8:11], s57 offen offset:1024
  buffer_load_dwordx4 v[152:155], v4, s[8:11], s57 offen offset:2048
  buffer_load_dwordx4 v[156:159], v4, s[8:11], s57 offen offset:3072
  s_add_u32 s55, s53, 1
  s_and_b32 s55, s55, 3
  s_mul_i32 s41, s55, 131072
  s_add_u32 s41, s41, s54
  s_lshl_b32 s57, s55, 13
  s_add_u32 s57, s57, s44
  s_mov_b32 m0, s40
  s_add_u32 s40, s40, 1024
  buffer_load_dwordx4 v5, s[12:15], s41 offen lds
  s_add_u32 s41, s41, 8192
  s_mov_b32 m0, s40
  s_add_u32 s40, s40, 1024
  buffer_load_dwordx4 v5, s[12:15], s41 offen lds
  s_add_u32 s41, s41, 8192
  s_mov_b32 m0, s40
  s_add_u32 s40, s40, 1024
  buffer_load_dwordx4 v5, s[12:15], s41 offen lds
  s_add_u32 s41, s41, 8192
  s_mov_b32 m0, s40
  s_add_u32 s40, s40, 13312
  buffer_load_dwordx4 v5, s[12:15], s41 offen lds
  buffer_load_dwordx4 v[160:163], v4, s[8:11], s57 offen offset:0
  buffer_load_dwordx4 v[164:167], v4, s[8:11], s57 offen offset:1024
  buffer_load_dwordx4 v[168:171], v4, s[8:11], s57 offen offset:2048
  buffer_load_dwordx4 v[172:175], v4, s[8:11], s57 offen offset:3072
  s_add_u32 s57, s57, 4096
  buffer_load_dwordx4 v[176:179], v4, s[8:11], s57 offen offset:0
  buffer_load_dwordx4 v[180:183], v4, s[8:11], s57 offen offset:1024
  buffer_load_dwordx4 v[184:187], v4, s[8:11], s57 offen offset:2048
  buffer_load_dwordx4 v[188:191], v4, s[8:11], s57 offen offset:3072
  s_waitcnt vmcnt(20)
  s_barrier
  ds_read_b64_tr_b16 v[32:33], v6 offset:0
  ds_read_b64_tr_b16 v[34:35], v6 offset:512
  ds_read_b64_tr_b16 v[36:37], v7 offset:0
  ds_read_b64_tr_b16 v[38:39], v7 offset:512
  ds_read_b64_tr_b16 v[40:41], v6 offset:2048
  ds_read_b64_tr_b16 v[42:43], v6 offset:2560
  ds_read_b64_tr_b16 v[44:45], v7 offset:2048
  ds_read_b64_tr_b16 v[46:47], v7 offset:2560
  ds_read_b64_tr_b16 v[48:49], v6 offset:4096
  ds_read_b64_tr_b16 v[50:51], v6 offset:4608
  ds_read_b64_tr_b16 v[52:53], v7 offset:4096
  ds_read_b64_tr_b16 v[54:55], v7 offset:4608
  s_waitcnt vmcnt(19)
  s_waitcnt lgkmcnt(8)
  v_mfma_f32_32x32x16_bf16 v[64:79], v[32:35], v[128:131], 0
  v_mfma_f32_32x32x16_bf16 v[80:95], v[36:39], v[128:131], 0
  ds_read_b64_tr_b16 v[56:57], v6 offset:6144
  ds_read_b64_tr_b16 v[58:59], v6 offset:6656
  ds_read_b64_tr_b16 v[60:61], v7 offset:6144
  ds_read_b64_tr_b16 v[62:63], v7 offset:6656
  s_add_u32 s55, s53, 2
  s_and_b32 s55, s55, 3
  s_mul_i32 s41, s55, 131072
  s_add_u32 s41, s41, s54
  s_lshl_b32 s57, s55, 13
  s_add_u32 s57, s57, s44
  s_mov_b32 m0, s40
  s_add_u32 s40, s40, 1024
  buffer_load_dwordx4 v5, s[12:15], s41 offen lds
  s_add_u32 s41, s41, 8192
  s_mov_b32 m0, s40
  s_add_u32 s40, s40, 1024
  buffer_load_dwordx4 v5, s[12:15], s41 offen lds
  s_add_u32 s41, s41, 8192
  s_waitcnt vmcnt(20)
  s_waitcnt lgkmcnt(8)
  v_mfma_f32_32x32x16_bf16 v[64:79], v[40:43], v[132:135], v[64:79]
  v_mfma_f32_32x32x16_bf16 v[80:95], v[44:47], v[132:135], v[80:95]
  ds_read_b64_tr_b16 v[32:33], v6 offset:8192
  ds_read_b64_tr_b16 v[34:35], v6 offset:8704
  ds_read_b64_tr_b16 v[36:37], v7 offset:8192
  ds_read_b64_tr_b16 v[38:39], v7 offset:8704
  s_mov_b32 m0, s40
  s_add_u32 s40, s40, 1024
  buffer_load_dwordx4 v5, s[12:15], s41 offen lds
  s_add_u32 s41, s41, 8192
  s_waitcnt vmcnt(20)
  s_waitcnt lgkmcnt(8)
  v_mfma_f32_32x32x16_bf16 v[64:79], v[48:51], v[136:139], v[64:79]
  v_mfma_f32_32x32x16_bf16 v[80:95], v[52:55], v[136:139], v[80:95]
  ds_read_b64_tr_b16 v[40:41], v6 offset:10240
  ds_read_b64_tr_b16 v[42:43], v6 offset:10752
  ds_read_b64_tr_b16 v[44:45], v7 offset:10240
  ds_read_b64_tr_b16 v[46:47], v7 offset:10752
  s_mov_b32 m0, s40
  s_add_u32 s40, s40, 13312
  buffer_load_dwordx4 v5, s[12:15], s41 offen lds
  buffer_load_dwordx4 v[192:195], v4, s[8:11], s57 offen offset:0
  s_waitcnt vmcnt(21)
  s_waitcnt lgkmcnt(8)
  v_mfma_f32_32x32x16_bf16 v[64:79], v[56:59], v[140:143], v[64:79]
  v_mfma_f32_32x32x16_bf16 v[80:95], v[60:63], v[140:143], v[80:95]
  ds_read_b64_tr_b16 v[48:49], v6 offset:12288
  ds_read_b64_tr_b16 v[50:51], v6 offset:12800
  ds_read_b64_tr_b16 v[52:53], v7 offset:12288
  ds_read_b64_tr_b16 v[54:55], v7 offset:12800
  buffer_load_dwordx4 v[196:199], v4, s[8:11], s57 offen offset:1024
  s_waitcnt vmcnt(21)
  s_waitcnt lgkmcnt(8)
  v_mfma_f32_32x32x16_bf16 v[64:79], v[32:35], v[144:147], v[64:79]
  v_mfma_f32_32x32x16_bf16 v[80:95], v[36:39], v[144:147], v[80:95]
  ds_read_b64_tr_b16 v[56:57], v6 offset:14336
  ds_read_b64_tr_b16 v[58:59], v6 offset:14848
  ds_read_b64_tr_b16 v[60:61], v7 offset:14336
  ds_read_b64_tr_b16 v[62:63], v7 offset:14848
  buffer_load_dwordx4 v[200:203], v4, s[8:11], s57 offen offset:2048
  buffer_load_dwordx4 v[204:207], v4, s[8:11], s57 offen offset:3072
  s_add_u32 s57, s57, 4096
  s_waitcnt vmcnt(22)
  s_waitcnt lgkmcnt(8)
  v_mfma_f32_32x32x16_bf16 v[64:79], v[40:43], v[148:151], v[64:79]
  v_mfma_f32_32x32x16_bf16 v[80:95], v[44:47], v[148:151], v[80:95]
  s_waitcnt vmcnt(16)
  s_barrier
  ds_read_b64_tr_b16 v[32:33], v6 offset:16384
  ds_read_b64_tr_b16 v[34:35], v6 offset:16896
  ds_read_b64_tr_b16 v[36:37], v7 offset:16384
  ds_read_b64_tr_b16 v[38:39], v7 offset:16896
  buffer_load_dwordx4 v[208:211], v4, s[8:11], s57 offen offset:0
  s_waitcnt lgkmcnt(8)
  v_mfma_f32_32x32x16_bf16 v[64:79], v[48:51], v[152:155], v[64:79]
  v_mfma_f32_32x32x16_bf16 v[80:95], v[52:55], v[152:155], v[80:95]
  ds_read_b64_tr_b16 v[40:41], v6 offset:18432
  ds_read_b64_tr_b16 v[42:43], v6 offset:18944
  ds_read_b64_tr_b16 v[44:45], v7 offset:18432
  ds_read_b64_tr_b16 v[46:47], v7 offset:18944
  buffer_load_dwordx4 v[212:215], v4, s[8:11], s57 offen offset:1024
  buffer_load_dwordx4 v[216:219], v4, s[8:11], s57 offen offset:2048
  s_waitcnt lgkmcnt(8)
  v_mfma_f32_32x32x16_bf16 v[64:79], v[56:59], v[156:159], v[64:79]
  v_mfma_f32_32x32x16_bf16 v[80:95], v[60:63], v[156:159], v[80:95]
  ds_read_b64_tr_b16 v[48:49], v6 offset:20480
  ds_read_b64_tr_b16 v[50:51], v6 offset:20992
  ds_read_b64_tr_b16 v[52:53], v7 offset:20480
  ds_read_b64_tr_b16 v[54:55], v7 offset:20992
  buffer_load_dwordx4 v[220:223], v4, s[8:11], s57 offen offset:3072
  s_waitcnt vmcnt(19)
  s_waitcnt lgkmcnt(8)
  v_mfma_f32_32x32x16_bf16 v[64:79], v[32:35], v[160:163], v[64:79]
  v_mfma_f32_32x32x16_bf16 v[80:95], v[36:39], v[160:163], v[80:95]
  ds_read_b64_tr_b16 v[56:57], v6 offset:22528
  ds_read_b64_tr_b16 v[58:59], v6 offset:23040
  ds_read_b64_tr_b16 v[60:61], v7 offset:22528
  ds_read_b64_tr_b16 v[62:63], v7 offset:23040
  s_add_u32 s55, s53, 3
  s_and_b32 s55, s55, 3
  s_mul_i32 s41, s55, 131072
  s_add_u32 s41, s41, s54
  s_lshl_b32 s57, s55, 13
  s_add_u32 s57, s57, s44
  s_mov_b32 m0, s40
  s_add_u32 s40, s40, 1024
  buffer_load_dwordx4 v5, s[12:15], s41 offen lds
  s_add_u32 s41, s41, 8192
  s_mov_b32 m0, s40
  s_add_u32 s40, s40, 1024
  buffer_load_dwordx4 v5, s[12:15], s41 offen lds
  s_add_u32 s41, s41, 8192
  s_waitcnt vmcnt(20)
  s_waitcnt lgkmcnt(8)
  v_mfma_f32_32x32x16_bf16 v[64:79], v[40:43], v[164:167], v[64:79]
  v_mfma_f32_32x32x16_bf16 v[80:95], v[44:47], v[164:167], v[80:95]
  ds_read_b64_tr_b16 v[32:33], v6 offset:24576
  ds_read_b64_tr_b16 v[34:35], v6 offset:25088
  ds_read_b64_tr_b16 v[36:37], v7 offset:24576
  ds_read_b64_tr_b16 v[38:39], v7 offset:25088
  s_mov_b32 m0, s40
  s_add_u32 s40, s40, 1024
  buffer_load_dwordx4 v5, s[12:15], s41 offen lds
  s_add_u32 s41, s41, 8192
  s_waitcnt vmcnt(20)
  s_waitcnt lgkmcnt(8)
  v_mfma_f32_32x32x16_bf16 v[64:79], v[48:51], v[168:171], v[64:79]
  v_mfma_f32_32x32x16_bf16 v[80:95], v[52:55], v[168:171], v[80:95]
  ds_read_b64_tr_b16 v[40:41], v6 offset:26624
  ds_read_b64_tr_b16 v[42:43], v6 offset:27136
  ds_read_b64_tr_b16 v[44:45], v7 offset:26624
  ds_read_b64_tr_b16 v[46:47], v7 offset:27136
  s_mov_b32 m0, s40
  s_add_u32 s40, s40, 13312
  buffer_load_dwordx4 v5, s[12:15], s41 offen lds
  buffer_load_dwordx4 v[224:227], v4, s[8:11], s57 offen offset:0
  s_waitcnt vmcnt(21)
  s_waitcnt lgkmcnt(8)
  v_mfma_f32_32x32x16_bf16 v[64:79], v[56:59], v[172:175], v[64:79]
  v_mfma_f32_32x32x16_bf16 v[80:95], v[60:63], v[172:175], v[80:95]
  ds_read_b64_tr_b16 v[48:49], v6 offset:28672
  ds_read_b64_tr_b16 v[50:51], v6 offset:29184
  ds_read_b64_tr_b16 v[52:53], v7 offset:28672
  ds_read_b64_tr_b16 v[54:55], v7 offset:29184
  buffer_load_dwordx4 v[228:231], v4, s[8:11], s57 offen offset:1024
  s_waitcnt vmcnt(21)
  s_waitcnt lgkmcnt(8)
  v_mfma_f32_32x32x16_bf16 v[64:79], v[32:35], v[176:179], v[64:79]
  v_mfma_f32_32x32x16_bf16 v[80:95], v[36:39], v[176:179], v[80:95]
  ds_read_b64_tr_b16 v[56:57], v6 offset:30720
  ds_read_b64_tr_b16 v[58:59], v6 offset:31232
  ds_read_b64_tr_b16 v[60:61], v7 offset:30720
  ds_read_b64_tr_b16 v[62:63], v7 offset:31232
  buffer_load_dwordx4 v[232:235], v4, s[8:11], s57 offen offset:2048
  buffer_load_dwordx4 v[236:239], v4, s[8:11], s57 offen offset:3072
  s_add_u32 s57, s57, 4096
  s_waitcnt vmcnt(22)
  s_waitcnt lgkmcnt(8)
  v_mfma_f32_32x32x16_bf16 v[64:79], v[40:43], v[180:183], v[64:79]
  v_mfma_f32_32x32x16_bf16 v[80:95], v[44:47], v[180:183], v[80:95]
  s_waitcnt vmcnt(16)
  s_barrier
  ds_read_b64_tr_b16 v[32:33], v6 offset:32768
  ds_read_b64_tr_b16 v[34:35], v6 offset:33280
  ds_read_b64_tr_b16 v[36:37], v7 offset:32768
  ds_read_b64_tr_b16 v[38:39], v7 offset:33280
  buffer_load_dwordx4 v[240:243], v4, s[8:11], s57 offen offset:0
  s_waitcnt lgkmcnt(8)
  v_mfma_f32_32x32x16_bf16 v[64:79], v[48:51], v[184:187], v[64:79]
  v_mfma_f32_32x32x16_bf16 v[80:95], v[52:55], v[184:187], v[80:95]
  ds_read_b64_tr_b16 v[40:41], v6 offset:34816
  ds_read_b64_tr_b16 v[42:43], v6 offset:35328
  ds_read_b64_tr_b16 v[44:45], v7 offset:34816
  ds_read_b64_tr_b16 v[46:47], v7 offset:35328
  buffer_load_dwordx4 v[244:247], v4, s[8:11], s57 offen offset:1024
  buffer_load_dwordx4 v[248:251], v4, s[8:11], s57 offen offset:2048
  s_waitcnt lgkmcnt(8)
  v_mfma_f32_32x32x16_bf16 v[64:79], v[56:59], v[188:191], v[64:79]
  v_mfma_f32_32x32x16_bf16 v[80:95], v[60:63], v[188:191], v[80:95]
  ds_read_b64_tr_b16 v[48:49], v6 offset:36864
  ds_read_b64_tr_b16 v[50:51], v6 offset:37376
  ds_read_b64_tr_b16 v[52:53], v7 offset:36864
  ds_read_b64_tr_b16 v[54:55], v7 offset:37376
  buffer_load_dwordx4 v[252:255], v4, s[8:11], s57 offen offset:3072
  s_waitcnt vmcnt(19)
  s_waitcnt lgkmcnt(8)
  v_mfma_f32_32x32x16_bf16 v[64:79], v[32:35], v[192:195], v[64:79]
  v_mfma_f32_32x32x16_bf16 v[80:95], v[36:39], v[192:195], v[80:95]
  ds_read_b64_tr_b16 v[56:57], v6 offset:38912
  ds_read_b64_tr_b16 v[58:59], v6 offset:39424
  ds_read_b64_tr_b16 v[60:61], v7 offset:38912
  ds_read_b64_tr_b16 v[62:63], v7 offset:39424
  s_waitcnt vmcnt(18)
  s_waitcnt lgkmcnt(8)
  v_mfma_f32_32x32x16_bf16 v[64:79], v[40:43], v[196:199], v[64:79]
  v_mfma_f32_32x32x16_bf16 v[80:95], v[44:47], v[196:199], v[80:95]
  ds_read_b64_tr_b16 v[32:33], v6 offset:40960
  ds_read_b64_tr_b16 v[34:35], v6 offset:41472
  ds_read_b64_tr_b16 v[36:37], v7 offset:40960
  ds_read_b64_tr_b16 v[38:39], v7 offset:41472
  s_waitcnt vmcnt(17)
  s_waitcnt lgkmcnt(8)
  v_mfma_f32_32x32x16_bf16 v[64:79], v[48:51], v[200:203], v[64:79]
  v_mfma_f32_32x32x16_bf16 v[80:95], v[52:55], v[200:203], v[80:95]
  ds_read_b64_tr_b16 v[40:41], v6 offset:43008
  ds_read_b64_tr_b16 v[42:43], v6 offset:43520
  ds_read_b64_tr_b16 v[44:45], v7 offset:43008
  ds_read_b64_tr_b16 v[46:47], v7 offset:43520
  s_waitcnt vmcnt(16)
  s_waitcnt lgkmcnt(8)
  v_mfma_f32_32x32x16_bf16 v[64:79], v[56:59], v[204:207], v[64:79]
  v_mfma_f32_32x32x16_bf16 v[80:95], v[60:63], v[204:207], v[80:95]
  ds_read_b64_tr_b16 v[48:49], v6 offset:45056
  ds_read_b64_tr_b16 v[50:51], v6 offset:45568
  ds_read_b64_tr_b16 v[52:53], v7 offset:45056
  ds_read_b64_tr_b16 v[54:55], v7 offset:45568
  s_waitcnt vmcnt(15)
  s_waitcnt lgkmcnt(8)
  v_mfma_f32_32x32x16_bf16 v[64:79], v[32:35], v[208:211], v[64:79]
  v_mfma_f32_32x32x16_bf16 v[80:95], v[36:39], v[208:211], v[80:95]
  ds_read_b64_tr_b16 v[56:57], v6 offset:47104
  ds_read_b64_tr_b16 v[58:59], v6 offset:47616
  ds_read_b64_tr_b16 v[60:61], v7 offset:47104
  ds_read_b64_tr_b16 v[62:63], v7 offset:47616
  s_waitcnt vmcnt(14)
  s_waitcnt lgkmcnt(8)
  v_mfma_f32_32x32x16_bf16 v[64:79], v[40:43], v[212:215], v[64:79]
  v_mfma_f32_32x32x16_bf16 v[80:95], v[44:47], v[212:215], v[80:95]
  s_waitcnt vmcnt(8)
  s_barrier
  ds_read_b64_tr_b16 v[32:33], v6 offset:49152
  ds_read_b64_tr_b16 v[34:35], v6 offset:49664
  ds_read_b64_tr_b16 v[36:37], v7 offset:49152
  ds_read_b64_tr_b16 v[38:39], v7 offset:49664
  s_waitcnt lgkmcnt(8)
  v_mfma_f32_32x32x16_bf16 v[64:79], v[48:51], v[216:219], v[64:79]
  v_mfma_f32_32x32x16_bf16 v[80:95], v[52:55], v[216:219], v[80:95]
  ds_read_b64_tr_b16 v[40:41], v6 offset:51200
  ds_read_b64_tr_b16 v[42:43], v6 offset:51712
  ds_read_b64_tr_b16 v[44:45], v7 offset:51200
  ds_read_b64_tr_b16 v[46:47], v7 offset:51712
  s_waitcnt lgkmcnt(8)
  v_mfma_f32_32x32x16_bf16 v[64:79], v[56:59], v[220:223], v[64:79]
  v_mfma_f32_32x32x16_bf16 v[80:95], v[60:63], v[220:223], v[80:95]
  ds_read_b64_tr_b16 v[48:49], v6 offset:53248
  ds_read_b64_tr_b16 v[50:51], v6 offset:53760
  ds_read_b64_tr_b16 v[52:53], v7 offset:53248
  ds_read_b64_tr_b16 v[54:55], v7 offset:53760
  s_waitcnt vmcnt(7)
  s_waitcnt lgkmcnt(8)
  v_mfma_f32_32x32x16_bf16 v[64:79], v[32:35], v[224:227], v[64:79]
  v_mfma_f32_32x32x16_bf16 v[80:95], v[36:39], v[224:227], v[80:95]
  ds_read_b64_tr_b16 v[56:57], v6 offset:55296
  ds_read_b64_tr_b16 v[58:59], v6 offset:55808
  ds_read_b64_tr_b16 v[60:61], v7 offset:55296
  ds_read_b64_tr_b16 v[62:63], v7 offset:55808
  s_waitcnt vmcnt(6)
  s_waitcnt lgkmcnt(8)
  v_mfma_f32_32x32x16_bf16 v[64:79], v[40:43], v[228:231], v[64:79]
  v_mfma_f32_32x32x16_bf16 v[80:95], v[44:47], v[228:231], v[80:95]
  ds_read_b64_tr_b16 v[32:33], v6 offset:57344
  ds_read_b64_tr_b16 v[34:35], v6 offset:57856
  ds_read_b64_tr_b16 v[36:37], v7 offset:57344
  ds_read_b64_tr_b16 v[38:39], v7 offset:57856
  s_waitcnt vmcnt(5)
  s_waitcnt lgkmcnt(8)
  v_mfma_f32_32x32x16_bf16 v[64:79], v[48:51], v[232:235], v[64:79]
  v_mfma_f32_32x32x16_bf16 v[80:95], v[52:55], v[232:235], v[80:95]
  ds_read_b64_tr_b16 v[40:41], v6 offset:59392
  ds_read_b64_tr_b16 v[42:43], v6 offset:59904
  ds_read_b64_tr_b16 v[44:45], v7 offset:59392
  ds_read_b64_tr_b16 v[46:47], v7 offset:59904
  s_waitcnt vmcnt(4)
  s_waitcnt lgkmcnt(8)
  v_mfma_f32_32x32x16_bf16 v[64:79], v[56:59], v[236:239], v[64:79]
  v_mfma_f32_32x32x16_bf16 v[80:95], v[60:63], v[236:239], v[80:95]
  ds_read_b64_tr_b16 v[48:49], v6 offset:61440
  ds_read_b64_tr_b16 v[50:51], v6 offset:61952
  ds_read_b64_tr_b16 v[52:53], v7 offset:61440
  ds_read_b64_tr_b16 v[54:55], v7 offset:61952
  s_waitcnt vmcnt(3)
  s_waitcnt lgkmcnt(8)
  v_mfma_f32_32x32x16_bf16 v[64:79], v[32:35], v[240:243], v[64:79]
  v_mfma_f32_32x32x16_bf16 v[80:95], v[36:39], v[240:243], v[80:95]
  ds_read_b64_tr_b16 v[56:57], v6 offset:63488
  ds_read_b64_tr_b16 v[58:59], v6 offset:64000
  ds_read_b64_tr_b16 v[60:61], v7 offset:63488
  ds_read_b64_tr_b16 v[62:63], v7 offset:64000
  s_waitcnt vmcnt(2)
  s_waitcnt lgkmcnt(8)
  v_mfma_f32_32x32x16_bf16 v[64:79], v[40:43], v[244:247], v[64:79]
  v_mfma_f32_32x32x16_bf16 v[80:95], v[44:47], v[244:247], v[80:95]
  s_waitcnt vmcnt(1)
  s_waitcnt lgkmcnt(4)
  v_mfma_f32_32x32x16_bf16 v[64:79], v[48:51], v[248:251], v[64:79]
  v_mfma_f32_32x32x16_bf16 v[80:95], v[52:55], v[248:251], v[80:95]
  s_waitcnt vmcnt(0)
  s_waitcnt lgkmcnt(0)
  v_mfma_f32_32x32x16_bf16 v[64:79], v[56:59], v[252:255], v[64:79]
  v_mfma_f32_32x32x16_bf16 v[80:95], v[60:63], v[252:255], v[80:95]
K3A_epi:
  s_lshl_b32 s44, s44, 1
  s_add_u32 s44, s44, s45
  v_and_b32 v11, 14, v1
  v_bfe_u32 v10, v1, 4, 1
  v_lshlrev_b32 v10, 6, v10
  v_lshl_or_b32 v10, v2, 5, v10
  v_lshl_or_b32 v9, v11, 11, v10
  v_and_b32 v10, 1, v1
  v_lshl_or_b32 v9, v10, 4, v9
  v_sub_u32 v12, 0, v10
  s_nop 7
  v_cvt_pk_bf16_f32 v32, v64, v65
  v_cvt_pk_bf16_f32 v33, v66, v67
  v_cvt_pk_bf16_f32 v34, v68, v69
  v_cvt_pk_bf16_f32 v35, v70, v71
  v_cvt_pk_bf16_f32 v36, v72, v73
  v_cvt_pk_bf16_f32 v37, v74, v75
  v_cvt_pk_bf16_f32 v38, v76, v77
  v_cvt_pk_bf16_f32 v39, v78, v79
  v_cvt_pk_bf16_f32 v40, v80, v81
  v_cvt_pk_bf16_f32 v41, v82, v83
  v_cvt_pk_bf16_f32 v42, v84, v85
  v_cvt_pk_bf16_f32 v43, v86, v87
  v_cvt_pk_bf16_f32 v44, v88, v89
  v_cvt_pk_bf16_f32 v45, v90, v91
  v_cvt_pk_bf16_f32 v46, v92, v93
  v_cvt_pk_bf16_f32 v47, v94, v95
  s_nop 1
  v_permlane32_swap_b32 v32, v36
  v_permlane32_swap_b32 v33, v37
  v_permlane32_swap_b32 v34, v38
  v_permlane32_swap_b32 v35, v39
  v_permlane32_swap_b32 v40, v44
  v_permlane32_swap_b32 v41, v45
  v_permlane32_swap_b32 v42, v46
  v_permlane32_swap_b32 v43, v47
  s_nop 1
  v_xor_b32_dpp v48, v36, v32 quad_perm:[1,0,3,2] row_mask:0xf bank_mask:0xf
  v_xor_b32_dpp v49, v37, v33 quad_perm:[1,0,3,2] row_mask:0xf bank_mask:0xf
  v_xor_b32_dpp v50, v38, v34 quad_perm:[1,0,3,2] row_mask:0xf bank_mask:0xf
  v_xor_b32_dpp v51, v39, v35 quad_perm:[1,0,3,2] row_mask:0xf bank_mask:0xf
  v_xor_b32_dpp v52, v44, v40 quad_perm:[1,0,3,2] row_mask:0xf bank_mask:0xf
  v_xor_b32_dpp v53, v45, v41 quad_perm:[1,0,3,2] row_mask:0xf bank_mask:0xf
  v_xor_b32_dpp v54, v46, v42 quad_perm:[1,0,3,2] row_mask:0xf bank_mask:0xf
  v_xor_b32_dpp v55, v47, v43 quad_perm:[1,0,3,2] row_mask:0xf bank_mask:0xf
  v_and_b32 v48, v12, v48
  v_and_b32 v49, v12, v49
  v_and_b32 v50, v12, v50
  v_and_b32 v51, v12, v51
  v_and_b32 v52, v12, v52
  v_and_b32 v53, v12, v53
  v_and_b32 v54, v12, v54
  v_and_b32 v55, v12, v55
  v_xor_b32 v32, v48, v32
  v_xor_b32 v33, v49, v33
  v_xor_b32 v34, v50, v34
  v_xor_b32 v35, v51, v35
  v_xor_b32 v40, v52, v40
  v_xor_b32 v41, v53, v41
  v_xor_b32 v42, v54, v42
  v_xor_b32 v43, v55, v43
  v_xor_b32_dpp v36, v48, v36 quad_perm:[1,0,3,2] row_mask:0xf bank_mask:0xf
  v_xor_b32_dpp v37, v49, v37 quad_perm:[1,0,3,2] row_mask:0xf bank_mask:0xf
  v_xor_b32_dpp v38, v50, v38 quad_perm:[1,0,3,2] row_mask:0xf bank_mask:0xf
  v_xor_b32_dpp v39, v51, v39 quad_perm:[1,0,3,2] row_mask:0xf bank_mask:0xf
  v_xor_b32_dpp v44, v52, v44 quad_perm:[1,0,3,2] row_mask:0xf bank_mask:0xf
  v_xor_b32_dpp v45, v53, v45 quad_perm:[1,0,3,2] row_mask:0xf bank_mask:0xf
  v_xor_b32_dpp v46, v54, v46 quad_perm:[1,0,3,2] row_mask:0xf bank_mask:0xf
  v_xor_b32_dpp v47, v55, v47 quad_perm:[1,0,3,2] row_mask:0xf bank_mask:0xf
  v_permlane16_swap_b32 v32, v40
  v_permlane16_swap_b32 v33, v41
  v_permlane16_swap_b32 v34, v42
  v_permlane16_swap_b32 v35, v43
  v_permlane16_swap_b32 v36, v44
  v_permlane16_swap_b32 v37, v45
  v_permlane16_swap_b32 v38, v46
  v_permlane16_swap_b32 v39, v47
  buffer_store_dwordx4 v[32:35], v9, s[16:19], s44 offen sc0 sc1
  s_add_u32 s44, s44, 2048
  buffer_store_dwordx4 v[36:39], v9, s[16:19], s44 offen sc0 sc1
  s_add_u32 s44, s44, 30720
  buffer_store_dwordx4 v[40:43], v9, s[16:19], s44 offen sc0 sc1
  s_add_u32 s44, s44, 2048
  buffer_store_dwordx4 v[44:47], v9, s[16:19], s44 offen sc0 sc1
  s_endpgm
K3_b:
  s_and_b32 s4, s7, 7
  s_lshl_b32 s6, s6, 3
  s_add_u32 s4, s4, s6
  s_bfe_u32 s5, s7, 0x20003
  s_lshl_b32 s5, s5, 2
  s_add_u32 s5, s5, s3
  s_add_u32 s8, s78, 9437184
  s_addc_u32 s9, s79, 0
  s_mov_b32 s10, 524288
  s_mov_b32 s11, 0x00020000
  s_add_u32 s12, s78, 7340032
  s_addc_u32 s13, s79, 0
  s_mov_b32 s14, 2097152
  s_mov_b32 s15, 0x00020000
  v_lshrrev_b32 v10, 2, v1
  v_and_b32 v10, 4, v10
  v_xor_b32 v10, v10, v1
  v_and_b32 v10, 7, v10
  v_lshlrev_b32 v10, 4, v10
  v_lshrrev_b32 v11, 3, v1
  v_lshl_or_b32 v5, v11, 12, v10
  v_and_b32 v10, 3, v1
  v_lshlrev_b32 v10, 3, v10
  v_bfe_u32 v11, v1, 2, 2
  v_lshl_or_b32 v8, v11, 5, v10
  v_lshl_or_b32 v8, v2, 10, v8
  v_add_u32 v8, 0x10000, v8
  v_lshl_or_b32 v10, v11, 7, v10
  v_lshl_or_b32 v10, v2, 10, v10
  v_bfe_u32 v11, v1, 4, 1
  v_lshl_or_b32 v10, v11, 5, v10
  v_bfe_u32 v11, v1, 3, 1
  v_lshl_or_b32 v6, v11, 6, v10
  v_xor_b32 v7, 64, v6
  v_lshlrev_b32 v4, 4, v1
  s_lshl_b32 s44, s5, 15
  s_lshl_b32 s45, s4, 7
  s_lshr_b32 s53, s5, 2
  s_add_u32 s53, s53, s4
  s_and_b32 s53, s53, 0
  s_lshl_b32 s40, s3, 12
  s_mul_i32 s54, s3, 131072
  s_add_u32 s54, s54, s45
  s_add_u32 s55, s53, 0
  s_and_b32 s55, s55, 3
  s_mul_i32 s41, s55, 524288
  s_add_u32 s41, s41, s54
  s_lshl_b32 s57, s55, 13
  s_add_u32 s57, s57, s44
  s_mov_b32 m0, s40
  s_add_u32 s40, s40, 1024
  buffer_load_dwordx4 v5, s[12:15], s41 offen lds
  s_add_u32 s41, s41, 32768
  s_mov_b32 m0, s40
  s_add_u32 s40, s40, 1024
  buffer_load_dwordx4 v5, s[12:15], s41 offen lds
  s_add_u32 s41, s41, 32768
  s_mov_b32 m0, s40
  s_add_u32 s40, s40, 1024
  buffer_load_dwordx4 v5, s[12:15], s41 offen lds
  s_add_u32 s41, s41, 32768
  s_mov_b32 m0, s40
  s_add_u32 s40, s40, 13312
  buffer_load_dwordx4 v5, s[12:15], s41 offen lds
  buffer_load_dwordx4 v[128:131], v4, s[8:11], s57 offen offset:0
  buffer_load_dwordx4 v[132:135], v4, s[8:11], s57 offen offset:1024
  buffer_load_dwordx4 v[136:139], v4, s[8:11], s57 offen offset:2048
  buffer_load_dwordx4 v[140:143], v4, s[8:11], s57 offen offset:3072
  s_add_u32 s57, s57, 4096
  buffer_load_dwordx4 v[144:147], v4, s[8:11], s57 offen offset:0
  buffer_load_dwordx4 v[148:151], v4, s[8:11], s57 offen offset:1024
  buffer_load_dwordx4 v[152:155], v4, s[8:11], s57 offen offset:2048
  buffer_load_dwordx4 v[156:159], v4, s[8:11], s57 offen offset:3072
  s_add_u32 s55, s53, 1
  s_and_b32 s55, s55, 3
  s_mul_i32 s41, s55, 524288
  s_add_u32 s41, s41, s54
  s_lshl_b32 s57, s55, 13
  s_add_u32 s57, s57, s44
  s_mov_b32 m0, s40
  s_add_u32 s40, s40, 1024
  buffer_load_dwordx4 v5, s[12:15], s41 offen lds
  s_add_u32 s41, s41, 32768
  s_mov_b32 m0, s40
  s_add_u32 s40, s40, 1024
  buffer_load_dwordx4 v5, s[12:15], s41 offen lds
  s_add_u32 s41, s41, 32768
  s_mov_b32 m0, s40
  s_add_u32 s40, s40, 1024
  buffer_load_dwordx4 v5, s[12:15], s41 offen lds
  s_add_u32 s41, s41, 32768
  s_mov_b32 m0, s40
  s_add_u32 s40, s40, 13312
  buffer_load_dwordx4 v5, s[12:15], s41 offen lds
  buffer_load_dwordx4 v[160:163], v4, s[8:11], s57 offen offset:0
  buffer_load_dwordx4 v[164:167], v4, s[8:11], s57 offen offset:1024
  buffer_load_dwordx4 v[168:171], v4, s[8:11], s57 offen offset:2048
  buffer_load_dwordx4 v[172:175], v4, s[8:11], s57 offen offset:3072
  s_add_u32 s57, s57, 4096
  buffer_load_dwordx4 v[176:179], v4, s[8:11], s57 offen offset:0
  buffer_load_dwordx4 v[180:183], v4, s[8:11], s57 offen offset:1024
  buffer_load_dwordx4 v[184:187], v4, s[8:11], s57 offen offset:2048
  buffer_load_dwordx4 v[188:191], v4, s[8:11], s57 offen offset:3072
  s_waitcnt vmcnt(20)
  s_barrier
  ds_read_b64_tr_b16 v[32:33], v6 offset:0
  ds_read_b64_tr_b16 v[34:35], v6 offset:512
  ds_read_b64_tr_b16 v[36:37], v7 offset:0
  ds_read_b64_tr_b16 v[38:39], v7 offset:512
  ds_read_b64_tr_b16 v[40:41], v6 offset:2048
  ds_read_b64_tr_b16 v[42:43], v6 offset:2560
  ds_read_b64_tr_b16 v[44:45], v7 offset:2048
  ds_read_b64_tr_b16 v[46:47], v7 offset:2560
  ds_read_b64_tr_b16 v[48:49], v6 offset:4096
  ds_read_b64_tr_b16 v[50:51], v6 offset:4608
  ds_read_b64_tr_b16 v[52:53], v7 offset:4096
  ds_read_b64_tr_b16 v[54:55], v7 offset:4608
  s_waitcnt vmcnt(19)
  s_waitcnt lgkmcnt(8)
  v_mfma_f32_32x32x16_bf16 v[64:79], v[128:131], v[32:35], 0
  v_mfma_f32_32x32x16_bf16 v[80:95], v[128:131], v[36:39], 0
  ds_read_b64_tr_b16 v[56:57], v6 offset:6144
  ds_read_b64_tr_b16 v[58:59], v6 offset:6656
  ds_read_b64_tr_b16 v[60:61], v7 offset:6144
  ds_read_b64_tr_b16 v[62:63], v7 offset:6656
  s_add_u32 s55, s53, 2
  s_and_b32 s55, s55, 3
  s_mul_i32 s41, s55, 524288
  s_add_u32 s41, s41, s54
  s_lshl_b32 s57, s55, 13
  s_add_u32 s57, s57, s44
  s_mov_b32 m0, s40
  s_add_u32 s40, s40, 1024
  buffer_load_dwordx4 v5, s[12:15], s41 offen lds
  s_add_u32 s41, s41, 32768
  s_mov_b32 m0, s40
  s_add_u32 s40, s40, 1024
  buffer_load_dwordx4 v5, s[12:15], s41 offen lds
  s_add_u32 s41, s41, 32768
  s_waitcnt vmcnt(20)
  s_waitcnt lgkmcnt(8)
  v_mfma_f32_32x32x16_bf16 v[64:79], v[132:135], v[40:43], v[64:79]
  v_mfma_f32_32x32x16_bf16 v[80:95], v[132:135], v[44:47], v[80:95]
  ds_read_b64_tr_b16 v[32:33], v6 offset:8192
  ds_read_b64_tr_b16 v[34:35], v6 offset:8704
  ds_read_b64_tr_b16 v[36:37], v7 offset:8192
  ds_read_b64_tr_b16 v[38:39], v7 offset:8704
  s_mov_b32 m0, s40
  s_add_u32 s40, s40, 1024
  buffer_load_dwordx4 v5, s[12:15], s41 offen lds
  s_add_u32 s41, s41, 32768
  s_waitcnt vmcnt(20)
  s_waitcnt lgkmcnt(8)
  v_mfma_f32_32x32x16_bf16 v[64:79], v[136:139], v[48:51], v[64:79]
  v_mfma_f32_32x32x16_bf16 v[80:95], v[136:139], v[52:55], v[80:95]
  ds_read_b64_tr_b16 v[40:41], v6 offset:10240
  ds_read_b64_tr_b16 v[42:43], v6 offset:10752
  ds_read_b64_tr_b16 v[44:45], v7 offset:10240
  ds_read_b64_tr_b16 v[46:47], v7 offset:10752
  s_mov_b32 m0, s40
  s_add_u32 s40, s40, 13312
  buffer_load_dwordx4 v5, s[12:15], s41 offen lds
  buffer_load_dwordx4 v[192:195], v4, s[8:11], s57 offen offset:0
  s_waitcnt vmcnt(21)
  s_waitcnt lgkmcnt(8)
  v_mfma_f32_32x32x16_bf16 v[64:79], v[140:143], v[56:59], v[64:79]
  v_mfma_f32_32x32x16_bf16 v[80:95], v[140:143], v[60:63], v[80:95]
  ds_read_b64_tr_b16 v[48:49], v6 offset:12288
  ds_read_b64_tr_b16 v[50:51], v6 offset:12800
  ds_read_b64_tr_b16 v[52:53], v7 offset:12288
  ds_read_b64_tr_b16 v[54:55], v7 offset:12800
  buffer_load_dwordx4 v[196:199], v4, s[8:11], s57 offen offset:1024
  s_waitcnt vmcnt(21)
  s_waitcnt lgkmcnt(8)
  v_mfma_f32_32x32x16_bf16 v[64:79], v[144:147], v[32:35], v[64:79]
  v_mfma_f32_32x32x16_bf16 v[80:95], v[144:147], v[36:39], v[80:95]
  ds_read_b64_tr_b16 v[56:57], v6 offset:14336
  ds_read_b64_tr_b16 v[58:59], v6 offset:14848
  ds_read_b64_tr_b16 v[60:61], v7 offset:14336
  ds_read_b64_tr_b16 v[62:63], v7 offset:14848
  buffer_load_dwordx4 v[200:203], v4, s[8:11], s57 offen offset:2048
  buffer_load_dwordx4 v[204:207], v4, s[8:11], s57 offen offset:3072
  s_add_u32 s57, s57, 4096
  s_waitcnt vmcnt(22)
  s_waitcnt lgkmcnt(8)
  v_mfma_f32_32x32x16_bf16 v[64:79], v[148:151], v[40:43], v[64:79]
  v_mfma_f32_32x32x16_bf16 v[80:95], v[148:151], v[44:47], v[80:95]
  s_waitcnt vmcnt(16)
  s_barrier
  ds_read_b64_tr_b16 v[32:33], v6 offset:16384
  ds_read_b64_tr_b16 v[34:35], v6 offset:16896
  ds_read_b64_tr_b16 v[36:37], v7 offset:16384
  ds_read_b64_tr_b16 v[38:39], v7 offset:16896
  buffer_load_dwordx4 v[208:211], v4, s[8:11], s57 offen offset:0
  s_waitcnt lgkmcnt(8)
  v_mfma_f32_32x32x16_bf16 v[64:79], v[152:155], v[48:51], v[64:79]
  v_mfma_f32_32x32x16_bf16 v[80:95], v[152:155], v[52:55], v[80:95]
  ds_read_b64_tr_b16 v[40:41], v6 offset:18432
  ds_read_b64_tr_b16 v[42:43], v6 offset:18944
  ds_read_b64_tr_b16 v[44:45], v7 offset:18432
  ds_read_b64_tr_b16 v[46:47], v7 offset:18944
  buffer_load_dwordx4 v[212:215], v4, s[8:11], s57 offen offset:1024
  buffer_load_dwordx4 v[216:219], v4, s[8:11], s57 offen offset:2048
  s_waitcnt lgkmcnt(8)
  v_mfma_f32_32x32x16_bf16 v[64:79], v[156:159], v[56:59], v[64:79]
  v_mfma_f32_32x32x16_bf16 v[80:95], v[156:159], v[60:63], v[80:95]
  ds_read_b64_tr_b16 v[48:49], v6 offset:20480
  ds_read_b64_tr_b16 v[50:51], v6 offset:20992
  ds_read_b64_tr_b16 v[52:53], v7 offset:20480
  ds_read_b64_tr_b16 v[54:55], v7 offset:20992
  buffer_load_dwordx4 v[220:223], v4, s[8:11], s57 offen offset:3072
  s_waitcnt vmcnt(19)
  s_waitcnt lgkmcnt(8)
  v_mfma_f32_32x32x16_bf16 v[64:79], v[160:163], v[32:35], v[64:79]
  v_mfma_f32_32x32x16_bf16 v[80:95], v[160:163], v[36:39], v[80:95]
  ds_read_b64_tr_b16 v[56:57], v6 offset:22528
  ds_read_b64_tr_b16 v[58:59], v6 offset:23040
  ds_read_b64_tr_b16 v[60:61], v7 offset:22528
  ds_read_b64_tr_b16 v[62:63], v7 offset:23040
  s_add_u32 s55, s53, 3
  s_and_b32 s55, s55, 3
  s_mul_i32 s41, s55, 524288
  s_add_u32 s41, s41, s54
  s_lshl_b32 s57, s55, 13
  s_add_u32 s57, s57, s44
  s_mov_b32 m0, s40
  s_add_u32 s40, s40, 1024
  buffer_load_dwordx4 v5, s[12:15], s41 offen lds
  s_add_u32 s41, s41, 32768
  s_mov_b32 m0, s40
  s_add_u32 s40, s40, 1024
  buffer_load_dwordx4 v5, s[12:15], s41 offen lds
  s_add_u32 s41, s41, 32768
  s_waitcnt vmcnt(20)
  s_waitcnt lgkmcnt(8)
  v_mfma_f32_32x32x16_bf16 v[64:79], v[164:167], v[40:43], v[64:79]
  v_mfma_f32_32x32x16_bf16 v[80:95], v[164:167], v[44:47], v[80:95]
  ds_read_b64_tr_b16 v[32:33], v6 offset:24576
  ds_read_b64_tr_b16 v[34:35], v6 offset:25088
  ds_read_b64_tr_b16 v[36:37], v7 offset:24576
  ds_read_b64_tr_b16 v[38:39], v7 offset:25088
  s_mov_b32 m0, s40
  s_add_u32 s40, s40, 1024
  buffer_load_dwordx4 v5, s[12:15], s41 offen lds
  s_add_u32 s41, s41, 32768
  s_waitcnt vmcnt(20)
  s_waitcnt lgkmcnt(8)
  v_mfma_f32_32x32x16_bf16 v[64:79], v[168:171], v[48:51], v[64:79]
  v_mfma_f32_32x32x16_bf16 v[80:95], v[168:171], v[52:55], v[80:95]
  ds_read_b64_tr_b16 v[40:41], v6 offset:26624
  ds_read_b64_tr_b16 v[42:43], v6 offset:27136
  ds_read_b64_tr_b16 v[44:45], v7 offset:26624
  ds_read_b64_tr_b16 v[46:47], v7 offset:27136
  s_mov_b32 m0, s40
  s_add_u32 s40, s40, 13312
  buffer_load_dwordx4 v5, s[12:15], s41 offen lds
  buffer_load_dwordx4 v[224:227], v4, s[8:11], s57 offen offset:0
  s_waitcnt vmcnt(21)
  s_waitcnt lgkmcnt(8)
  v_mfma_f32_32x32x16_bf16 v[64:79], v[172:175], v[56:59], v[64:79]
  v_mfma_f32_32x32x16_bf16 v[80:95], v[172:175], v[60:63], v[80:95]
  ds_read_b64_tr_b16 v[48:49], v6 offset:28672
  ds_read_b64_tr_b16 v[50:51], v6 offset:29184
  ds_read_b64_tr_b16 v[52:53], v7 offset:28672
  ds_read_b64_tr_b16 v[54:55], v7 offset:29184
  buffer_load_dwordx4 v[228:231], v4, s[8:11], s57 offen offset:1024
  s_waitcnt vmcnt(21)
  s_waitcnt lgkmcnt(8)
  v_mfma_f32_32x32x16_bf16 v[64:79], v[176:179], v[32:35], v[64:79]
  v_mfma_f32_32x32x16_bf16 v[80:95], v[176:179], v[36:39], v[80:95]
  ds_read_b64_tr_b16 v[56:57], v6 offset:30720
  ds_read_b64_tr_b16 v[58:59], v6 offset:31232
  ds_read_b64_tr_b16 v[60:61], v7 offset:30720
  ds_read_b64_tr_b16 v[62:63], v7 offset:31232
  buffer_load_dwordx4 v[232:235], v4, s[8:11], s57 offen offset:2048
  buffer_load_dwordx4 v[236:239], v4, s[8:11], s57 offen offset:3072
  s_add_u32 s57, s57, 4096
  s_waitcnt vmcnt(22)
  s_waitcnt lgkmcnt(8)
  v_mfma_f32_32x32x16_bf16 v[64:79], v[180:183], v[40:43], v[64:79]
  v_mfma_f32_32x32x16_bf16 v[80:95], v[180:183], v[44:47], v[80:95]
  s_waitcnt vmcnt(16)
  s_barrier
  ds_read_b64_tr_b16 v[32:33], v6 offset:32768
  ds_read_b64_tr_b16 v[34:35], v6 offset:33280
  ds_read_b64_tr_b16 v[36:37], v7 offset:32768
  ds_read_b64_tr_b16 v[38:39], v7 offset:33280
  buffer_load_dwordx4 v[240:243], v4, s[8:11], s57 offen offset:0
  s_waitcnt lgkmcnt(8)
  v_mfma_f32_32x32x16_bf16 v[64:79], v[184:187], v[48:51], v[64:79]
  v_mfma_f32_32x32x16_bf16 v[80:95], v[184:187], v[52:55], v[80:95]
  ds_read_b64_tr_b16 v[40:41], v6 offset:34816
  ds_read_b64_tr_b16 v[42:43], v6 offset:35328
  ds_read_b64_tr_b16 v[44:45], v7 offset:34816
  ds_read_b64_tr_b16 v[46:47], v7 offset:35328
  buffer_load_dwordx4 v[244:247], v4, s[8:11], s57 offen offset:1024
  buffer_load_dwordx4 v[248:251], v4, s[8:11], s57 offen offset:2048
  s_waitcnt lgkmcnt(8)
  v_mfma_f32_32x32x16_bf16 v[64:79], v[188:191], v[56:59], v[64:79]
  v_mfma_f32_32x32x16_bf16 v[80:95], v[188:191], v[60:63], v[80:95]
  ds_read_b64_tr_b16 v[48:49], v6 offset:36864
  ds_read_b64_tr_b16 v[50:51], v6 offset:37376
  ds_read_b64_tr_b16 v[52:53], v7 offset:36864
  ds_read_b64_tr_b16 v[54:55], v7 offset:37376
  buffer_load_dwordx4 v[252:255], v4, s[8:11], s57 offen offset:3072
  s_waitcnt vmcnt(19)
  s_waitcnt lgkmcnt(8)
  v_mfma_f32_32x32x16_bf16 v[64:79], v[192:195], v[32:35], v[64:79]
  v_mfma_f32_32x32x16_bf16 v[80:95], v[192:195], v[36:39], v[80:95]
  ds_read_b64_tr_b16 v[56:57], v6 offset:38912
  ds_read_b64_tr_b16 v[58:59], v6 offset:39424
  ds_read_b64_tr_b16 v[60:61], v7 offset:38912
  ds_read_b64_tr_b16 v[62:63], v7 offset:39424
  s_waitcnt vmcnt(18)
  s_waitcnt lgkmcnt(8)
  v_mfma_f32_32x32x16_bf16 v[64:79], v[196:199], v[40:43], v[64:79]
  v_mfma_f32_32x32x16_bf16 v[80:95], v[196:199], v[44:47], v[80:95]
  ds_read_b64_tr_b16 v[32:33], v6 offset:40960
  ds_read_b64_tr_b16 v[34:35], v6 offset:41472
  ds_read_b64_tr_b16 v[36:37], v7 offset:40960
  ds_read_b64_tr_b16 v[38:39], v7 offset:41472
  s_waitcnt vmcnt(17)
  s_waitcnt lgkmcnt(8)
  v_mfma_f32_32x32x16_bf16 v[64:79], v[200:203], v[48:51], v[64:79]
  v_mfma_f32_32x32x16_bf16 v[80:95], v[200:203], v[52:55], v[80:95]
  ds_read_b64_tr_b16 v[40:41], v6 offset:43008
  ds_read_b64_tr_b16 v[42:43], v6 offset:43520
  ds_read_b64_tr_b16 v[44:45], v7 offset:43008
  ds_read_b64_tr_b16 v[46:47], v7 offset:43520
  s_waitcnt vmcnt(16)
  s_waitcnt lgkmcnt(8)
  v_mfma_f32_32x32x16_bf16 v[64:79], v[204:207], v[56:59], v[64:79]
  v_mfma_f32_32x32x16_bf16 v[80:95], v[204:207], v[60:63], v[80:95]
  ds_read_b64_tr_b16 v[48:49], v6 offset:45056
  ds_read_b64_tr_b16 v[50:51], v6 offset:45568
  ds_read_b64_tr_b16 v[52:53], v7 offset:45056
  ds_read_b64_tr_b16 v[54:55], v7 offset:45568
  s_waitcnt vmcnt(15)
  s_waitcnt lgkmcnt(8)
  v_mfma_f32_32x32x16_bf16 v[64:79], v[208:211], v[32:35], v[64:79]
  v_mfma_f32_32x32x16_bf16 v[80:95], v[208:211], v[36:39], v[80:95]
  ds_read_b64_tr_b16 v[56:57], v6 offset:47104
  ds_read_b64_tr_b16 v[58:59], v6 offset:47616
  ds_read_b64_tr_b16 v[60:61], v7 offset:47104
  ds_read_b64_tr_b16 v[62:63], v7 offset:47616
  s_waitcnt vmcnt(14)
  s_waitcnt lgkmcnt(8)
  v_mfma_f32_32x32x16_bf16 v[64:79], v[212:215], v[40:43], v[64:79]
  v_mfma_f32_32x32x16_bf16 v[80:95], v[212:215], v[44:47], v[80:95]
  s_waitcnt vmcnt(8)
  s_barrier
  ds_read_b64_tr_b16 v[32:33], v6 offset:49152
  ds_read_b64_tr_b16 v[34:35], v6 offset:49664
  ds_read_b64_tr_b16 v[36:37], v7 offset:49152
  ds_read_b64_tr_b16 v[38:39], v7 offset:49664
  s_waitcnt lgkmcnt(8)
  v_mfma_f32_32x32x16_bf16 v[64:79], v[216:219], v[48:51], v[64:79]
  v_mfma_f32_32x32x16_bf16 v[80:95], v[216:219], v[52:55], v[80:95]
  ds_read_b64_tr_b16 v[40:41], v6 offset:51200
  ds_read_b64_tr_b16 v[42:43], v6 offset:51712
  ds_read_b64_tr_b16 v[44:45], v7 offset:51200
  ds_read_b64_tr_b16 v[46:47], v7 offset:51712
  s_waitcnt lgkmcnt(8)
  v_mfma_f32_32x32x16_bf16 v[64:79], v[220:223], v[56:59], v[64:79]
  v_mfma_f32_32x32x16_bf16 v[80:95], v[220:223], v[60:63], v[80:95]
  ds_read_b64_tr_b16 v[48:49], v6 offset:53248
  ds_read_b64_tr_b16 v[50:51], v6 offset:53760
  ds_read_b64_tr_b16 v[52:53], v7 offset:53248
  ds_read_b64_tr_b16 v[54:55], v7 offset:53760
  s_waitcnt vmcnt(7)
  s_waitcnt lgkmcnt(8)
  v_mfma_f32_32x32x16_bf16 v[64:79], v[224:227], v[32:35], v[64:79]
  v_mfma_f32_32x32x16_bf16 v[80:95], v[224:227], v[36:39], v[80:95]
  ds_read_b64_tr_b16 v[56:57], v6 offset:55296
  ds_read_b64_tr_b16 v[58:59], v6 offset:55808
  ds_read_b64_tr_b16 v[60:61], v7 offset:55296
  ds_read_b64_tr_b16 v[62:63], v7 offset:55808
  s_waitcnt vmcnt(6)
  s_waitcnt lgkmcnt(8)
  v_mfma_f32_32x32x16_bf16 v[64:79], v[228:231], v[40:43], v[64:79]
  v_mfma_f32_32x32x16_bf16 v[80:95], v[228:231], v[44:47], v[80:95]
  ds_read_b64_tr_b16 v[32:33], v6 offset:57344
  ds_read_b64_tr_b16 v[34:35], v6 offset:57856
  ds_read_b64_tr_b16 v[36:37], v7 offset:57344
  ds_read_b64_tr_b16 v[38:39], v7 offset:57856
  s_waitcnt vmcnt(5)
  s_waitcnt lgkmcnt(8)
  v_mfma_f32_32x32x16_bf16 v[64:79], v[232:235], v[48:51], v[64:79]
  v_mfma_f32_32x32x16_bf16 v[80:95], v[232:235], v[52:55], v[80:95]
  ds_read_b64_tr_b16 v[40:41], v6 offset:59392
  ds_read_b64_tr_b16 v[42:43], v6 offset:59904
  ds_read_b64_tr_b16 v[44:45], v7 offset:59392
  ds_read_b64_tr_b16 v[46:47], v7 offset:59904
  s_waitcnt vmcnt(4)
  s_waitcnt lgkmcnt(8)
  v_mfma_f32_32x32x16_bf16 v[64:79], v[236:239], v[56:59], v[64:79]
  v_mfma_f32_32x32x16_bf16 v[80:95], v[236:239], v[60:63], v[80:95]
  ds_read_b64_tr_b16 v[48:49], v6 offset:61440
  ds_read_b64_tr_b16 v[50:51], v6 offset:61952
  ds_read_b64_tr_b16 v[52:53], v7 offset:61440
  ds_read_b64_tr_b16 v[54:55], v7 offset:61952
  s_waitcnt vmcnt(3)
  s_waitcnt lgkmcnt(8)
  v_mfma_f32_32x32x16_bf16 v[64:79], v[240:243], v[32:35], v[64:79]
  v_mfma_f32_32x32x16_bf16 v[80:95], v[240:243], v[36:39], v[80:95]
  ds_read_b64_tr_b16 v[56:57], v6 offset:63488
  ds_read_b64_tr_b16 v[58:59], v6 offset:64000
  ds_read_b64_tr_b16 v[60:61], v7 offset:63488
  ds_read_b64_tr_b16 v[62:63], v7 offset:64000
  s_waitcnt vmcnt(2)
  s_waitcnt lgkmcnt(8)
  v_mfma_f32_32x32x16_bf16 v[64:79], v[244:247], v[40:43], v[64:79]
  v_mfma_f32_32x32x16_bf16 v[80:95], v[244:247], v[44:47], v[80:95]
  s_waitcnt vmcnt(1)
  s_waitcnt lgkmcnt(4)
  v_mfma_f32_32x32x16_bf16 v[64:79], v[248:251], v[48:51], v[64:79]
  v_mfma_f32_32x32x16_bf16 v[80:95], v[248:251], v[52:55], v[80:95]
  s_waitcnt vmcnt(0)
  s_waitcnt lgkmcnt(0)
  v_mfma_f32_32x32x16_bf16 v[64:79], v[252:255], v[56:59], v[64:79]
  v_mfma_f32_32x32x16_bf16 v[80:95], v[252:255], v[60:63], v[80:95]
  v_and_b32 v11, 28, v1
  v_lshl_or_b32 v11, v2, 1, v11
  v_and_b32 v10, 3, v1
  v_lshlrev_b32 v10, 4, v10
  v_lshl_or_b32 v9, v11, 16, v10
  v_bfe_i32 v12, v1, 0, 1
  v_bfe_i32 v13, v1, 1, 1
  s_lshl_b32 s44, s4, 11
  s_lshl_b32 s45, s5, 6
  s_add_u32 s44, s44, s45
  s_add_u32 s44, s44, 1024
  s_add_u32 s45, s44, 2097152
  s_nop 7
  v_cvt_pk_bf16_f32 v32, v64, v65
  v_cvt_pk_bf16_f32 v33, v66, v67
  v_cvt_pk_bf16_f32 v34, v68, v69
  v_cvt_pk_bf16_f32 v35, v70, v71
  v_cvt_pk_bf16_f32 v36, v72, v73
  v_cvt_pk_bf16_f32 v37, v74, v75
  v_cvt_pk_bf16_f32 v38, v76, v77
  v_cvt_pk_bf16_f32 v39, v78, v79
  s_nop 1
  v_xor_b32_dpp v48, v36, v32 quad_perm:[2,3,0,1] row_mask:0xf bank_mask:0xf
  v_xor_b32_dpp v49, v37, v33 quad_perm:[2,3,0,1] row_mask:0xf bank_mask:0xf
  v_xor_b32_dpp v50, v38, v34 quad_perm:[2,3,0,1] row_mask:0xf bank_mask:0xf
  v_xor_b32_dpp v51, v39, v35 quad_perm:[2,3,0,1] row_mask:0xf bank_mask:0xf
  v_and_b32 v48, v13, v48
  v_and_b32 v49, v13, v49
  v_and_b32 v50, v13, v50
  v_and_b32 v51, v13, v51
  v_xor_b32 v32, v48, v32
  v_xor_b32 v33, v49, v33
  v_xor_b32 v34, v50, v34
  v_xor_b32 v35, v51, v35
  v_xor_b32_dpp v36, v48, v36 quad_perm:[2,3,0,1] row_mask:0xf bank_mask:0xf
  v_xor_b32_dpp v37, v49, v37 quad_perm:[2,3,0,1] row_mask:0xf bank_mask:0xf
  v_xor_b32_dpp v38, v50, v38 quad_perm:[2,3,0,1] row_mask:0xf bank_mask:0xf
  v_xor_b32_dpp v39, v51, v39 quad_perm:[2,3,0,1] row_mask:0xf bank_mask:0xf
  s_nop 1
  v_permlane32_swap_b32 v32, v36
  v_permlane32_swap_b32 v33, v37
  v_permlane32_swap_b32 v34, v38
  v_permlane32_swap_b32 v35, v39
  s_nop 1
  v_xor_b32_dpp v48, v36, v32 quad_perm:[1,0,3,2] row_mask:0xf bank_mask:0xf
  v_xor_b32_dpp v49, v37, v33 quad_perm:[1,0,3,2] row_mask:0xf bank_mask:0xf
  v_xor_b32_dpp v50, v38, v34 quad_perm:[1,0,3,2] row_mask:0xf bank_mask:0xf
  v_xor_b32_dpp v51, v39, v35 quad_perm:[1,0,3,2] row_mask:0xf bank_mask:0xf
  v_and_b32 v48, v12, v48
  v_and_b32 v49, v12, v49
  v_and_b32 v50, v12, v50
  v_and_b32 v51, v12, v51
  v_xor_b32 v32, v48, v32
  v_xor_b32 v33, v49, v33
  v_xor_b32 v34, v50, v34
  v_xor_b32 v35, v51, v35
  v_xor_b32_dpp v36, v48, v36 quad_perm:[1,0,3,2] row_mask:0xf bank_mask:0xf
  v_xor_b32_dpp v37, v49, v37 quad_perm:[1,0,3,2] row_mask:0xf bank_mask:0xf
  v_xor_b32_dpp v38, v50, v38 quad_perm:[1,0,3,2] row_mask:0xf bank_mask:0xf
  v_xor_b32_dpp v39, v51, v39 quad_perm:[1,0,3,2] row_mask:0xf bank_mask:0xf
  buffer_store_dwordx4 v[32:35], v9, s[16:19], s44 offen sc0 sc1
  s_add_u32 s44, s44, 65536
  buffer_store_dwordx4 v[36:39], v9, s[16:19], s44 offen sc0 sc1
  v_cvt_pk_bf16_f32 v40, v80, v81
  v_cvt_pk_bf16_f32 v41, v82, v83
  v_cvt_pk_bf16_f32 v42, v84, v85
  v_cvt_pk_bf16_f32 v43, v86, v87
  v_cvt_pk_bf16_f32 v44, v88, v89
  v_cvt_pk_bf16_f32 v45, v90, v91
  v_cvt_pk_bf16_f32 v46, v92, v93
  v_cvt_pk_bf16_f32 v47, v94, v95
  s_nop 1
  v_xor_b32_dpp v48, v44, v40 quad_perm:[2,3,0,1] row_mask:0xf bank_mask:0xf
  v_xor_b32_dpp v49, v45, v41 quad_perm:[2,3,0,1] row_mask:0xf bank_mask:0xf
  v_xor_b32_dpp v50, v46, v42 quad_perm:[2,3,0,1] row_mask:0xf bank_mask:0xf
  v_xor_b32_dpp v51, v47, v43 quad_perm:[2,3,0,1] row_mask:0xf bank_mask:0xf
  v_and_b32 v48, v13, v48
  v_and_b32 v49, v13, v49
  v_and_b32 v50, v13, v50
  v_and_b32 v51, v13, v51
  v_xor_b32 v40, v48, v40
  v_xor_b32 v41, v49, v41
  v_xor_b32 v42, v50, v42
  v_xor_b32 v43, v51, v43
  v_xor_b32_dpp v44, v48, v44 quad_perm:[2,3,0,1] row_mask:0xf bank_mask:0xf
  v_xor_b32_dpp v45, v49, v45 quad_perm:[2,3,0,1] row_mask:0xf bank_mask:0xf
  v_xor_b32_dpp v46, v50, v46 quad_perm:[2,3,0,1] row_mask:0xf bank_mask:0xf
  v_xor_b32_dpp v47, v51, v47 quad_perm:[2,3,0,1] row_mask:0xf bank_mask:0xf
  s_nop 1
  v_permlane32_swap_b32 v40, v44
  v_permlane32_swap_b32 v41, v45
  v_permlane32_swap_b32 v42, v46
  v_permlane32_swap_b32 v43, v47
  s_nop 1
  v_xor_b32_dpp v48, v44, v40 quad_perm:[1,0,3,2] row_mask:0xf bank_mask:0xf
  v_xor_b32_dpp v49, v45, v41 quad_perm:[1,0,3,2] row_mask:0xf bank_mask:0xf
  v_xor_b32_dpp v50, v46, v42 quad_perm:[1,0,3,2] row_mask:0xf bank_mask:0xf
  v_xor_b32_dpp v51, v47, v43 quad_perm:[1,0,3,2] row_mask:0xf bank_mask:0xf
  v_and_b32 v48, v12, v48
  v_and_b32 v49, v12, v49
  v_and_b32 v50, v12, v50
  v_and_b32 v51, v12, v51
  v_xor_b32 v40, v48, v40
  v_xor_b32 v41, v49, v41
  v_xor_b32 v42, v50, v42
  v_xor_b32 v43, v51, v43
  v_xor_b32_dpp v44, v48, v44 quad_perm:[1,0,3,2] row_mask:0xf bank_mask:0xf
  v_xor_b32_dpp v45, v49, v45 quad_perm:[1,0,3,2] row_mask:0xf bank_mask:0xf
  v_xor_b32_dpp v46, v50, v46 quad_perm:[1,0,3,2] row_mask:0xf bank_mask:0xf
  v_xor_b32_dpp v47, v51, v47 quad_perm:[1,0,3,2] row_mask:0xf bank_mask:0xf
  buffer_store_dwordx4 v[40:43], v9, s[16:19], s45 offen sc0 sc1
  s_add_u32 s45, s45, 65536
  buffer_store_dwordx4 v[44:47], v9, s[16:19], s45 offen sc0 sc1
K3_exit:
  s_endpgm
.section .rodata,"a"
.p2align 6
.amdhsa_kernel k1_kernel
  .amdhsa_next_free_vgpr 256
  .amdhsa_next_free_sgpr 96
  .amdhsa_accum_offset 256
  .amdhsa_group_segment_fixed_size 0
  .amdhsa_kernarg_size 88
  .amdhsa_user_sgpr_count 2
  .amdhsa_user_sgpr_kernarg_segment_ptr 1
  .amdhsa_system_sgpr_workgroup_id_x 1
.end_amdhsa_kernel
.p2align 6
.amdhsa_kernel k2_kernel
  .amdhsa_next_free_vgpr 168
  .amdhsa_next_free_sgpr 96
  .amdhsa_accum_offset 168
  .amdhsa_group_segment_fixed_size 0
  .amdhsa_kernarg_size 88
  .amdhsa_user_sgpr_count 2
  .amdhsa_user_sgpr_kernarg_segment_ptr 1
  .amdhsa_system_sgpr_workgroup_id_x 1
.end_amdhsa_kernel
.p2align 6
.amdhsa_kernel k3_kernel
  .amdhsa_next_free_vgpr 256
  .amdhsa_next_free_sgpr 96
  .amdhsa_accum_offset 256
  .amdhsa_group_segment_fixed_size 0
  .amdhsa_kernarg_size 88
  .amdhsa_user_sgpr_count 2
  .amdhsa_user_sgpr_kernarg_segment_ptr 1
  .amdhsa_system_sgpr_workgroup_id_x 1
.end_amdhsa_kernel
```
